```python
import torch

def _softmax(x, axis=-1):
    return torch.softmax(x, dim=axis)

def _gelu(x):
    return torch.nn.functional.gelu(x, approximate='tanh')

def _silu(x):
    return torch.nn.functional.silu(x)

def _sigmoid(x):
    return torch.sigmoid(x)

def _layernorm(x, axis=-1, eps=1e-05):
    m = x.mean(dim=axis, keepdim=True)
    v = x.var(dim=axis, keepdim=True, unbiased=False)
    return (x - m) / torch.sqrt(v + eps)

def _scatter_add(tgt, idx, src, axis=0):
    return tgt.clone().index_add_(axis, idx, src)

def _segment_sum(src, seg, n):
    out = torch.zeros((n,) + src.shape[1:], dtype=src.dtype)
    return out.index_add_(0, seg, src)

def _pad(x, pw):
    flat = tuple((v for pair in reversed(pw) for v in pair))
    return torch.nn.functional.pad(x, flat)
kernel_name = 'concat_heads__spectral_gfnet__memory_aug_recurrent_mem_tr__prompt'

def setup_inputs():

    _w = lambda a: (lambda t: t.to(torch.bfloat16) if t.is_floating_point() else t)(torch.as_tensor(a))

    def _A_setup():
        B, S, D = (1, 2048, 640)
        Df = D // 2 + 1
        return {'x': _w((lambda *s: torch.randn(*s, dtype=torch.bfloat16) * 0.05)(B, S, D)), 'w_r': _w((lambda *s: torch.randn(*s, dtype=torch.bfloat16) * 3.2)(S, Df) * 0.02), 'w_i': _w((lambda *s: torch.randn(*s, dtype=torch.bfloat16) * 3.2)(S, Df) * 0.02)}
    _A_in = _A_setup()

    def _B_setup():
        B, S, Dm = (1, 2048, 640)
        H, Dh = (32, 128)
        M, seg = (8, 32)
        seg = min(seg, S)
        S = S // seg * seg
        return {'x': _w((lambda *s: torch.randn(*s, dtype=torch.bfloat16) * 0.05)(B, S, Dm)), 'mem0': _w((lambda *s: torch.randn(*s, dtype=torch.bfloat16) * 0.4)(B, M, Dm)), 'Wq': _w((lambda *s: torch.randn(*s, dtype=torch.bfloat16) * 6.4)(Dm, H, Dh) * Dm ** (-0.5)), 'Wk': _w((lambda *s: torch.randn(*s, dtype=torch.bfloat16) * 6.4)(Dm, H, Dh) * Dm ** (-0.5)), 'Wv': _w((lambda *s: torch.randn(*s, dtype=torch.bfloat16) * 0.4)(Dm, H, Dh) * Dm ** (-0.5)), 'Wo': _w((lambda *s: torch.randn(*s, dtype=torch.bfloat16) * 0.4)(H, Dh, Dm) * (H * Dh) ** (-0.5)), 'seg_len': seg}
    _B_in = _B_setup()
    return {'A_x': _A_in['x'], 'A_w_r': _A_in['w_r'], 'A_w_i': _A_in['w_i'], 'B_x': _B_in['x'], 'B_mem0': _B_in['mem0'], 'B_Wq': _B_in['Wq'], 'B_Wk': _B_in['Wk'], 'B_Wv': _B_in['Wv'], 'B_Wo': _B_in['Wo'], 'B_seg_len': _B_in['seg_len']}

def reference(A_x, A_w_r, A_w_i, B_x, B_mem0, B_Wq, B_Wk, B_Wv, B_Wo, B_seg_len):

    def _A_ref(x, w_r, w_i):
        B, S, D = x.shape
        X = (lambda x, axes=(-2, -1): torch.fft.rfft2(x.float(), dim=axes))(x, axes=(-2, -1))
        W = w_r + 1j * w_i
        X = X * W
        y = (lambda x, s, axes=(-2, -1): torch.fft.irfft2(x, s=s, dim=axes).to(torch.bfloat16))(X, (S, D), axes=(-2, -1))
        return y

    def _B_ref(x, mem0, Wq, Wk, Wv, Wo, seg_len):
        B, S, Dm = x.shape
        H, Dh = (Wq.shape[1], Wq.shape[2])
        M = mem0.shape[1]
        scale = Dh ** (-0.5)
        n_seg = S // seg_len
        L = M + seg_len
        idx = torch.arange(L)
        mask = (idx[:, None] < M) | (idx[:, None] >= idx[None, :])
        mem = mem0
        outs = []
        for s in range(n_seg):
            xs = x[:, s * seg_len:(s + 1) * seg_len, :].clone()
            h = torch.concatenate([mem, xs], axis=1)
            q = torch.einsum('btd,dhe->bhte', h, Wq)
            k = torch.einsum('btd,dhe->bhte', h, Wk)
            v = torch.einsum('btd,dhe->bhte', h, Wv)
            scores = torch.einsum('bhqe,bhke->bhqk', q, k) * scale
            scores = torch.where(mask[None, None], scores, -1000000000.0)
            p = _softmax(scores, axis=-1)
            o = torch.einsum('bhqk,bhke->bhqe', p, v)
            o = torch.einsum('bhte,hed->btd', o, Wo)
            mem = o[:, :M, :].clone()
            outs.append(o[:, M:, :])
        return torch.concatenate(outs, axis=1)
    a = _A_ref(A_x, A_w_r, A_w_i)
    b = _B_ref(B_x, B_mem0, B_Wq, B_Wk, B_Wv, B_Wo, B_seg_len)
    return torch.concatenate([a, b], axis=-1)
```

```asm
; @launch kernel=main_kernel grid=(256,1,1) block=(256,1,1) lds=149504
.amdgcn_target "amdgcn-amd-amdhsa--gfx950"
.text
.globl main_kernel
.p2align 8
.type main_kernel,@function
main_kernel:
    s_cmp_ge_u32 s2, 256
    s_cbranch_scc1 .done_2
    s_load_dwordx16 s[16:31], s[0:1], 0
    s_load_dwordx8 s[32:39], s[0:1], 64
    s_load_dwordx2 s[40:41], s[0:1], 96
    s_waitcnt lgkmcnt(0)
    s_sub_u32 s3, 0, s40
    s_and_b32 s3, s3, 0x1fffff
    s_add_u32 s40, s40, s3
    s_addc_u32 s41, s41, 0
    s_getreg_b32 s3, hwreg(HW_REG_XCC_ID)
    s_and_b32 s3, s3, 7
    s_cmp_lg_u32 s3, 0
    s_cbranch_scc1 .other_6
    v_mov_b32 v1, 0
    v_mov_b32 v2, 1
    v_cmp_eq_u32 vcc, 0, v0
    s_nop 0
    s_and_saveexec_b64 s[6:7], vcc
    s_cbranch_execz .tk_9
    global_atomic_add v3, v1, v2, s[38:39] sc0
    s_waitcnt vmcnt(0)
    v_mov_b32 v4, 0
    ds_write_b32 v4, v3
    s_waitcnt lgkmcnt(0)
.tk_9:
    s_mov_b64 exec, s[6:7]
    s_barrier
    v_mov_b32 v4, 0
    ds_read_b32 v3, v4
    s_waitcnt lgkmcnt(0)
    v_readfirstlane_b32 s52, v3
    s_barrier
    s_cmp_lt_u32 s52, 32
    s_cbranch_scc1 .hrole_4
.other_6:
    s_cmp_lg_u32 s3, 1
    s_cbranch_scc1 .other2_10
    v_mov_b32 v1, 4
    v_mov_b32 v2, 1
    v_cmp_eq_u32 vcc, 0, v0
    s_nop 0
    s_and_saveexec_b64 s[6:7], vcc
    s_cbranch_execz .tk_11
    global_atomic_add v3, v1, v2, s[38:39] sc0
    s_waitcnt vmcnt(0)
    v_mov_b32 v4, 0
    ds_write_b32 v4, v3
    s_waitcnt lgkmcnt(0)
.tk_11:
    s_mov_b64 exec, s[6:7]
    s_barrier
    v_mov_b32 v4, 0
    ds_read_b32 v3, v4
    s_waitcnt lgkmcnt(0)
    v_readfirstlane_b32 s52, v3
    s_barrier
    s_cmp_lt_u32 s52, 32
    s_cbranch_scc1 .vrole_5
.other2_10:
    v_mov_b32 v1, 112
    v_mov_b32 v2, 1
    v_cmp_eq_u32 vcc, 0, v0
    s_nop 0
    s_and_saveexec_b64 s[6:7], vcc
    s_cbranch_execz .tk_12
    global_atomic_add v3, v1, v2, s[38:39] sc0
    s_waitcnt vmcnt(0)
    v_mov_b32 v4, 0
    ds_write_b32 v4, v3
    s_waitcnt lgkmcnt(0)
.tk_12:
    s_mov_b64 exec, s[6:7]
    s_barrier
    v_mov_b32 v4, 0
    ds_read_b32 v3, v4
    s_waitcnt lgkmcnt(0)
    v_readfirstlane_b32 s52, v3
    s_barrier
    s_mov_b32 s82, s52
    s_cmp_lg_u32 s3, 2
    s_cbranch_scc1 .nomeas_13
    v_mov_b32 v1, 132
    v_mov_b32 v2, 1
    v_cmp_eq_u32 vcc, 0, v0
    s_nop 0
    s_and_saveexec_b64 s[6:7], vcc
    s_cbranch_execz .tk_14
    global_atomic_add v3, v1, v2, s[38:39] sc0
    s_waitcnt vmcnt(0)
    v_mov_b32 v4, 0
    ds_write_b32 v4, v3
    s_waitcnt lgkmcnt(0)
.tk_14:
    s_mov_b64 exec, s[6:7]
    s_barrier
    v_mov_b32 v4, 0
    ds_read_b32 v3, v4
    s_waitcnt lgkmcnt(0)
    v_readfirstlane_b32 s55, v3
    s_barrier
    s_cmp_lg_u32 s55, 0
    s_cbranch_scc1 .nomeas_13
    v_readfirstlane_b32 s55, v0
    s_nop 0
    s_cmp_lg_u32 s55, 0
    s_cbranch_scc1 .nomeas_13
    s_mov_b64 exec, 1
    v_mov_b32 v3, 0
    s_mov_b32 s70, -1
    s_mov_b32 s71, -1
    v_mov_b32 v2, 0x5aa1f80
    s_memtime s[4:5]
    s_waitcnt lgkmcnt(0)
    global_atomic_add v4, v2, v3, s[40:41] sc0
    s_waitcnt vmcnt(0)
    s_memtime s[6:7]
    s_waitcnt lgkmcnt(0)
    s_sub_u32 s6, s6, s4
    s_min_u32 s70, s70, s6
    v_mov_b32 v2, 0x5aa3f80
    s_memtime s[4:5]
    s_waitcnt lgkmcnt(0)
    global_atomic_add v4, v2, v3, s[40:41] sc0
    s_waitcnt vmcnt(0)
    s_memtime s[6:7]
    s_waitcnt lgkmcnt(0)
    s_sub_u32 s6, s6, s4
    s_min_u32 s71, s71, s6
    v_mov_b32 v2, 0x5aa1b80
    s_memtime s[4:5]
    s_waitcnt lgkmcnt(0)
    global_atomic_add v4, v2, v3, s[40:41] sc0
    s_waitcnt vmcnt(0)
    s_memtime s[6:7]
    s_waitcnt lgkmcnt(0)
    s_sub_u32 s6, s6, s4
    s_min_u32 s70, s70, s6
    v_mov_b32 v2, 0x5aa3b80
    s_memtime s[4:5]
    s_waitcnt lgkmcnt(0)
    global_atomic_add v4, v2, v3, s[40:41] sc0
    s_waitcnt vmcnt(0)
    s_memtime s[6:7]
    s_waitcnt lgkmcnt(0)
    s_sub_u32 s6, s6, s4
    s_min_u32 s71, s71, s6
    v_mov_b32 v2, 0x5aa1780
    s_memtime s[4:5]
    s_waitcnt lgkmcnt(0)
    global_atomic_add v4, v2, v3, s[40:41] sc0
    s_waitcnt vmcnt(0)
    s_memtime s[6:7]
    s_waitcnt lgkmcnt(0)
    s_sub_u32 s6, s6, s4
    s_min_u32 s70, s70, s6
    v_mov_b32 v2, 0x5aa3780
    s_memtime s[4:5]
    s_waitcnt lgkmcnt(0)
    global_atomic_add v4, v2, v3, s[40:41] sc0
    s_waitcnt vmcnt(0)
    s_memtime s[6:7]
    s_waitcnt lgkmcnt(0)
    s_sub_u32 s6, s6, s4
    s_min_u32 s71, s71, s6
    v_mov_b32 v2, 0x5aa1380
    s_memtime s[4:5]
    s_waitcnt lgkmcnt(0)
    global_atomic_add v4, v2, v3, s[40:41] sc0
    s_waitcnt vmcnt(0)
    s_memtime s[6:7]
    s_waitcnt lgkmcnt(0)
    s_sub_u32 s6, s6, s4
    s_min_u32 s70, s70, s6
    v_mov_b32 v2, 0x5aa3380
    s_memtime s[4:5]
    s_waitcnt lgkmcnt(0)
    global_atomic_add v4, v2, v3, s[40:41] sc0
    s_waitcnt vmcnt(0)
    s_memtime s[6:7]
    s_waitcnt lgkmcnt(0)
    s_sub_u32 s6, s6, s4
    s_min_u32 s71, s71, s6
    v_mov_b32 v2, 0x5aa1f80
    s_memtime s[4:5]
    s_waitcnt lgkmcnt(0)
    global_atomic_add v4, v2, v3, s[40:41] sc0
    s_waitcnt vmcnt(0)
    s_memtime s[6:7]
    s_waitcnt lgkmcnt(0)
    s_sub_u32 s6, s6, s4
    s_min_u32 s70, s70, s6
    v_mov_b32 v2, 0x5aa3f80
    s_memtime s[4:5]
    s_waitcnt lgkmcnt(0)
    global_atomic_add v4, v2, v3, s[40:41] sc0
    s_waitcnt vmcnt(0)
    s_memtime s[6:7]
    s_waitcnt lgkmcnt(0)
    s_sub_u32 s6, s6, s4
    s_min_u32 s71, s71, s6
    v_mov_b32 v2, 0x5aa1b80
    s_memtime s[4:5]
    s_waitcnt lgkmcnt(0)
    global_atomic_add v4, v2, v3, s[40:41] sc0
    s_waitcnt vmcnt(0)
    s_memtime s[6:7]
    s_waitcnt lgkmcnt(0)
    s_sub_u32 s6, s6, s4
    s_min_u32 s70, s70, s6
    v_mov_b32 v2, 0x5aa3b80
    s_memtime s[4:5]
    s_waitcnt lgkmcnt(0)
    global_atomic_add v4, v2, v3, s[40:41] sc0
    s_waitcnt vmcnt(0)
    s_memtime s[6:7]
    s_waitcnt lgkmcnt(0)
    s_sub_u32 s6, s6, s4
    s_min_u32 s71, s71, s6
    v_mov_b32 v2, 0x5aa1780
    s_memtime s[4:5]
    s_waitcnt lgkmcnt(0)
    global_atomic_add v4, v2, v3, s[40:41] sc0
    s_waitcnt vmcnt(0)
    s_memtime s[6:7]
    s_waitcnt lgkmcnt(0)
    s_sub_u32 s6, s6, s4
    s_min_u32 s70, s70, s6
    v_mov_b32 v2, 0x5aa3780
    s_memtime s[4:5]
    s_waitcnt lgkmcnt(0)
    global_atomic_add v4, v2, v3, s[40:41] sc0
    s_waitcnt vmcnt(0)
    s_memtime s[6:7]
    s_waitcnt lgkmcnt(0)
    s_sub_u32 s6, s6, s4
    s_min_u32 s71, s71, s6
    v_mov_b32 v2, 0x5aa1380
    s_memtime s[4:5]
    s_waitcnt lgkmcnt(0)
    global_atomic_add v4, v2, v3, s[40:41] sc0
    s_waitcnt vmcnt(0)
    s_memtime s[6:7]
    s_waitcnt lgkmcnt(0)
    s_sub_u32 s6, s6, s4
    s_min_u32 s70, s70, s6
    v_mov_b32 v2, 0x5aa3380
    s_memtime s[4:5]
    s_waitcnt lgkmcnt(0)
    global_atomic_add v4, v2, v3, s[40:41] sc0
    s_waitcnt vmcnt(0)
    s_memtime s[6:7]
    s_waitcnt lgkmcnt(0)
    s_sub_u32 s6, s6, s4
    s_min_u32 s71, s71, s6
    v_mov_b32 v2, 0x5aa1f80
    s_memtime s[4:5]
    s_waitcnt lgkmcnt(0)
    global_atomic_add v4, v2, v3, s[40:41] sc0
    s_waitcnt vmcnt(0)
    s_memtime s[6:7]
    s_waitcnt lgkmcnt(0)
    s_sub_u32 s6, s6, s4
    s_min_u32 s70, s70, s6
    v_mov_b32 v2, 0x5aa3f80
    s_memtime s[4:5]
    s_waitcnt lgkmcnt(0)
    global_atomic_add v4, v2, v3, s[40:41] sc0
    s_waitcnt vmcnt(0)
    s_memtime s[6:7]
    s_waitcnt lgkmcnt(0)
    s_sub_u32 s6, s6, s4
    s_min_u32 s71, s71, s6
    v_mov_b32 v2, 0x5aa1b80
    s_memtime s[4:5]
    s_waitcnt lgkmcnt(0)
    global_atomic_add v4, v2, v3, s[40:41] sc0
    s_waitcnt vmcnt(0)
    s_memtime s[6:7]
    s_waitcnt lgkmcnt(0)
    s_sub_u32 s6, s6, s4
    s_min_u32 s70, s70, s6
    v_mov_b32 v2, 0x5aa3b80
    s_memtime s[4:5]
    s_waitcnt lgkmcnt(0)
    global_atomic_add v4, v2, v3, s[40:41] sc0
    s_waitcnt vmcnt(0)
    s_memtime s[6:7]
    s_waitcnt lgkmcnt(0)
    s_sub_u32 s6, s6, s4
    s_min_u32 s71, s71, s6
    s_cmp_lt_u32 s71, s70
    s_cselect_b32 s55, 2, 1
    v_mov_b32 v2, 16
    v_mov_b32 v4, s55
    v_mov_b32 v5, 0
    global_atomic_cmpswap v2, v[4:5], s[38:39]
    s_mov_b64 exec, -1
.nomeas_13:
    s_mov_b32 s76, 0
    s_mov_b32 s77, 0
    s_mov_b32 s83, -1
.work_8:
    s_cmp_lg_u32 s76, 0
    s_cbranch_scc1 .chk_15
    s_cmp_gt_u32 s77, 34
    s_cselect_b32 s76, 1, 0
.chk_15:
    s_cmp_lt_u32 s82, 92
    s_cbranch_scc1 .nc2_17
    s_cmp_lg_u32 s76, 1
    s_cbranch_scc1 .nc_16
    v_mov_b32 v1, 0
    v_mov_b32 v2, 0
    v_cmp_eq_u32 vcc, 0, v0
    s_nop 0
    s_and_saveexec_b64 s[6:7], vcc
    s_cbranch_execz .tk_18
    global_atomic_add v3, v1, v2, s[38:39] sc0
    s_waitcnt vmcnt(0)
    v_mov_b32 v4, 0
    ds_write_b32 v4, v3
    s_waitcnt lgkmcnt(0)
.tk_18:
    s_mov_b64 exec, s[6:7]
    s_barrier
    v_mov_b32 v4, 0
    ds_read_b32 v3, v4
    s_waitcnt lgkmcnt(0)
    v_readfirstlane_b32 s55, v3
    s_barrier
    s_cmp_ge_u32 s55, 32
    s_cbranch_scc1 .nc_16
    v_mov_b32 v1, 8
    v_mov_b32 v2, 1
    v_cmp_eq_u32 vcc, 0, v0
    s_nop 0
    s_and_saveexec_b64 s[6:7], vcc
    s_cbranch_execz .tk_19
    global_atomic_add v3, v1, v2, s[38:39] sc0
    s_waitcnt vmcnt(0)
    v_mov_b32 v4, 0
    ds_write_b32 v4, v3
    s_waitcnt lgkmcnt(0)
.tk_19:
    s_mov_b64 exec, s[6:7]
    s_barrier
    v_mov_b32 v4, 0
    ds_read_b32 v3, v4
    s_waitcnt lgkmcnt(0)
    v_readfirstlane_b32 s55, v3
    s_barrier
    v_mov_b32 v1, 0
    v_mov_b32 v2, 1
    v_cmp_eq_u32 vcc, 0, v0
    s_nop 0
    s_and_saveexec_b64 s[6:7], vcc
    s_cbranch_execz .tk_20
    global_atomic_add v3, v1, v2, s[38:39] sc0
    s_waitcnt vmcnt(0)
    v_mov_b32 v4, 0
    ds_write_b32 v4, v3
    s_waitcnt lgkmcnt(0)
.tk_20:
    s_mov_b64 exec, s[6:7]
    s_barrier
    v_mov_b32 v4, 0
    ds_read_b32 v3, v4
    s_waitcnt lgkmcnt(0)
    v_readfirstlane_b32 s52, v3
    s_barrier
    s_cmp_lt_u32 s52, 32
    s_cbranch_scc1 .hrole_4
.nc_16:
    s_cmp_lg_u32 s76, 1
    s_cbranch_scc1 .nc2_17
    v_mov_b32 v1, 4
    v_mov_b32 v2, 0
    v_cmp_eq_u32 vcc, 0, v0
    s_nop 0
    s_and_saveexec_b64 s[6:7], vcc
    s_cbranch_execz .tk_21
    global_atomic_add v3, v1, v2, s[38:39] sc0
    s_waitcnt vmcnt(0)
    v_mov_b32 v4, 0
    ds_write_b32 v4, v3
    s_waitcnt lgkmcnt(0)
.tk_21:
    s_mov_b64 exec, s[6:7]
    s_barrier
    v_mov_b32 v4, 0
    ds_read_b32 v3, v4
    s_waitcnt lgkmcnt(0)
    v_readfirstlane_b32 s55, v3
    s_barrier
    s_cmp_ge_u32 s55, 32
    s_cbranch_scc1 .nc2_17
    v_mov_b32 v1, 124
    v_mov_b32 v2, 1
    v_cmp_eq_u32 vcc, 0, v0
    s_nop 0
    s_and_saveexec_b64 s[6:7], vcc
    s_cbranch_execz .tk_22
    global_atomic_add v3, v1, v2, s[38:39] sc0
    s_waitcnt vmcnt(0)
    v_mov_b32 v4, 0
    ds_write_b32 v4, v3
    s_waitcnt lgkmcnt(0)
.tk_22:
    s_mov_b64 exec, s[6:7]
    s_barrier
    v_mov_b32 v4, 0
    ds_read_b32 v3, v4
    s_waitcnt lgkmcnt(0)
    v_readfirstlane_b32 s55, v3
    s_barrier
    v_mov_b32 v1, 4
    v_mov_b32 v2, 1
    v_cmp_eq_u32 vcc, 0, v0
    s_nop 0
    s_and_saveexec_b64 s[6:7], vcc
    s_cbranch_execz .tk_23
    global_atomic_add v3, v1, v2, s[38:39] sc0
    s_waitcnt vmcnt(0)
    v_mov_b32 v4, 0
    ds_write_b32 v4, v3
    s_waitcnt lgkmcnt(0)
.tk_23:
    s_mov_b64 exec, s[6:7]
    s_barrier
    v_mov_b32 v4, 0
    ds_read_b32 v3, v4
    s_waitcnt lgkmcnt(0)
    v_readfirstlane_b32 s52, v3
    s_barrier
    s_cmp_lt_u32 s52, 32
    s_cbranch_scc1 .vrole_5
.nc2_17:
    s_cmp_eq_u32 s76, 1
    s_cselect_b32 s76, 2, s76
    s_cmp_lg_u32 s76, 2
    s_cbranch_scc1 .gen_24
    s_mov_b32 s52, s82
    s_cmp_lt_u32 s82, 60
    s_cbranch_scc1 .orole_7
    s_cmp_lt_u32 s82, 92
    s_cbranch_scc1 .attnq_3
.gen_24:
    v_mov_b32 v1, 12
    v_mov_b32 v2, 1
    v_cmp_eq_u32 vcc, 0, v0
    s_nop 0
    s_and_saveexec_b64 s[6:7], vcc
    s_cbranch_execz .tk_25
    global_atomic_add v3, v1, v2, s[38:39] sc0
    s_waitcnt vmcnt(0)
    v_mov_b32 v4, 0
    ds_write_b32 v4, v3
    s_waitcnt lgkmcnt(0)
.tk_25:
    s_mov_b64 exec, s[6:7]
    s_barrier
    v_mov_b32 v4, 0
    ds_read_b32 v3, v4
    s_waitcnt lgkmcnt(0)
    v_readfirstlane_b32 s72, v3
    s_barrier
    s_add_u32 s77, s72, 1
    s_cmp_lt_u32 s72, 34
    s_cbranch_scc1 .tinit_27
    s_sub_u32 s72, s72, 34
    s_cmp_lt_u32 s72, 32
    s_cbranch_scc1 .b1_26
    s_sub_u32 s72, s72, 32
    s_cmp_lt_u32 s72, 64
    s_cbranch_scc1 .task_28
    s_sub_u32 s72, s72, 64
    s_cmp_lt_u32 s72, 320
    s_cbranch_scc1 .task_29
    s_sub_u32 s72, s72, 320
    s_cmp_lt_u32 s72, 133
    s_cbranch_scc1 .task_30
    s_sub_u32 s72, s72, 133
    s_cmp_lt_u32 s72, 80
    s_cbranch_scc1 .task_31
    s_sub_u32 s72, s72, 80
    s_cmp_lt_u32 s72, 0
    s_cbranch_scc1 .task_32
    s_sub_u32 s72, s72, 0
    s_cmp_lt_u32 s72, 81
    s_cbranch_scc1 .task_33
    s_sub_u32 s72, s72, 81
    s_cmp_lt_u32 s72, 80
    s_cbranch_scc1 .task_34
    s_sub_u32 s72, s72, 80
    s_cmp_lt_u32 s72, 0
    s_cbranch_scc1 .task_35
    s_sub_u32 s72, s72, 0
    s_mov_b32 s52, s82
    s_cmp_lt_u32 s82, 60
    s_cbranch_scc1 .orole_7
.attnq_3:
    v_mov_b32 v1, 120
    v_mov_b32 v2, 1
    v_cmp_eq_u32 vcc, 0, v0
    s_nop 0
    s_and_saveexec_b64 s[6:7], vcc
    s_cbranch_execz .tk_36
    global_atomic_add v3, v1, v2, s[38:39] sc0
    s_waitcnt vmcnt(0)
    v_mov_b32 v4, 0
    ds_write_b32 v4, v3
    s_waitcnt lgkmcnt(0)
.tk_36:
    s_mov_b64 exec, s[6:7]
    s_barrier
    v_mov_b32 v4, 0
    ds_read_b32 v3, v4
    s_waitcnt lgkmcnt(0)
    v_readfirstlane_b32 s72, v3
    s_barrier
    s_cmp_lt_u32 s72, 512
    s_cbranch_scc1 .task_35
    s_branch .done_2
.tinit_27:
    s_mov_b32 s44, s40
    s_and_b32 s45, s41, 0xffff
    s_mov_b32 s46, 0xfe00000
    s_mov_b32 s47, 0x00020000
    s_mov_b32 s48, s24
    s_and_b32 s49, s25, 0xffff
    s_mov_b32 s50, 0x2800
    s_mov_b32 s51, 0x00020000
    s_lshl_b32 s73, s72, 3
    s_add_u32 s74, s73, 8
    s_min_u32 s74, s74, 272
.il_38:
    s_lshl_b32 s3, s73, 12
    v_lshlrev_b32 v1, 4, v0
    v_add_u32 v1, s3, v1
    v_and_b32 v2, 0xffff, v1
    v_bfe_u32 v3, v2, 4, 3
    v_mul_u32_u24 v3, 1280, v3
    v_lshrrev_b32 v8, 10, v2
    v_lshl_add_u32 v3, v8, 7, v3
    v_bfe_u32 v8, v2, 7, 3
    v_lshl_add_u32 v3, v8, 4, v3
    buffer_load_dwordx4 v[4:7], v3, s[48:51], 0 offen
    s_movk_i32 s54, 10240
    v_cmp_gt_u32 s[52:53], s54, v2
    s_mov_b32 s54, 131072
    v_cmp_gt_u32 vcc, s54, v1
    s_nop 0
    s_and_b64 vcc, vcc, s[52:53]
    s_waitcnt vmcnt(0)
    v_min_u32 v4, 0xfffffffe, v4
    v_cndmask_b32 v4, -1, v4, vcc
    v_min_u32 v5, 0xfffffffe, v5
    v_cndmask_b32 v5, -1, v5, vcc
    v_min_u32 v6, 0xfffffffe, v6
    v_cndmask_b32 v6, -1, v6, vcc
    v_min_u32 v7, 0xfffffffe, v7
    v_cndmask_b32 v7, -1, v7, vcc
    s_mov_b32 s54, 0x5a00000
    buffer_store_dwordx4 v[4:7], v1, s[44:47], s54 offen sc1
    s_add_u32 s73, s73, 1
    s_cmp_lt_u32 s73, s74
    s_cbranch_scc1 .il_38
    s_mov_b32 s75, 116
    s_waitcnt vmcnt(0)
    s_barrier
    v_mov_b32 v1, s75
    v_mov_b32 v2, 1
    v_cmp_eq_u32 vcc, 0, v0
    s_nop 0
    s_and_saveexec_b64 s[6:7], vcc
    s_cbranch_execz .sg_39
    global_atomic_add v1, v2, s[38:39]
.sg_39:
    s_mov_b64 exec, s[6:7]
    s_branch .work_8
.task_28:
    s_and_b32 s73, s72, 31
    s_add_u32 s73, s73, 16
    s_lshr_b32 s75, s72, 5
    s_lshl_b32 s74, s75, 7
    s_mov_b32 s75, 32
    s_lshr_b32 s58, s73, 4
    s_and_b32 s56, s73, 15
    s_cmp_eq_u32 s58, 1
    s_cselect_b32 s44, s28, s26
    s_cselect_b32 s45, s29, s27
    s_cmp_eq_u32 s58, 2
    s_cselect_b32 s44, s30, s44
    s_cselect_b32 s45, s31, s45
    s_and_b32 s45, s45, 0xffff
    s_mov_b32 s46, 0x500000
    s_mov_b32 s47, 0x00020000
    s_mov_b32 s48, s22
    s_and_b32 s49, s23, 0xffff
    s_mov_b32 s50, 0x280000
    s_mov_b32 s51, 0x00020000
    s_mov_b32 s52, s40
    s_and_b32 s53, s41, 0xffff
    s_mov_b32 s54, 0xfe00000
    s_mov_b32 s55, 0x00020000
    s_lshl_b32 s66, s56, 9
    s_mul_i32 s67, s74, 1280
    s_lshl_b32 s68, s58, 24
    s_lshl_b32 s59, s74, 13
    s_add_u32 s68, s68, s59
    s_add_u32 s68, s68, s66
    v_and_b32 v8, 63, v0
    v_lshrrev_b32 v9, 6, v0
    s_nop 0
    v_readfirstlane_b32 s63, v9
    v_mov_b32 v11, 256
    v_mad_u32_u24 v10, v9, v11, v8
    v_lshrrev_b32 v11, 5, v10
    v_and_b32 v10, 31, v10
    v_and_b32 v12, 3, v11
    v_lshlrev_b32 v12, 2, v12
    v_xor_b32 v10, v10, v12
    s_mov_b32 s64, 8192
    v_mul_lo_u32 v11, v11, s64
    v_lshl_add_u32 v13, v10, 4, v11
    v_mov_b32 v11, 256
    v_mad_u32_u24 v10, v9, v11, v8
    v_add_u32 v10, 64, v10
    v_lshrrev_b32 v11, 5, v10
    v_and_b32 v10, 31, v10
    v_and_b32 v12, 3, v11
    v_lshlrev_b32 v12, 2, v12
    v_xor_b32 v10, v10, v12
    s_mov_b32 s64, 8192
    v_mul_lo_u32 v11, v11, s64
    v_lshl_add_u32 v14, v10, 4, v11
    v_mov_b32 v11, 256
    v_mad_u32_u24 v10, v9, v11, v8
    v_add_u32 v10, 128, v10
    v_lshrrev_b32 v11, 5, v10
    v_and_b32 v10, 31, v10
    v_and_b32 v12, 3, v11
    v_lshlrev_b32 v12, 2, v12
    v_xor_b32 v10, v10, v12
    s_mov_b32 s64, 8192
    v_mul_lo_u32 v11, v11, s64
    v_lshl_add_u32 v15, v10, 4, v11
    v_mov_b32 v11, 256
    v_mad_u32_u24 v10, v9, v11, v8
    v_add_u32 v10, 192, v10
    v_lshrrev_b32 v11, 5, v10
    v_and_b32 v10, 31, v10
    v_and_b32 v12, 3, v11
    v_lshlrev_b32 v12, 2, v12
    v_xor_b32 v10, v10, v12
    s_mov_b32 s64, 8192
    v_mul_lo_u32 v11, v11, s64
    v_lshl_add_u32 v16, v10, 4, v11
    v_lshrrev_b32 v10, 2, v8
    v_mov_b32 v11, 32
    v_mad_u32_u24 v10, v9, v11, v10
    s_mov_b32 s64, 1280
    v_mul_lo_u32 v10, v10, s64
    v_lshrrev_b32 v11, 4, v8
    v_xor_b32 v11, v11, v8
    v_and_b32 v11, 3, v11
    v_lshl_add_u32 v17, v11, 4, v10
    v_lshrrev_b32 v10, 2, v8
    v_mov_b32 v11, 32
    v_mad_u32_u24 v10, v9, v11, v10
    v_add_u32 v10, 16, v10
    s_mov_b32 s64, 1280
    v_mul_lo_u32 v10, v10, s64
    v_lshrrev_b32 v11, 4, v8
    v_xor_b32 v11, v11, v8
    v_and_b32 v11, 3, v11
    v_lshl_add_u32 v18, v11, 4, v10
    v_lshrrev_b32 v12, 1, v9
    v_bfe_u32 v10, v8, 2, 2
    v_mov_b32 v11, 4
    v_mad_u32_u24 v11, v12, v11, 0
    v_xor_b32 v11, v11, v10
    v_lshlrev_b32 v11, 6, v11
    v_lshrrev_b32 v19, 5, v8
    v_lshl_add_u32 v10, v19, 3, v10
    v_mov_b32 v19, 512
    v_mad_u32_u24 v11, v10, v19, v11
    v_bfe_u32 v10, v8, 4, 1
    v_lshl_add_u32 v11, v10, 5, v11
    v_and_b32 v10, 3, v8
    v_lshl_add_u32 v11, v10, 3, v11
    v_add_u32 v19, 0, v11
    v_bfe_u32 v10, v8, 2, 2
    v_mov_b32 v11, 4
    v_mad_u32_u24 v11, v12, v11, 1
    v_xor_b32 v11, v11, v10
    v_lshlrev_b32 v11, 6, v11
    v_lshrrev_b32 v20, 5, v8
    v_lshl_add_u32 v10, v20, 3, v10
    v_mov_b32 v20, 512
    v_mad_u32_u24 v11, v10, v20, v11
    v_bfe_u32 v10, v8, 4, 1
    v_lshl_add_u32 v11, v10, 5, v11
    v_and_b32 v10, 3, v8
    v_lshl_add_u32 v11, v10, 3, v11
    v_add_u32 v20, 0, v11
    v_bfe_u32 v10, v8, 2, 2
    v_mov_b32 v11, 4
    v_mad_u32_u24 v11, v12, v11, 2
    v_xor_b32 v11, v11, v10
    v_lshlrev_b32 v11, 6, v11
    v_lshrrev_b32 v21, 5, v8
    v_lshl_add_u32 v10, v21, 3, v10
    v_mov_b32 v21, 512
    v_mad_u32_u24 v11, v10, v21, v11
    v_bfe_u32 v10, v8, 4, 1
    v_lshl_add_u32 v11, v10, 5, v11
    v_and_b32 v10, 3, v8
    v_lshl_add_u32 v11, v10, 3, v11
    v_add_u32 v21, 0, v11
    v_bfe_u32 v10, v8, 2, 2
    v_mov_b32 v11, 4
    v_mad_u32_u24 v11, v12, v11, 3
    v_xor_b32 v11, v11, v10
    v_lshlrev_b32 v11, 6, v11
    v_lshrrev_b32 v22, 5, v8
    v_lshl_add_u32 v10, v22, 3, v10
    v_mov_b32 v22, 512
    v_mad_u32_u24 v11, v10, v22, v11
    v_bfe_u32 v10, v8, 4, 1
    v_lshl_add_u32 v11, v10, 5, v11
    v_and_b32 v10, 3, v8
    v_lshl_add_u32 v11, v10, 3, v11
    v_add_u32 v22, 0, v11
    v_and_b32 v12, 1, v9
    v_and_b32 v10, 31, v8
    v_lshrrev_b32 v11, 5, v8
    v_bfe_u32 v23, v8, 2, 2
    v_xor_b32 v11, v11, v23
    v_lshlrev_b32 v11, 4, v11
    v_lshl_add_u32 v10, v10, 6, v11
    v_mov_b32 v11, 4096
    v_mad_u32_u24 v10, v12, v11, v10
    v_add_u32 v23, 16384, v10
    v_and_b32 v10, 31, v8
    v_lshrrev_b32 v11, 5, v8
    v_add_u32 v11, 2, v11
    v_bfe_u32 v24, v8, 2, 2
    v_xor_b32 v11, v11, v24
    v_lshlrev_b32 v11, 4, v11
    v_lshl_add_u32 v10, v10, 6, v11
    v_mov_b32 v11, 4096
    v_mad_u32_u24 v10, v12, v11, v10
    v_add_u32 v24, 16384, v10
    s_mul_i32 s61, s63, 4096
    s_mov_b32 s60, 0
    s_mul_i32 s64, s63, -2048
    s_add_u32 s64, s64, s61
    s_add_u32 s64, s64, 16384
    s_add_u32 m0, s61, 0
    s_nop 0
    buffer_load_dwordx4 v13, s[44:47], s66 offen lds
    s_add_u32 m0, s61, 1024
    s_nop 0
    buffer_load_dwordx4 v14, s[44:47], s66 offen lds
    s_add_u32 m0, s61, 2048
    s_nop 0
    buffer_load_dwordx4 v15, s[44:47], s66 offen lds
    s_add_u32 m0, s61, 3072
    s_nop 0
    buffer_load_dwordx4 v16, s[44:47], s66 offen lds
    s_add_u32 m0, s64, 0
    s_nop 0
    buffer_load_dwordx4 v17, s[48:51], s67 offen lds
    s_add_u32 m0, s64, 1024
    s_nop 0
    buffer_load_dwordx4 v18, s[48:51], s67 offen lds
    s_add_u32 s66, s66, 262144
    s_add_u32 s67, s67, 64
    s_add_u32 s61, s61, 24576
    s_cmp_ge_u32 s61, 98304
    s_cselect_b32 s65, 98304, 0
    s_sub_u32 s61, s61, s65
    s_mul_i32 s64, s63, -2048
    s_add_u32 s64, s64, s61
    s_add_u32 s64, s64, 16384
    s_add_u32 m0, s61, 0
    s_nop 0
    buffer_load_dwordx4 v13, s[44:47], s66 offen lds
    s_add_u32 m0, s61, 1024
    s_nop 0
    buffer_load_dwordx4 v14, s[44:47], s66 offen lds
    s_add_u32 m0, s61, 2048
    s_nop 0
    buffer_load_dwordx4 v15, s[44:47], s66 offen lds
    s_add_u32 m0, s61, 3072
    s_nop 0
    buffer_load_dwordx4 v16, s[44:47], s66 offen lds
    s_add_u32 m0, s64, 0
    s_nop 0
    buffer_load_dwordx4 v17, s[48:51], s67 offen lds
    s_add_u32 m0, s64, 1024
    s_nop 0
    buffer_load_dwordx4 v18, s[48:51], s67 offen lds
    s_add_u32 s66, s66, 262144
    s_add_u32 s67, s67, 64
    s_add_u32 s61, s61, 24576
    s_cmp_ge_u32 s61, 98304
    s_cselect_b32 s65, 98304, 0
    s_sub_u32 s61, s61, s65
    s_mul_i32 s64, s63, -2048
    s_add_u32 s64, s64, s61
    s_add_u32 s64, s64, 16384
    s_add_u32 m0, s61, 0
    s_nop 0
    buffer_load_dwordx4 v13, s[44:47], s66 offen lds
    s_add_u32 m0, s61, 1024
    s_nop 0
    buffer_load_dwordx4 v14, s[44:47], s66 offen lds
    s_add_u32 m0, s61, 2048
    s_nop 0
    buffer_load_dwordx4 v15, s[44:47], s66 offen lds
    s_add_u32 m0, s61, 3072
    s_nop 0
    buffer_load_dwordx4 v16, s[44:47], s66 offen lds
    s_add_u32 m0, s64, 0
    s_nop 0
    buffer_load_dwordx4 v17, s[48:51], s67 offen lds
    s_add_u32 m0, s64, 1024
    s_nop 0
    buffer_load_dwordx4 v18, s[48:51], s67 offen lds
    s_add_u32 s66, s66, 262144
    s_add_u32 s67, s67, 64
    s_add_u32 s61, s61, 24576
    s_cmp_ge_u32 s61, 98304
    s_cselect_b32 s65, 98304, 0
    s_sub_u32 s61, s61, s65
    v_add_u32 v25, s60, v19
    v_add_u32 v26, s60, v20
    v_add_u32 v27, s60, v21
    v_add_u32 v28, s60, v22
    v_add_u32 v29, s60, v23
    v_add_u32 v30, s60, v24
    s_add_u32 s60, s60, 24576
    s_cmp_ge_u32 s60, 98304
    s_cselect_b32 s60, 0, s60
    s_waitcnt vmcnt(12)
    s_barrier
    ds_read_b64_tr_b16 v[32:33], v25 offset:0
    ds_read_b64_tr_b16 v[34:35], v25 offset:2048
    ds_read_b64_tr_b16 v[36:37], v26 offset:0
    ds_read_b64_tr_b16 v[38:39], v26 offset:2048
    ds_read_b64_tr_b16 v[40:41], v27 offset:0
    ds_read_b64_tr_b16 v[42:43], v27 offset:2048
    ds_read_b64_tr_b16 v[44:45], v28 offset:0
    ds_read_b64_tr_b16 v[46:47], v28 offset:2048
    ds_read_b128 v[64:67], v29 offset:0
    ds_read_b128 v[68:71], v29 offset:2048
    s_waitcnt lgkmcnt(0)
    v_mfma_f32_32x32x16_bf16 a[0:15], v[32:35], v[64:67], 0
    ds_read_b64_tr_b16 v[48:49], v25 offset:8192
    ds_read_b64_tr_b16 v[50:51], v25 offset:10240
    v_mfma_f32_32x32x16_bf16 a[16:31], v[32:35], v[68:71], 0
    ds_read_b64_tr_b16 v[52:53], v26 offset:8192
    ds_read_b64_tr_b16 v[54:55], v26 offset:10240
    v_mfma_f32_32x32x16_bf16 a[32:47], v[36:39], v[64:67], 0
    ds_read_b64_tr_b16 v[56:57], v27 offset:8192
    ds_read_b64_tr_b16 v[58:59], v27 offset:10240
    v_mfma_f32_32x32x16_bf16 a[48:63], v[36:39], v[68:71], 0
    ds_read_b64_tr_b16 v[60:61], v28 offset:8192
    ds_read_b64_tr_b16 v[62:63], v28 offset:10240
    v_mfma_f32_32x32x16_bf16 a[64:79], v[40:43], v[64:67], 0
    ds_read_b128 v[72:75], v30 offset:0
    ds_read_b128 v[76:79], v30 offset:2048
    v_mfma_f32_32x32x16_bf16 a[80:95], v[40:43], v[68:71], 0
    v_mfma_f32_32x32x16_bf16 a[96:111], v[44:47], v[64:67], 0
    v_mfma_f32_32x32x16_bf16 a[112:127], v[44:47], v[68:71], 0
    s_waitcnt vmcnt(6)
    s_barrier
    v_add_u32 v25, s60, v19
    v_add_u32 v26, s60, v20
    v_add_u32 v27, s60, v21
    v_add_u32 v28, s60, v22
    v_add_u32 v29, s60, v23
    v_add_u32 v30, s60, v24
    s_add_u32 s60, s60, 24576
    s_cmp_ge_u32 s60, 98304
    s_cselect_b32 s60, 0, s60
    s_mul_i32 s64, s63, -2048
    s_add_u32 s64, s64, s61
    s_add_u32 s64, s64, 16384
    s_waitcnt lgkmcnt(0)
    v_mfma_f32_32x32x16_bf16 a[0:15], v[48:51], v[72:75], a[0:15]
    ds_read_b64_tr_b16 v[32:33], v25 offset:0
    ds_read_b64_tr_b16 v[34:35], v25 offset:2048
    v_mfma_f32_32x32x16_bf16 a[16:31], v[48:51], v[76:79], a[16:31]
    ds_read_b64_tr_b16 v[36:37], v26 offset:0
    ds_read_b64_tr_b16 v[38:39], v26 offset:2048
    v_mfma_f32_32x32x16_bf16 a[32:47], v[52:55], v[72:75], a[32:47]
    ds_read_b64_tr_b16 v[40:41], v27 offset:0
    ds_read_b64_tr_b16 v[42:43], v27 offset:2048
    v_mfma_f32_32x32x16_bf16 a[48:63], v[52:55], v[76:79], a[48:63]
    ds_read_b64_tr_b16 v[44:45], v28 offset:0
    ds_read_b64_tr_b16 v[46:47], v28 offset:2048
    v_mfma_f32_32x32x16_bf16 a[64:79], v[56:59], v[72:75], a[64:79]
    ds_read_b128 v[64:67], v29 offset:0
    ds_read_b128 v[68:71], v29 offset:2048
    v_mfma_f32_32x32x16_bf16 a[80:95], v[56:59], v[76:79], a[80:95]
    s_add_u32 m0, s61, 0
    s_nop 0
    buffer_load_dwordx4 v13, s[44:47], s66 offen lds
    s_add_u32 m0, s61, 1024
    s_nop 0
    buffer_load_dwordx4 v14, s[44:47], s66 offen lds
    v_mfma_f32_32x32x16_bf16 a[96:111], v[60:63], v[72:75], a[96:111]
    s_add_u32 m0, s61, 2048
    s_nop 0
    buffer_load_dwordx4 v15, s[44:47], s66 offen lds
    s_add_u32 m0, s61, 3072
    s_nop 0
    buffer_load_dwordx4 v16, s[44:47], s66 offen lds
    v_mfma_f32_32x32x16_bf16 a[112:127], v[60:63], v[76:79], a[112:127]
    s_add_u32 m0, s64, 0
    s_nop 0
    buffer_load_dwordx4 v17, s[48:51], s67 offen lds
    s_add_u32 m0, s64, 1024
    s_nop 0
    buffer_load_dwordx4 v18, s[48:51], s67 offen lds
    s_add_u32 s66, s66, 262144
    s_add_u32 s67, s67, 64
    s_add_u32 s61, s61, 24576
    s_cmp_ge_u32 s61, 98304
    s_cselect_b32 s65, 98304, 0
    s_sub_u32 s61, s61, s65
    s_mov_b32 s62, 16
.gl_40:
    s_waitcnt lgkmcnt(0)
    v_mfma_f32_32x32x16_bf16 a[0:15], v[32:35], v[64:67], a[0:15]
    ds_read_b64_tr_b16 v[48:49], v25 offset:8192
    ds_read_b64_tr_b16 v[50:51], v25 offset:10240
    v_mfma_f32_32x32x16_bf16 a[16:31], v[32:35], v[68:71], a[16:31]
    ds_read_b64_tr_b16 v[52:53], v26 offset:8192
    ds_read_b64_tr_b16 v[54:55], v26 offset:10240
    v_mfma_f32_32x32x16_bf16 a[32:47], v[36:39], v[64:67], a[32:47]
    ds_read_b64_tr_b16 v[56:57], v27 offset:8192
    ds_read_b64_tr_b16 v[58:59], v27 offset:10240
    v_mfma_f32_32x32x16_bf16 a[48:63], v[36:39], v[68:71], a[48:63]
    ds_read_b64_tr_b16 v[60:61], v28 offset:8192
    ds_read_b64_tr_b16 v[62:63], v28 offset:10240
    v_mfma_f32_32x32x16_bf16 a[64:79], v[40:43], v[64:67], a[64:79]
    ds_read_b128 v[72:75], v30 offset:0
    ds_read_b128 v[76:79], v30 offset:2048
    v_mfma_f32_32x32x16_bf16 a[80:95], v[40:43], v[68:71], a[80:95]
    v_mfma_f32_32x32x16_bf16 a[96:111], v[44:47], v[64:67], a[96:111]
    v_mfma_f32_32x32x16_bf16 a[112:127], v[44:47], v[68:71], a[112:127]
    s_waitcnt vmcnt(6)
    s_barrier
    v_add_u32 v25, s60, v19
    v_add_u32 v26, s60, v20
    v_add_u32 v27, s60, v21
    v_add_u32 v28, s60, v22
    v_add_u32 v29, s60, v23
    v_add_u32 v30, s60, v24
    s_add_u32 s60, s60, 24576
    s_cmp_ge_u32 s60, 98304
    s_cselect_b32 s60, 0, s60
    s_mul_i32 s64, s63, -2048
    s_add_u32 s64, s64, s61
    s_add_u32 s64, s64, 16384
    s_waitcnt lgkmcnt(0)
    v_mfma_f32_32x32x16_bf16 a[0:15], v[48:51], v[72:75], a[0:15]
    ds_read_b64_tr_b16 v[32:33], v25 offset:0
    ds_read_b64_tr_b16 v[34:35], v25 offset:2048
    v_mfma_f32_32x32x16_bf16 a[16:31], v[48:51], v[76:79], a[16:31]
    ds_read_b64_tr_b16 v[36:37], v26 offset:0
    ds_read_b64_tr_b16 v[38:39], v26 offset:2048
    v_mfma_f32_32x32x16_bf16 a[32:47], v[52:55], v[72:75], a[32:47]
    ds_read_b64_tr_b16 v[40:41], v27 offset:0
    ds_read_b64_tr_b16 v[42:43], v27 offset:2048
    v_mfma_f32_32x32x16_bf16 a[48:63], v[52:55], v[76:79], a[48:63]
    ds_read_b64_tr_b16 v[44:45], v28 offset:0
    ds_read_b64_tr_b16 v[46:47], v28 offset:2048
    v_mfma_f32_32x32x16_bf16 a[64:79], v[56:59], v[72:75], a[64:79]
    ds_read_b128 v[64:67], v29 offset:0
    ds_read_b128 v[68:71], v29 offset:2048
    v_mfma_f32_32x32x16_bf16 a[80:95], v[56:59], v[76:79], a[80:95]
    s_add_u32 m0, s61, 0
    s_nop 0
    buffer_load_dwordx4 v13, s[44:47], s66 offen lds
    s_add_u32 m0, s61, 1024
    s_nop 0
    buffer_load_dwordx4 v14, s[44:47], s66 offen lds
    v_mfma_f32_32x32x16_bf16 a[96:111], v[60:63], v[72:75], a[96:111]
    s_add_u32 m0, s61, 2048
    s_nop 0
    buffer_load_dwordx4 v15, s[44:47], s66 offen lds
    s_add_u32 m0, s61, 3072
    s_nop 0
    buffer_load_dwordx4 v16, s[44:47], s66 offen lds
    v_mfma_f32_32x32x16_bf16 a[112:127], v[60:63], v[76:79], a[112:127]
    s_add_u32 m0, s64, 0
    s_nop 0
    buffer_load_dwordx4 v17, s[48:51], s67 offen lds
    s_add_u32 m0, s64, 1024
    s_nop 0
    buffer_load_dwordx4 v18, s[48:51], s67 offen lds
    s_add_u32 s66, s66, 262144
    s_add_u32 s67, s67, 64
    s_add_u32 s61, s61, 24576
    s_cmp_ge_u32 s61, 98304
    s_cselect_b32 s65, 98304, 0
    s_sub_u32 s61, s61, s65
    s_sub_u32 s62, s62, 1
    s_cmp_lg_u32 s62, 0
    s_cbranch_scc1 .gl_40
    s_waitcnt lgkmcnt(0)
    v_mfma_f32_32x32x16_bf16 a[0:15], v[32:35], v[64:67], a[0:15]
    ds_read_b64_tr_b16 v[48:49], v25 offset:8192
    ds_read_b64_tr_b16 v[50:51], v25 offset:10240
    v_mfma_f32_32x32x16_bf16 a[16:31], v[32:35], v[68:71], a[16:31]
    ds_read_b64_tr_b16 v[52:53], v26 offset:8192
    ds_read_b64_tr_b16 v[54:55], v26 offset:10240
    v_mfma_f32_32x32x16_bf16 a[32:47], v[36:39], v[64:67], a[32:47]
    ds_read_b64_tr_b16 v[56:57], v27 offset:8192
    ds_read_b64_tr_b16 v[58:59], v27 offset:10240
    v_mfma_f32_32x32x16_bf16 a[48:63], v[36:39], v[68:71], a[48:63]
    ds_read_b64_tr_b16 v[60:61], v28 offset:8192
    ds_read_b64_tr_b16 v[62:63], v28 offset:10240
    v_mfma_f32_32x32x16_bf16 a[64:79], v[40:43], v[64:67], a[64:79]
    ds_read_b128 v[72:75], v30 offset:0
    ds_read_b128 v[76:79], v30 offset:2048
    v_mfma_f32_32x32x16_bf16 a[80:95], v[40:43], v[68:71], a[80:95]
    v_mfma_f32_32x32x16_bf16 a[96:111], v[44:47], v[64:67], a[96:111]
    v_mfma_f32_32x32x16_bf16 a[112:127], v[44:47], v[68:71], a[112:127]
    s_waitcnt vmcnt(6)
    s_barrier
    v_add_u32 v25, s60, v19
    v_add_u32 v26, s60, v20
    v_add_u32 v27, s60, v21
    v_add_u32 v28, s60, v22
    v_add_u32 v29, s60, v23
    v_add_u32 v30, s60, v24
    s_add_u32 s60, s60, 24576
    s_cmp_ge_u32 s60, 98304
    s_cselect_b32 s60, 0, s60
    s_waitcnt lgkmcnt(0)
    v_mfma_f32_32x32x16_bf16 a[0:15], v[48:51], v[72:75], a[0:15]
    ds_read_b64_tr_b16 v[32:33], v25 offset:0
    ds_read_b64_tr_b16 v[34:35], v25 offset:2048
    v_mfma_f32_32x32x16_bf16 a[16:31], v[48:51], v[76:79], a[16:31]
    ds_read_b64_tr_b16 v[36:37], v26 offset:0
    ds_read_b64_tr_b16 v[38:39], v26 offset:2048
    v_mfma_f32_32x32x16_bf16 a[32:47], v[52:55], v[72:75], a[32:47]
    ds_read_b64_tr_b16 v[40:41], v27 offset:0
    ds_read_b64_tr_b16 v[42:43], v27 offset:2048
    v_mfma_f32_32x32x16_bf16 a[48:63], v[52:55], v[76:79], a[48:63]
    ds_read_b64_tr_b16 v[44:45], v28 offset:0
    ds_read_b64_tr_b16 v[46:47], v28 offset:2048
    v_mfma_f32_32x32x16_bf16 a[64:79], v[56:59], v[72:75], a[64:79]
    ds_read_b128 v[64:67], v29 offset:0
    ds_read_b128 v[68:71], v29 offset:2048
    v_mfma_f32_32x32x16_bf16 a[80:95], v[56:59], v[76:79], a[80:95]
    v_mfma_f32_32x32x16_bf16 a[96:111], v[60:63], v[72:75], a[96:111]
    v_mfma_f32_32x32x16_bf16 a[112:127], v[60:63], v[76:79], a[112:127]
    s_waitcnt lgkmcnt(0)
    v_mfma_f32_32x32x16_bf16 a[0:15], v[32:35], v[64:67], a[0:15]
    ds_read_b64_tr_b16 v[48:49], v25 offset:8192
    ds_read_b64_tr_b16 v[50:51], v25 offset:10240
    v_mfma_f32_32x32x16_bf16 a[16:31], v[32:35], v[68:71], a[16:31]
    ds_read_b64_tr_b16 v[52:53], v26 offset:8192
    ds_read_b64_tr_b16 v[54:55], v26 offset:10240
    v_mfma_f32_32x32x16_bf16 a[32:47], v[36:39], v[64:67], a[32:47]
    ds_read_b64_tr_b16 v[56:57], v27 offset:8192
    ds_read_b64_tr_b16 v[58:59], v27 offset:10240
    v_mfma_f32_32x32x16_bf16 a[48:63], v[36:39], v[68:71], a[48:63]
    ds_read_b64_tr_b16 v[60:61], v28 offset:8192
    ds_read_b64_tr_b16 v[62:63], v28 offset:10240
    v_mfma_f32_32x32x16_bf16 a[64:79], v[40:43], v[64:67], a[64:79]
    ds_read_b128 v[72:75], v30 offset:0
    ds_read_b128 v[76:79], v30 offset:2048
    v_mfma_f32_32x32x16_bf16 a[80:95], v[40:43], v[68:71], a[80:95]
    v_mfma_f32_32x32x16_bf16 a[96:111], v[44:47], v[64:67], a[96:111]
    v_mfma_f32_32x32x16_bf16 a[112:127], v[44:47], v[68:71], a[112:127]
    s_waitcnt vmcnt(0)
    s_barrier
    v_add_u32 v25, s60, v19
    v_add_u32 v26, s60, v20
    v_add_u32 v27, s60, v21
    v_add_u32 v28, s60, v22
    v_add_u32 v29, s60, v23
    v_add_u32 v30, s60, v24
    s_add_u32 s60, s60, 24576
    s_cmp_ge_u32 s60, 98304
    s_cselect_b32 s60, 0, s60
    s_waitcnt lgkmcnt(0)
    v_mfma_f32_32x32x16_bf16 a[0:15], v[48:51], v[72:75], a[0:15]
    ds_read_b64_tr_b16 v[32:33], v25 offset:0
    ds_read_b64_tr_b16 v[34:35], v25 offset:2048
    v_mfma_f32_32x32x16_bf16 a[16:31], v[48:51], v[76:79], a[16:31]
    ds_read_b64_tr_b16 v[36:37], v26 offset:0
    ds_read_b64_tr_b16 v[38:39], v26 offset:2048
    v_mfma_f32_32x32x16_bf16 a[32:47], v[52:55], v[72:75], a[32:47]
    ds_read_b64_tr_b16 v[40:41], v27 offset:0
    ds_read_b64_tr_b16 v[42:43], v27 offset:2048
    v_mfma_f32_32x32x16_bf16 a[48:63], v[52:55], v[76:79], a[48:63]
    ds_read_b64_tr_b16 v[44:45], v28 offset:0
    ds_read_b64_tr_b16 v[46:47], v28 offset:2048
    v_mfma_f32_32x32x16_bf16 a[64:79], v[56:59], v[72:75], a[64:79]
    ds_read_b128 v[64:67], v29 offset:0
    ds_read_b128 v[68:71], v29 offset:2048
    v_mfma_f32_32x32x16_bf16 a[80:95], v[56:59], v[76:79], a[80:95]
    v_mfma_f32_32x32x16_bf16 a[96:111], v[60:63], v[72:75], a[96:111]
    v_mfma_f32_32x32x16_bf16 a[112:127], v[60:63], v[76:79], a[112:127]
    s_waitcnt lgkmcnt(0)
    v_mfma_f32_32x32x16_bf16 a[0:15], v[32:35], v[64:67], a[0:15]
    ds_read_b64_tr_b16 v[48:49], v25 offset:8192
    ds_read_b64_tr_b16 v[50:51], v25 offset:10240
    v_mfma_f32_32x32x16_bf16 a[16:31], v[32:35], v[68:71], a[16:31]
    ds_read_b64_tr_b16 v[52:53], v26 offset:8192
    ds_read_b64_tr_b16 v[54:55], v26 offset:10240
    v_mfma_f32_32x32x16_bf16 a[32:47], v[36:39], v[64:67], a[32:47]
    ds_read_b64_tr_b16 v[56:57], v27 offset:8192
    ds_read_b64_tr_b16 v[58:59], v27 offset:10240
    v_mfma_f32_32x32x16_bf16 a[48:63], v[36:39], v[68:71], a[48:63]
    ds_read_b64_tr_b16 v[60:61], v28 offset:8192
    ds_read_b64_tr_b16 v[62:63], v28 offset:10240
    v_mfma_f32_32x32x16_bf16 a[64:79], v[40:43], v[64:67], a[64:79]
    ds_read_b128 v[72:75], v30 offset:0
    ds_read_b128 v[76:79], v30 offset:2048
    v_mfma_f32_32x32x16_bf16 a[80:95], v[40:43], v[68:71], a[80:95]
    v_mfma_f32_32x32x16_bf16 a[96:111], v[44:47], v[64:67], a[96:111]
    v_mfma_f32_32x32x16_bf16 a[112:127], v[44:47], v[68:71], a[112:127]
    s_waitcnt lgkmcnt(0)
    v_mfma_f32_32x32x16_bf16 a[0:15], v[48:51], v[72:75], a[0:15]
    v_mfma_f32_32x32x16_bf16 a[16:31], v[48:51], v[76:79], a[16:31]
    v_mfma_f32_32x32x16_bf16 a[32:47], v[52:55], v[72:75], a[32:47]
    v_mfma_f32_32x32x16_bf16 a[48:63], v[52:55], v[76:79], a[48:63]
    v_mfma_f32_32x32x16_bf16 a[64:79], v[56:59], v[72:75], a[64:79]
    v_mfma_f32_32x32x16_bf16 a[80:95], v[56:59], v[76:79], a[80:95]
    v_mfma_f32_32x32x16_bf16 a[96:111], v[60:63], v[72:75], a[96:111]
    v_mfma_f32_32x32x16_bf16 a[112:127], v[60:63], v[76:79], a[112:127]
    s_barrier
    s_mul_i32 s64, s63, 17408
    v_and_b32 v10, 31, v8
    v_mul_u32_u24 v10, 272, v10
    v_lshrrev_b32 v11, 5, v8
    v_lshl_add_u32 v10, v11, 4, v10
    v_add_u32 v13, s64, v10
    v_lshrrev_b32 v10, 4, v8
    v_mul_u32_u24 v10, 272, v10
    v_and_b32 v11, 15, v8
    v_lshl_add_u32 v10, v11, 4, v10
    v_add_u32 v14, s64, v10
    v_accvgpr_read_b32 v32, a0
    v_accvgpr_read_b32 v33, a1
    v_accvgpr_read_b32 v34, a2
    v_accvgpr_read_b32 v35, a3
    v_accvgpr_read_b32 v36, a4
    v_accvgpr_read_b32 v37, a5
    v_accvgpr_read_b32 v38, a6
    v_accvgpr_read_b32 v39, a7
    v_accvgpr_read_b32 v40, a8
    v_accvgpr_read_b32 v41, a9
    v_accvgpr_read_b32 v42, a10
    v_accvgpr_read_b32 v43, a11
    v_accvgpr_read_b32 v44, a12
    v_accvgpr_read_b32 v45, a13
    v_accvgpr_read_b32 v46, a14
    v_accvgpr_read_b32 v47, a15
    v_cvt_pk_bf16_f32 v48, v32, v33
    v_cvt_pk_bf16_f32 v49, v34, v35
    v_cvt_pk_bf16_f32 v50, v36, v37
    v_cvt_pk_bf16_f32 v51, v38, v39
    v_cvt_pk_bf16_f32 v52, v40, v41
    v_cvt_pk_bf16_f32 v53, v42, v43
    v_cvt_pk_bf16_f32 v54, v44, v45
    v_cvt_pk_bf16_f32 v55, v46, v47
    v_permlane32_swap_b32 v48, v50
    v_permlane32_swap_b32 v49, v51
    v_permlane32_swap_b32 v52, v54
    v_permlane32_swap_b32 v53, v55
    ds_write_b128 v13, v[48:51] offset:0
    ds_write_b128 v13, v[52:55] offset:32
    v_accvgpr_read_b32 v56, a16
    v_accvgpr_read_b32 v57, a17
    v_accvgpr_read_b32 v58, a18
    v_accvgpr_read_b32 v59, a19
    v_accvgpr_read_b32 v60, a20
    v_accvgpr_read_b32 v61, a21
    v_accvgpr_read_b32 v62, a22
    v_accvgpr_read_b32 v63, a23
    v_accvgpr_read_b32 v64, a24
    v_accvgpr_read_b32 v65, a25
    v_accvgpr_read_b32 v66, a26
    v_accvgpr_read_b32 v67, a27
    v_accvgpr_read_b32 v68, a28
    v_accvgpr_read_b32 v69, a29
    v_accvgpr_read_b32 v70, a30
    v_accvgpr_read_b32 v71, a31
    v_cvt_pk_bf16_f32 v72, v56, v57
    v_cvt_pk_bf16_f32 v73, v58, v59
    v_cvt_pk_bf16_f32 v74, v60, v61
    v_cvt_pk_bf16_f32 v75, v62, v63
    v_cvt_pk_bf16_f32 v76, v64, v65
    v_cvt_pk_bf16_f32 v77, v66, v67
    v_cvt_pk_bf16_f32 v78, v68, v69
    v_cvt_pk_bf16_f32 v79, v70, v71
    v_permlane32_swap_b32 v72, v74
    v_permlane32_swap_b32 v73, v75
    v_permlane32_swap_b32 v76, v78
    v_permlane32_swap_b32 v77, v79
    ds_write_b128 v13, v[72:75] offset:8704
    ds_write_b128 v13, v[76:79] offset:8736
    v_accvgpr_read_b32 v32, a32
    v_accvgpr_read_b32 v33, a33
    v_accvgpr_read_b32 v34, a34
    v_accvgpr_read_b32 v35, a35
    v_accvgpr_read_b32 v36, a36
    v_accvgpr_read_b32 v37, a37
    v_accvgpr_read_b32 v38, a38
    v_accvgpr_read_b32 v39, a39
    v_accvgpr_read_b32 v40, a40
    v_accvgpr_read_b32 v41, a41
    v_accvgpr_read_b32 v42, a42
    v_accvgpr_read_b32 v43, a43
    v_accvgpr_read_b32 v44, a44
    v_accvgpr_read_b32 v45, a45
    v_accvgpr_read_b32 v46, a46
    v_accvgpr_read_b32 v47, a47
    v_cvt_pk_bf16_f32 v48, v32, v33
    v_cvt_pk_bf16_f32 v49, v34, v35
    v_cvt_pk_bf16_f32 v50, v36, v37
    v_cvt_pk_bf16_f32 v51, v38, v39
    v_cvt_pk_bf16_f32 v52, v40, v41
    v_cvt_pk_bf16_f32 v53, v42, v43
    v_cvt_pk_bf16_f32 v54, v44, v45
    v_cvt_pk_bf16_f32 v55, v46, v47
    v_permlane32_swap_b32 v48, v50
    v_permlane32_swap_b32 v49, v51
    v_permlane32_swap_b32 v52, v54
    v_permlane32_swap_b32 v53, v55
    ds_write_b128 v13, v[48:51] offset:64
    ds_write_b128 v13, v[52:55] offset:96
    v_accvgpr_read_b32 v56, a48
    v_accvgpr_read_b32 v57, a49
    v_accvgpr_read_b32 v58, a50
    v_accvgpr_read_b32 v59, a51
    v_accvgpr_read_b32 v60, a52
    v_accvgpr_read_b32 v61, a53
    v_accvgpr_read_b32 v62, a54
    v_accvgpr_read_b32 v63, a55
    v_accvgpr_read_b32 v64, a56
    v_accvgpr_read_b32 v65, a57
    v_accvgpr_read_b32 v66, a58
    v_accvgpr_read_b32 v67, a59
    v_accvgpr_read_b32 v68, a60
    v_accvgpr_read_b32 v69, a61
    v_accvgpr_read_b32 v70, a62
    v_accvgpr_read_b32 v71, a63
    v_cvt_pk_bf16_f32 v72, v56, v57
    v_cvt_pk_bf16_f32 v73, v58, v59
    v_cvt_pk_bf16_f32 v74, v60, v61
    v_cvt_pk_bf16_f32 v75, v62, v63
    v_cvt_pk_bf16_f32 v76, v64, v65
    v_cvt_pk_bf16_f32 v77, v66, v67
    v_cvt_pk_bf16_f32 v78, v68, v69
    v_cvt_pk_bf16_f32 v79, v70, v71
    v_permlane32_swap_b32 v72, v74
    v_permlane32_swap_b32 v73, v75
    v_permlane32_swap_b32 v76, v78
    v_permlane32_swap_b32 v77, v79
    ds_write_b128 v13, v[72:75] offset:8768
    ds_write_b128 v13, v[76:79] offset:8800
    v_accvgpr_read_b32 v32, a64
    v_accvgpr_read_b32 v33, a65
    v_accvgpr_read_b32 v34, a66
    v_accvgpr_read_b32 v35, a67
    v_accvgpr_read_b32 v36, a68
    v_accvgpr_read_b32 v37, a69
    v_accvgpr_read_b32 v38, a70
    v_accvgpr_read_b32 v39, a71
    v_accvgpr_read_b32 v40, a72
    v_accvgpr_read_b32 v41, a73
    v_accvgpr_read_b32 v42, a74
    v_accvgpr_read_b32 v43, a75
    v_accvgpr_read_b32 v44, a76
    v_accvgpr_read_b32 v45, a77
    v_accvgpr_read_b32 v46, a78
    v_accvgpr_read_b32 v47, a79
    v_cvt_pk_bf16_f32 v48, v32, v33
    v_cvt_pk_bf16_f32 v49, v34, v35
    v_cvt_pk_bf16_f32 v50, v36, v37
    v_cvt_pk_bf16_f32 v51, v38, v39
    v_cvt_pk_bf16_f32 v52, v40, v41
    v_cvt_pk_bf16_f32 v53, v42, v43
    v_cvt_pk_bf16_f32 v54, v44, v45
    v_cvt_pk_bf16_f32 v55, v46, v47
    v_permlane32_swap_b32 v48, v50
    v_permlane32_swap_b32 v49, v51
    v_permlane32_swap_b32 v52, v54
    v_permlane32_swap_b32 v53, v55
    ds_write_b128 v13, v[48:51] offset:128
    ds_write_b128 v13, v[52:55] offset:160
    v_accvgpr_read_b32 v56, a80
    v_accvgpr_read_b32 v57, a81
    v_accvgpr_read_b32 v58, a82
    v_accvgpr_read_b32 v59, a83
    v_accvgpr_read_b32 v60, a84
    v_accvgpr_read_b32 v61, a85
    v_accvgpr_read_b32 v62, a86
    v_accvgpr_read_b32 v63, a87
    v_accvgpr_read_b32 v64, a88
    v_accvgpr_read_b32 v65, a89
    v_accvgpr_read_b32 v66, a90
    v_accvgpr_read_b32 v67, a91
    v_accvgpr_read_b32 v68, a92
    v_accvgpr_read_b32 v69, a93
    v_accvgpr_read_b32 v70, a94
    v_accvgpr_read_b32 v71, a95
    v_cvt_pk_bf16_f32 v72, v56, v57
    v_cvt_pk_bf16_f32 v73, v58, v59
    v_cvt_pk_bf16_f32 v74, v60, v61
    v_cvt_pk_bf16_f32 v75, v62, v63
    v_cvt_pk_bf16_f32 v76, v64, v65
    v_cvt_pk_bf16_f32 v77, v66, v67
    v_cvt_pk_bf16_f32 v78, v68, v69
    v_cvt_pk_bf16_f32 v79, v70, v71
    v_permlane32_swap_b32 v72, v74
    v_permlane32_swap_b32 v73, v75
    v_permlane32_swap_b32 v76, v78
    v_permlane32_swap_b32 v77, v79
    ds_write_b128 v13, v[72:75] offset:8832
    ds_write_b128 v13, v[76:79] offset:8864
    v_accvgpr_read_b32 v32, a96
    v_accvgpr_read_b32 v33, a97
    v_accvgpr_read_b32 v34, a98
    v_accvgpr_read_b32 v35, a99
    v_accvgpr_read_b32 v36, a100
    v_accvgpr_read_b32 v37, a101
    v_accvgpr_read_b32 v38, a102
    v_accvgpr_read_b32 v39, a103
    v_accvgpr_read_b32 v40, a104
    v_accvgpr_read_b32 v41, a105
    v_accvgpr_read_b32 v42, a106
    v_accvgpr_read_b32 v43, a107
    v_accvgpr_read_b32 v44, a108
    v_accvgpr_read_b32 v45, a109
    v_accvgpr_read_b32 v46, a110
    v_accvgpr_read_b32 v47, a111
    v_cvt_pk_bf16_f32 v48, v32, v33
    v_cvt_pk_bf16_f32 v49, v34, v35
    v_cvt_pk_bf16_f32 v50, v36, v37
    v_cvt_pk_bf16_f32 v51, v38, v39
    v_cvt_pk_bf16_f32 v52, v40, v41
    v_cvt_pk_bf16_f32 v53, v42, v43
    v_cvt_pk_bf16_f32 v54, v44, v45
    v_cvt_pk_bf16_f32 v55, v46, v47
    v_permlane32_swap_b32 v48, v50
    v_permlane32_swap_b32 v49, v51
    v_permlane32_swap_b32 v52, v54
    v_permlane32_swap_b32 v53, v55
    ds_write_b128 v13, v[48:51] offset:192
    ds_write_b128 v13, v[52:55] offset:224
    v_accvgpr_read_b32 v56, a112
    v_accvgpr_read_b32 v57, a113
    v_accvgpr_read_b32 v58, a114
    v_accvgpr_read_b32 v59, a115
    v_accvgpr_read_b32 v60, a116
    v_accvgpr_read_b32 v61, a117
    v_accvgpr_read_b32 v62, a118
    v_accvgpr_read_b32 v63, a119
    v_accvgpr_read_b32 v64, a120
    v_accvgpr_read_b32 v65, a121
    v_accvgpr_read_b32 v66, a122
    v_accvgpr_read_b32 v67, a123
    v_accvgpr_read_b32 v68, a124
    v_accvgpr_read_b32 v69, a125
    v_accvgpr_read_b32 v70, a126
    v_accvgpr_read_b32 v71, a127
    v_cvt_pk_bf16_f32 v72, v56, v57
    v_cvt_pk_bf16_f32 v73, v58, v59
    v_cvt_pk_bf16_f32 v74, v60, v61
    v_cvt_pk_bf16_f32 v75, v62, v63
    v_cvt_pk_bf16_f32 v76, v64, v65
    v_cvt_pk_bf16_f32 v77, v66, v67
    v_cvt_pk_bf16_f32 v78, v68, v69
    v_cvt_pk_bf16_f32 v79, v70, v71
    v_permlane32_swap_b32 v72, v74
    v_permlane32_swap_b32 v73, v75
    v_permlane32_swap_b32 v76, v78
    v_permlane32_swap_b32 v77, v79
    ds_write_b128 v13, v[72:75] offset:8896
    ds_write_b128 v13, v[76:79] offset:8928
    v_lshrrev_b32 v11, 1, v9
    v_mul_u32_u24 v11, 256, v11
    v_and_b32 v12, 15, v8
    v_lshl_add_u32 v15, v12, 4, v11
    v_and_b32 v10, 1, v9
    v_mul_u32_u24 v10, 64, v10
    v_lshrrev_b32 v11, 4, v8
    v_add_u32 v16, v10, v11
    s_waitcnt lgkmcnt(0)
    s_mov_b32 s64, 8192
    ds_read_b128 v[32:35], v14 offset:0
    ds_read_b128 v[36:39], v14 offset:1088
    ds_read_b128 v[40:43], v14 offset:2176
    ds_read_b128 v[44:47], v14 offset:3264
    ds_read_b128 v[48:51], v14 offset:4352
    ds_read_b128 v[52:55], v14 offset:5440
    ds_read_b128 v[56:59], v14 offset:6528
    ds_read_b128 v[60:63], v14 offset:7616
    v_add_u32 v64, 0, v16
    v_mul_lo_u32 v64, v64, s64
    v_add_u32 v64, v64, v15
    v_add_u32 v65, 4, v16
    v_mul_lo_u32 v65, v65, s64
    v_add_u32 v65, v65, v15
    v_add_u32 v66, 8, v16
    v_mul_lo_u32 v66, v66, s64
    v_add_u32 v66, v66, v15
    v_add_u32 v67, 12, v16
    v_mul_lo_u32 v67, v67, s64
    v_add_u32 v67, v67, v15
    v_add_u32 v68, 16, v16
    v_mul_lo_u32 v68, v68, s64
    v_add_u32 v68, v68, v15
    v_add_u32 v69, 20, v16
    v_mul_lo_u32 v69, v69, s64
    v_add_u32 v69, v69, v15
    v_add_u32 v70, 24, v16
    v_mul_lo_u32 v70, v70, s64
    v_add_u32 v70, v70, v15
    v_add_u32 v71, 28, v16
    v_mul_lo_u32 v71, v71, s64
    v_add_u32 v71, v71, v15
    s_waitcnt lgkmcnt(7)
    buffer_store_dwordx4 v[32:35], v64, s[52:55], s68 offen sc1
    s_waitcnt lgkmcnt(6)
    buffer_store_dwordx4 v[36:39], v65, s[52:55], s68 offen sc1
    s_waitcnt lgkmcnt(5)
    buffer_store_dwordx4 v[40:43], v66, s[52:55], s68 offen sc1
    s_waitcnt lgkmcnt(4)
    buffer_store_dwordx4 v[44:47], v67, s[52:55], s68 offen sc1
    s_waitcnt lgkmcnt(3)
    buffer_store_dwordx4 v[48:51], v68, s[52:55], s68 offen sc1
    s_waitcnt lgkmcnt(2)
    buffer_store_dwordx4 v[52:55], v69, s[52:55], s68 offen sc1
    s_waitcnt lgkmcnt(1)
    buffer_store_dwordx4 v[56:59], v70, s[52:55], s68 offen sc1
    s_waitcnt lgkmcnt(0)
    buffer_store_dwordx4 v[60:63], v71, s[52:55], s68 offen sc1
    ds_read_b128 v[32:35], v14 offset:8704
    ds_read_b128 v[36:39], v14 offset:9792
    ds_read_b128 v[40:43], v14 offset:10880
    ds_read_b128 v[44:47], v14 offset:11968
    ds_read_b128 v[48:51], v14 offset:13056
    ds_read_b128 v[52:55], v14 offset:14144
    ds_read_b128 v[56:59], v14 offset:15232
    ds_read_b128 v[60:63], v14 offset:16320
    v_add_u32 v64, 32, v16
    v_mul_lo_u32 v64, v64, s64
    v_add_u32 v64, v64, v15
    v_add_u32 v65, 36, v16
    v_mul_lo_u32 v65, v65, s64
    v_add_u32 v65, v65, v15
    v_add_u32 v66, 40, v16
    v_mul_lo_u32 v66, v66, s64
    v_add_u32 v66, v66, v15
    v_add_u32 v67, 44, v16
    v_mul_lo_u32 v67, v67, s64
    v_add_u32 v67, v67, v15
    v_add_u32 v68, 48, v16
    v_mul_lo_u32 v68, v68, s64
    v_add_u32 v68, v68, v15
    v_add_u32 v69, 52, v16
    v_mul_lo_u32 v69, v69, s64
    v_add_u32 v69, v69, v15
    v_add_u32 v70, 56, v16
    v_mul_lo_u32 v70, v70, s64
    v_add_u32 v70, v70, v15
    v_add_u32 v71, 60, v16
    v_mul_lo_u32 v71, v71, s64
    v_add_u32 v71, v71, v15
    s_waitcnt lgkmcnt(7)
    buffer_store_dwordx4 v[32:35], v64, s[52:55], s68 offen sc1
    s_waitcnt lgkmcnt(6)
    buffer_store_dwordx4 v[36:39], v65, s[52:55], s68 offen sc1
    s_waitcnt lgkmcnt(5)
    buffer_store_dwordx4 v[40:43], v66, s[52:55], s68 offen sc1
    s_waitcnt lgkmcnt(4)
    buffer_store_dwordx4 v[44:47], v67, s[52:55], s68 offen sc1
    s_waitcnt lgkmcnt(3)
    buffer_store_dwordx4 v[48:51], v68, s[52:55], s68 offen sc1
    s_waitcnt lgkmcnt(2)
    buffer_store_dwordx4 v[52:55], v69, s[52:55], s68 offen sc1
    s_waitcnt lgkmcnt(1)
    buffer_store_dwordx4 v[56:59], v70, s[52:55], s68 offen sc1
    s_waitcnt lgkmcnt(0)
    buffer_store_dwordx4 v[60:63], v71, s[52:55], s68 offen sc1
    s_waitcnt vmcnt(0)
    s_barrier
    v_mov_b32 v1, s75
    v_mov_b32 v2, 1
    v_cmp_eq_u32 vcc, 0, v0
    s_nop 0
    s_and_saveexec_b64 s[6:7], vcc
    s_cbranch_execz .sg_41
    global_atomic_add v1, v2, s[38:39]
.sg_41:
    s_mov_b64 exec, s[6:7]
    s_branch .work_8
.task_29:
    s_add_u32 s72, s72, 32
.b1_26:
    s_lshr_b32 s75, s72, 4
    s_mul_i32 s73, s75, 43
    s_lshr_b32 s73, s73, 8
    s_mul_i32 s74, s73, 6
    s_sub_u32 s75, s75, s74
    s_mul_i32 s75, s75, 5
    s_mov_b32 s74, 0x2092a29
    s_cmp_eq_u32 s73, 1
    s_cselect_b32 s74, 0x7460a6b, s74
    s_cmp_eq_u32 s73, 2
    s_cselect_b32 s74, 0xb6712ad, s74
    s_cmp_eq_u32 s73, 3
    s_cselect_b32 s74, 0x39aef, s74
    s_lshr_b32 s74, s74, s75
    s_bfe_u32 s55, s74, 0x20003
    s_and_b32 s75, s74, 7
    s_and_b32 s73, s72, 15
    s_lshl_b32 s56, s55, 4
    s_add_u32 s73, s73, s56
    s_lshl_b32 s74, s75, 8
    s_lshl_b32 s75, s75, 2
    s_cmp_eq_u32 s55, 0
    s_cselect_b32 s55, 80, 32
    s_add_u32 s75, s75, s55
.big_37:
    s_lshr_b32 s58, s73, 4
    s_and_b32 s56, s73, 15
    s_cmp_eq_u32 s58, 1
    s_cselect_b32 s44, s28, s26
    s_cselect_b32 s45, s29, s27
    s_cmp_eq_u32 s58, 2
    s_cselect_b32 s44, s30, s44
    s_cselect_b32 s45, s31, s45
    s_and_b32 s45, s45, 0xffff
    s_mov_b32 s46, 0x500000
    s_mov_b32 s47, 0x00020000
    s_mov_b32 s48, s22
    s_and_b32 s49, s23, 0xffff
    s_mov_b32 s50, 0x280000
    s_mov_b32 s51, 0x00020000
    s_mov_b32 s52, s40
    s_and_b32 s53, s41, 0xffff
    s_mov_b32 s54, 0xfe00000
    s_mov_b32 s55, 0x00020000
    s_lshl_b32 s66, s56, 9
    s_mul_i32 s67, s74, 1280
    s_lshl_b32 s68, s58, 24
    s_lshl_b32 s59, s74, 13
    s_add_u32 s68, s68, s59
    s_add_u32 s68, s68, s66
    v_and_b32 v8, 63, v0
    v_lshrrev_b32 v9, 6, v0
    s_nop 0
    v_readfirstlane_b32 s63, v9
    v_mov_b32 v11, 256
    v_mad_u32_u24 v10, v9, v11, v8
    v_lshrrev_b32 v11, 5, v10
    v_and_b32 v10, 31, v10
    v_and_b32 v12, 3, v11
    v_lshlrev_b32 v12, 2, v12
    v_xor_b32 v10, v10, v12
    s_mov_b32 s64, 8192
    v_mul_lo_u32 v11, v11, s64
    v_lshl_add_u32 v13, v10, 4, v11
    v_mov_b32 v11, 256
    v_mad_u32_u24 v10, v9, v11, v8
    v_add_u32 v10, 64, v10
    v_lshrrev_b32 v11, 5, v10
    v_and_b32 v10, 31, v10
    v_and_b32 v12, 3, v11
    v_lshlrev_b32 v12, 2, v12
    v_xor_b32 v10, v10, v12
    s_mov_b32 s64, 8192
    v_mul_lo_u32 v11, v11, s64
    v_lshl_add_u32 v14, v10, 4, v11
    v_mov_b32 v11, 256
    v_mad_u32_u24 v10, v9, v11, v8
    v_add_u32 v10, 128, v10
    v_lshrrev_b32 v11, 5, v10
    v_and_b32 v10, 31, v10
    v_and_b32 v12, 3, v11
    v_lshlrev_b32 v12, 2, v12
    v_xor_b32 v10, v10, v12
    s_mov_b32 s64, 8192
    v_mul_lo_u32 v11, v11, s64
    v_lshl_add_u32 v15, v10, 4, v11
    v_mov_b32 v11, 256
    v_mad_u32_u24 v10, v9, v11, v8
    v_add_u32 v10, 192, v10
    v_lshrrev_b32 v11, 5, v10
    v_and_b32 v10, 31, v10
    v_and_b32 v12, 3, v11
    v_lshlrev_b32 v12, 2, v12
    v_xor_b32 v10, v10, v12
    s_mov_b32 s64, 8192
    v_mul_lo_u32 v11, v11, s64
    v_lshl_add_u32 v16, v10, 4, v11
    v_lshrrev_b32 v10, 2, v8
    v_mov_b32 v11, 64
    v_mad_u32_u24 v10, v9, v11, v10
    s_mov_b32 s64, 1280
    v_mul_lo_u32 v10, v10, s64
    v_lshrrev_b32 v11, 4, v8
    v_xor_b32 v11, v11, v8
    v_and_b32 v11, 3, v11
    v_lshl_add_u32 v17, v11, 4, v10
    v_lshrrev_b32 v10, 2, v8
    v_mov_b32 v11, 64
    v_mad_u32_u24 v10, v9, v11, v10
    v_add_u32 v10, 16, v10
    s_mov_b32 s64, 1280
    v_mul_lo_u32 v10, v10, s64
    v_lshrrev_b32 v11, 4, v8
    v_xor_b32 v11, v11, v8
    v_and_b32 v11, 3, v11
    v_lshl_add_u32 v18, v11, 4, v10
    v_lshrrev_b32 v10, 2, v8
    v_mov_b32 v11, 64
    v_mad_u32_u24 v10, v9, v11, v10
    v_add_u32 v10, 32, v10
    s_mov_b32 s64, 1280
    v_mul_lo_u32 v10, v10, s64
    v_lshrrev_b32 v11, 4, v8
    v_xor_b32 v11, v11, v8
    v_and_b32 v11, 3, v11
    v_lshl_add_u32 v19, v11, 4, v10
    v_lshrrev_b32 v10, 2, v8
    v_mov_b32 v11, 64
    v_mad_u32_u24 v10, v9, v11, v10
    v_add_u32 v10, 48, v10
    s_mov_b32 s64, 1280
    v_mul_lo_u32 v10, v10, s64
    v_lshrrev_b32 v11, 4, v8
    v_xor_b32 v11, v11, v8
    v_and_b32 v11, 3, v11
    v_lshl_add_u32 v20, v11, 4, v10
    v_lshrrev_b32 v12, 1, v9
    v_bfe_u32 v10, v8, 2, 2
    v_mov_b32 v11, 4
    v_mad_u32_u24 v11, v12, v11, 0
    v_xor_b32 v11, v11, v10
    v_lshlrev_b32 v11, 6, v11
    v_lshrrev_b32 v21, 5, v8
    v_lshl_add_u32 v10, v21, 3, v10
    v_mov_b32 v21, 512
    v_mad_u32_u24 v11, v10, v21, v11
    v_bfe_u32 v10, v8, 4, 1
    v_lshl_add_u32 v11, v10, 5, v11
    v_and_b32 v10, 3, v8
    v_lshl_add_u32 v11, v10, 3, v11
    v_add_u32 v21, 0, v11
    v_bfe_u32 v10, v8, 2, 2
    v_mov_b32 v11, 4
    v_mad_u32_u24 v11, v12, v11, 1
    v_xor_b32 v11, v11, v10
    v_lshlrev_b32 v11, 6, v11
    v_lshrrev_b32 v22, 5, v8
    v_lshl_add_u32 v10, v22, 3, v10
    v_mov_b32 v22, 512
    v_mad_u32_u24 v11, v10, v22, v11
    v_bfe_u32 v10, v8, 4, 1
    v_lshl_add_u32 v11, v10, 5, v11
    v_and_b32 v10, 3, v8
    v_lshl_add_u32 v11, v10, 3, v11
    v_add_u32 v22, 0, v11
    v_bfe_u32 v10, v8, 2, 2
    v_mov_b32 v11, 4
    v_mad_u32_u24 v11, v12, v11, 2
    v_xor_b32 v11, v11, v10
    v_lshlrev_b32 v11, 6, v11
    v_lshrrev_b32 v23, 5, v8
    v_lshl_add_u32 v10, v23, 3, v10
    v_mov_b32 v23, 512
    v_mad_u32_u24 v11, v10, v23, v11
    v_bfe_u32 v10, v8, 4, 1
    v_lshl_add_u32 v11, v10, 5, v11
    v_and_b32 v10, 3, v8
    v_lshl_add_u32 v11, v10, 3, v11
    v_add_u32 v23, 0, v11
    v_bfe_u32 v10, v8, 2, 2
    v_mov_b32 v11, 4
    v_mad_u32_u24 v11, v12, v11, 3
    v_xor_b32 v11, v11, v10
    v_lshlrev_b32 v11, 6, v11
    v_lshrrev_b32 v24, 5, v8
    v_lshl_add_u32 v10, v24, 3, v10
    v_mov_b32 v24, 512
    v_mad_u32_u24 v11, v10, v24, v11
    v_bfe_u32 v10, v8, 4, 1
    v_lshl_add_u32 v11, v10, 5, v11
    v_and_b32 v10, 3, v8
    v_lshl_add_u32 v11, v10, 3, v11
    v_add_u32 v24, 0, v11
    v_and_b32 v12, 1, v9
    v_and_b32 v10, 31, v8
    v_lshrrev_b32 v11, 5, v8
    v_bfe_u32 v25, v8, 2, 2
    v_xor_b32 v11, v11, v25
    v_lshlrev_b32 v11, 4, v11
    v_lshl_add_u32 v10, v10, 6, v11
    v_mov_b32 v11, 8192
    v_mad_u32_u24 v10, v12, v11, v10
    v_add_u32 v25, 16384, v10
    v_and_b32 v10, 31, v8
    v_lshrrev_b32 v11, 5, v8
    v_add_u32 v11, 2, v11
    v_bfe_u32 v26, v8, 2, 2
    v_xor_b32 v11, v11, v26
    v_lshlrev_b32 v11, 4, v11
    v_lshl_add_u32 v10, v10, 6, v11
    v_mov_b32 v11, 8192
    v_mad_u32_u24 v10, v12, v11, v10
    v_add_u32 v26, 16384, v10
    s_mul_i32 s61, s63, 4096
    s_mov_b32 s60, 0
    s_mul_i32 s64, s63, 0
    s_add_u32 s64, s64, s61
    s_add_u32 s64, s64, 16384
    s_add_u32 m0, s61, 0
    s_nop 0
    buffer_load_dwordx4 v13, s[44:47], s66 offen lds
    s_add_u32 m0, s61, 1024
    s_nop 0
    buffer_load_dwordx4 v14, s[44:47], s66 offen lds
    s_add_u32 m0, s61, 2048
    s_nop 0
    buffer_load_dwordx4 v15, s[44:47], s66 offen lds
    s_add_u32 m0, s61, 3072
    s_nop 0
    buffer_load_dwordx4 v16, s[44:47], s66 offen lds
    s_add_u32 m0, s64, 0
    s_nop 0
    buffer_load_dwordx4 v17, s[48:51], s67 offen lds
    s_add_u32 m0, s64, 1024
    s_nop 0
    buffer_load_dwordx4 v18, s[48:51], s67 offen lds
    s_add_u32 m0, s64, 2048
    s_nop 0
    buffer_load_dwordx4 v19, s[48:51], s67 offen lds
    s_add_u32 m0, s64, 3072
    s_nop 0
    buffer_load_dwordx4 v20, s[48:51], s67 offen lds
    s_add_u32 s66, s66, 262144
    s_add_u32 s67, s67, 64
    s_add_u32 s61, s61, 32768
    s_cmp_ge_u32 s61, 131072
    s_cselect_b32 s65, 131072, 0
    s_sub_u32 s61, s61, s65
    s_mul_i32 s64, s63, 0
    s_add_u32 s64, s64, s61
    s_add_u32 s64, s64, 16384
    s_add_u32 m0, s61, 0
    s_nop 0
    buffer_load_dwordx4 v13, s[44:47], s66 offen lds
    s_add_u32 m0, s61, 1024
    s_nop 0
    buffer_load_dwordx4 v14, s[44:47], s66 offen lds
    s_add_u32 m0, s61, 2048
    s_nop 0
    buffer_load_dwordx4 v15, s[44:47], s66 offen lds
    s_add_u32 m0, s61, 3072
    s_nop 0
    buffer_load_dwordx4 v16, s[44:47], s66 offen lds
    s_add_u32 m0, s64, 0
    s_nop 0
    buffer_load_dwordx4 v17, s[48:51], s67 offen lds
    s_add_u32 m0, s64, 1024
    s_nop 0
    buffer_load_dwordx4 v18, s[48:51], s67 offen lds
    s_add_u32 m0, s64, 2048
    s_nop 0
    buffer_load_dwordx4 v19, s[48:51], s67 offen lds
    s_add_u32 m0, s64, 3072
    s_nop 0
    buffer_load_dwordx4 v20, s[48:51], s67 offen lds
    s_add_u32 s66, s66, 262144
    s_add_u32 s67, s67, 64
    s_add_u32 s61, s61, 32768
    s_cmp_ge_u32 s61, 131072
    s_cselect_b32 s65, 131072, 0
    s_sub_u32 s61, s61, s65
    s_mul_i32 s64, s63, 0
    s_add_u32 s64, s64, s61
    s_add_u32 s64, s64, 16384
    s_add_u32 m0, s61, 0
    s_nop 0
    buffer_load_dwordx4 v13, s[44:47], s66 offen lds
    s_add_u32 m0, s61, 1024
    s_nop 0
    buffer_load_dwordx4 v14, s[44:47], s66 offen lds
    s_add_u32 m0, s61, 2048
    s_nop 0
    buffer_load_dwordx4 v15, s[44:47], s66 offen lds
    s_add_u32 m0, s61, 3072
    s_nop 0
    buffer_load_dwordx4 v16, s[44:47], s66 offen lds
    s_add_u32 m0, s64, 0
    s_nop 0
    buffer_load_dwordx4 v17, s[48:51], s67 offen lds
    s_add_u32 m0, s64, 1024
    s_nop 0
    buffer_load_dwordx4 v18, s[48:51], s67 offen lds
    s_add_u32 m0, s64, 2048
    s_nop 0
    buffer_load_dwordx4 v19, s[48:51], s67 offen lds
    s_add_u32 m0, s64, 3072
    s_nop 0
    buffer_load_dwordx4 v20, s[48:51], s67 offen lds
    s_add_u32 s66, s66, 262144
    s_add_u32 s67, s67, 64
    s_add_u32 s61, s61, 32768
    s_cmp_ge_u32 s61, 131072
    s_cselect_b32 s65, 131072, 0
    s_sub_u32 s61, s61, s65
    v_add_u32 v27, s60, v21
    v_add_u32 v28, s60, v22
    v_add_u32 v29, s60, v23
    v_add_u32 v30, s60, v24
    v_add_u32 v31, s60, v25
    v_add_u32 v32, s60, v26
    s_add_u32 s60, s60, 32768
    s_cmp_ge_u32 s60, 131072
    s_cselect_b32 s60, 0, s60
    s_waitcnt vmcnt(16)
    s_barrier
    ds_read_b64_tr_b16 v[36:37], v27 offset:0
    ds_read_b64_tr_b16 v[38:39], v27 offset:2048
    ds_read_b64_tr_b16 v[40:41], v28 offset:0
    ds_read_b64_tr_b16 v[42:43], v28 offset:2048
    ds_read_b64_tr_b16 v[44:45], v29 offset:0
    ds_read_b64_tr_b16 v[46:47], v29 offset:2048
    ds_read_b64_tr_b16 v[48:49], v30 offset:0
    ds_read_b64_tr_b16 v[50:51], v30 offset:2048
    ds_read_b128 v[68:71], v31 offset:0
    ds_read_b128 v[72:75], v31 offset:2048
    ds_read_b128 v[76:79], v31 offset:4096
    ds_read_b128 v[80:83], v31 offset:6144
    s_waitcnt lgkmcnt(0)
    v_mfma_f32_32x32x16_bf16 a[0:15], v[36:39], v[68:71], 0
    ds_read_b64_tr_b16 v[52:53], v27 offset:8192
    v_mfma_f32_32x32x16_bf16 a[16:31], v[36:39], v[72:75], 0
    ds_read_b64_tr_b16 v[54:55], v27 offset:10240
    v_mfma_f32_32x32x16_bf16 a[32:47], v[36:39], v[76:79], 0
    ds_read_b64_tr_b16 v[56:57], v28 offset:8192
    v_mfma_f32_32x32x16_bf16 a[48:63], v[36:39], v[80:83], 0
    ds_read_b64_tr_b16 v[58:59], v28 offset:10240
    v_mfma_f32_32x32x16_bf16 a[64:79], v[40:43], v[68:71], 0
    ds_read_b64_tr_b16 v[60:61], v29 offset:8192
    v_mfma_f32_32x32x16_bf16 a[80:95], v[40:43], v[72:75], 0
    ds_read_b64_tr_b16 v[62:63], v29 offset:10240
    v_mfma_f32_32x32x16_bf16 a[96:111], v[40:43], v[76:79], 0
    ds_read_b64_tr_b16 v[64:65], v30 offset:8192
    v_mfma_f32_32x32x16_bf16 a[112:127], v[40:43], v[80:83], 0
    ds_read_b64_tr_b16 v[66:67], v30 offset:10240
    v_mfma_f32_32x32x16_bf16 a[128:143], v[44:47], v[68:71], 0
    ds_read_b128 v[84:87], v32 offset:0
    v_mfma_f32_32x32x16_bf16 a[144:159], v[44:47], v[72:75], 0
    ds_read_b128 v[88:91], v32 offset:2048
    v_mfma_f32_32x32x16_bf16 a[160:175], v[44:47], v[76:79], 0
    ds_read_b128 v[92:95], v32 offset:4096
    v_mfma_f32_32x32x16_bf16 a[176:191], v[44:47], v[80:83], 0
    ds_read_b128 v[96:99], v32 offset:6144
    v_mfma_f32_32x32x16_bf16 a[192:207], v[48:51], v[68:71], 0
    v_mfma_f32_32x32x16_bf16 a[208:223], v[48:51], v[72:75], 0
    v_mfma_f32_32x32x16_bf16 a[224:239], v[48:51], v[76:79], 0
    v_mfma_f32_32x32x16_bf16 a[240:255], v[48:51], v[80:83], 0
    s_waitcnt vmcnt(8)
    s_barrier
    v_add_u32 v27, s60, v21
    v_add_u32 v28, s60, v22
    v_add_u32 v29, s60, v23
    v_add_u32 v30, s60, v24
    v_add_u32 v31, s60, v25
    v_add_u32 v32, s60, v26
    s_add_u32 s60, s60, 32768
    s_cmp_ge_u32 s60, 131072
    s_cselect_b32 s60, 0, s60
    s_mul_i32 s64, s63, 0
    s_add_u32 s64, s64, s61
    s_add_u32 s64, s64, 16384
    s_waitcnt lgkmcnt(0)
    v_mfma_f32_32x32x16_bf16 a[0:15], v[52:55], v[84:87], a[0:15]
    ds_read_b64_tr_b16 v[36:37], v27 offset:0
    ds_read_b64_tr_b16 v[38:39], v27 offset:2048
    v_mfma_f32_32x32x16_bf16 a[16:31], v[52:55], v[88:91], a[16:31]
    ds_read_b64_tr_b16 v[40:41], v28 offset:0
    ds_read_b64_tr_b16 v[42:43], v28 offset:2048
    v_mfma_f32_32x32x16_bf16 a[32:47], v[52:55], v[92:95], a[32:47]
    ds_read_b64_tr_b16 v[44:45], v29 offset:0
    ds_read_b64_tr_b16 v[46:47], v29 offset:2048
    v_mfma_f32_32x32x16_bf16 a[48:63], v[52:55], v[96:99], a[48:63]
    ds_read_b64_tr_b16 v[48:49], v30 offset:0
    ds_read_b64_tr_b16 v[50:51], v30 offset:2048
    v_mfma_f32_32x32x16_bf16 a[64:79], v[56:59], v[84:87], a[64:79]
    ds_read_b128 v[68:71], v31 offset:0
    ds_read_b128 v[72:75], v31 offset:2048
    v_mfma_f32_32x32x16_bf16 a[80:95], v[56:59], v[88:91], a[80:95]
    ds_read_b128 v[76:79], v31 offset:4096
    ds_read_b128 v[80:83], v31 offset:6144
    v_mfma_f32_32x32x16_bf16 a[96:111], v[56:59], v[92:95], a[96:111]
    s_add_u32 m0, s61, 0
    s_nop 0
    buffer_load_dwordx4 v13, s[44:47], s66 offen lds
    s_add_u32 m0, s61, 1024
    s_nop 0
    buffer_load_dwordx4 v14, s[44:47], s66 offen lds
    v_mfma_f32_32x32x16_bf16 a[112:127], v[56:59], v[96:99], a[112:127]
    s_add_u32 m0, s61, 2048
    s_nop 0
    buffer_load_dwordx4 v15, s[44:47], s66 offen lds
    s_add_u32 m0, s61, 3072
    s_nop 0
    buffer_load_dwordx4 v16, s[44:47], s66 offen lds
    v_mfma_f32_32x32x16_bf16 a[128:143], v[60:63], v[84:87], a[128:143]
    s_add_u32 m0, s64, 0
    s_nop 0
    buffer_load_dwordx4 v17, s[48:51], s67 offen lds
    s_add_u32 m0, s64, 1024
    s_nop 0
    buffer_load_dwordx4 v18, s[48:51], s67 offen lds
    v_mfma_f32_32x32x16_bf16 a[144:159], v[60:63], v[88:91], a[144:159]
    s_add_u32 m0, s64, 2048
    s_nop 0
    buffer_load_dwordx4 v19, s[48:51], s67 offen lds
    s_add_u32 m0, s64, 3072
    s_nop 0
    buffer_load_dwordx4 v20, s[48:51], s67 offen lds
    v_mfma_f32_32x32x16_bf16 a[160:175], v[60:63], v[92:95], a[160:175]
    v_mfma_f32_32x32x16_bf16 a[176:191], v[60:63], v[96:99], a[176:191]
    v_mfma_f32_32x32x16_bf16 a[192:207], v[64:67], v[84:87], a[192:207]
    v_mfma_f32_32x32x16_bf16 a[208:223], v[64:67], v[88:91], a[208:223]
    v_mfma_f32_32x32x16_bf16 a[224:239], v[64:67], v[92:95], a[224:239]
    v_mfma_f32_32x32x16_bf16 a[240:255], v[64:67], v[96:99], a[240:255]
    s_add_u32 s66, s66, 262144
    s_add_u32 s67, s67, 64
    s_add_u32 s61, s61, 32768
    s_cmp_ge_u32 s61, 131072
    s_cselect_b32 s65, 131072, 0
    s_sub_u32 s61, s61, s65
    s_mov_b32 s62, 16
.gl_42:
    s_waitcnt lgkmcnt(0)
    v_mfma_f32_32x32x16_bf16 a[0:15], v[36:39], v[68:71], a[0:15]
    ds_read_b64_tr_b16 v[52:53], v27 offset:8192
    v_mfma_f32_32x32x16_bf16 a[16:31], v[36:39], v[72:75], a[16:31]
    ds_read_b64_tr_b16 v[54:55], v27 offset:10240
    v_mfma_f32_32x32x16_bf16 a[32:47], v[36:39], v[76:79], a[32:47]
    ds_read_b64_tr_b16 v[56:57], v28 offset:8192
    v_mfma_f32_32x32x16_bf16 a[48:63], v[36:39], v[80:83], a[48:63]
    ds_read_b64_tr_b16 v[58:59], v28 offset:10240
    v_mfma_f32_32x32x16_bf16 a[64:79], v[40:43], v[68:71], a[64:79]
    ds_read_b64_tr_b16 v[60:61], v29 offset:8192
    v_mfma_f32_32x32x16_bf16 a[80:95], v[40:43], v[72:75], a[80:95]
    ds_read_b64_tr_b16 v[62:63], v29 offset:10240
    v_mfma_f32_32x32x16_bf16 a[96:111], v[40:43], v[76:79], a[96:111]
    ds_read_b64_tr_b16 v[64:65], v30 offset:8192
    v_mfma_f32_32x32x16_bf16 a[112:127], v[40:43], v[80:83], a[112:127]
    ds_read_b64_tr_b16 v[66:67], v30 offset:10240
    v_mfma_f32_32x32x16_bf16 a[128:143], v[44:47], v[68:71], a[128:143]
    ds_read_b128 v[84:87], v32 offset:0
    v_mfma_f32_32x32x16_bf16 a[144:159], v[44:47], v[72:75], a[144:159]
    ds_read_b128 v[88:91], v32 offset:2048
    v_mfma_f32_32x32x16_bf16 a[160:175], v[44:47], v[76:79], a[160:175]
    ds_read_b128 v[92:95], v32 offset:4096
    v_mfma_f32_32x32x16_bf16 a[176:191], v[44:47], v[80:83], a[176:191]
    ds_read_b128 v[96:99], v32 offset:6144
    v_mfma_f32_32x32x16_bf16 a[192:207], v[48:51], v[68:71], a[192:207]
    v_mfma_f32_32x32x16_bf16 a[208:223], v[48:51], v[72:75], a[208:223]
    v_mfma_f32_32x32x16_bf16 a[224:239], v[48:51], v[76:79], a[224:239]
    v_mfma_f32_32x32x16_bf16 a[240:255], v[48:51], v[80:83], a[240:255]
    s_waitcnt vmcnt(8)
    s_barrier
    v_add_u32 v27, s60, v21
    v_add_u32 v28, s60, v22
    v_add_u32 v29, s60, v23
    v_add_u32 v30, s60, v24
    v_add_u32 v31, s60, v25
    v_add_u32 v32, s60, v26
    s_add_u32 s60, s60, 32768
    s_cmp_ge_u32 s60, 131072
    s_cselect_b32 s60, 0, s60
    s_mul_i32 s64, s63, 0
    s_add_u32 s64, s64, s61
    s_add_u32 s64, s64, 16384
    s_waitcnt lgkmcnt(0)
    v_mfma_f32_32x32x16_bf16 a[0:15], v[52:55], v[84:87], a[0:15]
    ds_read_b64_tr_b16 v[36:37], v27 offset:0
    ds_read_b64_tr_b16 v[38:39], v27 offset:2048
    v_mfma_f32_32x32x16_bf16 a[16:31], v[52:55], v[88:91], a[16:31]
    ds_read_b64_tr_b16 v[40:41], v28 offset:0
    ds_read_b64_tr_b16 v[42:43], v28 offset:2048
    v_mfma_f32_32x32x16_bf16 a[32:47], v[52:55], v[92:95], a[32:47]
    ds_read_b64_tr_b16 v[44:45], v29 offset:0
    ds_read_b64_tr_b16 v[46:47], v29 offset:2048
    v_mfma_f32_32x32x16_bf16 a[48:63], v[52:55], v[96:99], a[48:63]
    ds_read_b64_tr_b16 v[48:49], v30 offset:0
    ds_read_b64_tr_b16 v[50:51], v30 offset:2048
    v_mfma_f32_32x32x16_bf16 a[64:79], v[56:59], v[84:87], a[64:79]
    ds_read_b128 v[68:71], v31 offset:0
    ds_read_b128 v[72:75], v31 offset:2048
    v_mfma_f32_32x32x16_bf16 a[80:95], v[56:59], v[88:91], a[80:95]
    ds_read_b128 v[76:79], v31 offset:4096
    ds_read_b128 v[80:83], v31 offset:6144
    v_mfma_f32_32x32x16_bf16 a[96:111], v[56:59], v[92:95], a[96:111]
    s_add_u32 m0, s61, 0
    s_nop 0
    buffer_load_dwordx4 v13, s[44:47], s66 offen lds
    s_add_u32 m0, s61, 1024
    s_nop 0
    buffer_load_dwordx4 v14, s[44:47], s66 offen lds
    v_mfma_f32_32x32x16_bf16 a[112:127], v[56:59], v[96:99], a[112:127]
    s_add_u32 m0, s61, 2048
    s_nop 0
    buffer_load_dwordx4 v15, s[44:47], s66 offen lds
    s_add_u32 m0, s61, 3072
    s_nop 0
    buffer_load_dwordx4 v16, s[44:47], s66 offen lds
    v_mfma_f32_32x32x16_bf16 a[128:143], v[60:63], v[84:87], a[128:143]
    s_add_u32 m0, s64, 0
    s_nop 0
    buffer_load_dwordx4 v17, s[48:51], s67 offen lds
    s_add_u32 m0, s64, 1024
    s_nop 0
    buffer_load_dwordx4 v18, s[48:51], s67 offen lds
    v_mfma_f32_32x32x16_bf16 a[144:159], v[60:63], v[88:91], a[144:159]
    s_add_u32 m0, s64, 2048
    s_nop 0
    buffer_load_dwordx4 v19, s[48:51], s67 offen lds
    s_add_u32 m0, s64, 3072
    s_nop 0
    buffer_load_dwordx4 v20, s[48:51], s67 offen lds
    v_mfma_f32_32x32x16_bf16 a[160:175], v[60:63], v[92:95], a[160:175]
    v_mfma_f32_32x32x16_bf16 a[176:191], v[60:63], v[96:99], a[176:191]
    v_mfma_f32_32x32x16_bf16 a[192:207], v[64:67], v[84:87], a[192:207]
    v_mfma_f32_32x32x16_bf16 a[208:223], v[64:67], v[88:91], a[208:223]
    v_mfma_f32_32x32x16_bf16 a[224:239], v[64:67], v[92:95], a[224:239]
    v_mfma_f32_32x32x16_bf16 a[240:255], v[64:67], v[96:99], a[240:255]
    s_add_u32 s66, s66, 262144
    s_add_u32 s67, s67, 64
    s_add_u32 s61, s61, 32768
    s_cmp_ge_u32 s61, 131072
    s_cselect_b32 s65, 131072, 0
    s_sub_u32 s61, s61, s65
    s_sub_u32 s62, s62, 1
    s_cmp_lg_u32 s62, 0
    s_cbranch_scc1 .gl_42
    s_waitcnt lgkmcnt(0)
    v_mfma_f32_32x32x16_bf16 a[0:15], v[36:39], v[68:71], a[0:15]
    ds_read_b64_tr_b16 v[52:53], v27 offset:8192
    v_mfma_f32_32x32x16_bf16 a[16:31], v[36:39], v[72:75], a[16:31]
    ds_read_b64_tr_b16 v[54:55], v27 offset:10240
    v_mfma_f32_32x32x16_bf16 a[32:47], v[36:39], v[76:79], a[32:47]
    ds_read_b64_tr_b16 v[56:57], v28 offset:8192
    v_mfma_f32_32x32x16_bf16 a[48:63], v[36:39], v[80:83], a[48:63]
    ds_read_b64_tr_b16 v[58:59], v28 offset:10240
    v_mfma_f32_32x32x16_bf16 a[64:79], v[40:43], v[68:71], a[64:79]
    ds_read_b64_tr_b16 v[60:61], v29 offset:8192
    v_mfma_f32_32x32x16_bf16 a[80:95], v[40:43], v[72:75], a[80:95]
    ds_read_b64_tr_b16 v[62:63], v29 offset:10240
    v_mfma_f32_32x32x16_bf16 a[96:111], v[40:43], v[76:79], a[96:111]
    ds_read_b64_tr_b16 v[64:65], v30 offset:8192
    v_mfma_f32_32x32x16_bf16 a[112:127], v[40:43], v[80:83], a[112:127]
    ds_read_b64_tr_b16 v[66:67], v30 offset:10240
    v_mfma_f32_32x32x16_bf16 a[128:143], v[44:47], v[68:71], a[128:143]
    ds_read_b128 v[84:87], v32 offset:0
    v_mfma_f32_32x32x16_bf16 a[144:159], v[44:47], v[72:75], a[144:159]
    ds_read_b128 v[88:91], v32 offset:2048
    v_mfma_f32_32x32x16_bf16 a[160:175], v[44:47], v[76:79], a[160:175]
    ds_read_b128 v[92:95], v32 offset:4096
    v_mfma_f32_32x32x16_bf16 a[176:191], v[44:47], v[80:83], a[176:191]
    ds_read_b128 v[96:99], v32 offset:6144
    v_mfma_f32_32x32x16_bf16 a[192:207], v[48:51], v[68:71], a[192:207]
    v_mfma_f32_32x32x16_bf16 a[208:223], v[48:51], v[72:75], a[208:223]
    v_mfma_f32_32x32x16_bf16 a[224:239], v[48:51], v[76:79], a[224:239]
    v_mfma_f32_32x32x16_bf16 a[240:255], v[48:51], v[80:83], a[240:255]
    s_waitcnt vmcnt(8)
    s_barrier
    v_add_u32 v27, s60, v21
    v_add_u32 v28, s60, v22
    v_add_u32 v29, s60, v23
    v_add_u32 v30, s60, v24
    v_add_u32 v31, s60, v25
    v_add_u32 v32, s60, v26
    s_add_u32 s60, s60, 32768
    s_cmp_ge_u32 s60, 131072
    s_cselect_b32 s60, 0, s60
    s_waitcnt lgkmcnt(0)
    v_mfma_f32_32x32x16_bf16 a[0:15], v[52:55], v[84:87], a[0:15]
    ds_read_b64_tr_b16 v[36:37], v27 offset:0
    v_mfma_f32_32x32x16_bf16 a[16:31], v[52:55], v[88:91], a[16:31]
    ds_read_b64_tr_b16 v[38:39], v27 offset:2048
    v_mfma_f32_32x32x16_bf16 a[32:47], v[52:55], v[92:95], a[32:47]
    ds_read_b64_tr_b16 v[40:41], v28 offset:0
    v_mfma_f32_32x32x16_bf16 a[48:63], v[52:55], v[96:99], a[48:63]
    ds_read_b64_tr_b16 v[42:43], v28 offset:2048
    v_mfma_f32_32x32x16_bf16 a[64:79], v[56:59], v[84:87], a[64:79]
    ds_read_b64_tr_b16 v[44:45], v29 offset:0
    v_mfma_f32_32x32x16_bf16 a[80:95], v[56:59], v[88:91], a[80:95]
    ds_read_b64_tr_b16 v[46:47], v29 offset:2048
    v_mfma_f32_32x32x16_bf16 a[96:111], v[56:59], v[92:95], a[96:111]
    ds_read_b64_tr_b16 v[48:49], v30 offset:0
    v_mfma_f32_32x32x16_bf16 a[112:127], v[56:59], v[96:99], a[112:127]
    ds_read_b64_tr_b16 v[50:51], v30 offset:2048
    v_mfma_f32_32x32x16_bf16 a[128:143], v[60:63], v[84:87], a[128:143]
    ds_read_b128 v[68:71], v31 offset:0
    v_mfma_f32_32x32x16_bf16 a[144:159], v[60:63], v[88:91], a[144:159]
    ds_read_b128 v[72:75], v31 offset:2048
    v_mfma_f32_32x32x16_bf16 a[160:175], v[60:63], v[92:95], a[160:175]
    ds_read_b128 v[76:79], v31 offset:4096
    v_mfma_f32_32x32x16_bf16 a[176:191], v[60:63], v[96:99], a[176:191]
    ds_read_b128 v[80:83], v31 offset:6144
    v_mfma_f32_32x32x16_bf16 a[192:207], v[64:67], v[84:87], a[192:207]
    v_mfma_f32_32x32x16_bf16 a[208:223], v[64:67], v[88:91], a[208:223]
    v_mfma_f32_32x32x16_bf16 a[224:239], v[64:67], v[92:95], a[224:239]
    v_mfma_f32_32x32x16_bf16 a[240:255], v[64:67], v[96:99], a[240:255]
    s_waitcnt lgkmcnt(0)
    v_mfma_f32_32x32x16_bf16 a[0:15], v[36:39], v[68:71], a[0:15]
    ds_read_b64_tr_b16 v[52:53], v27 offset:8192
    v_mfma_f32_32x32x16_bf16 a[16:31], v[36:39], v[72:75], a[16:31]
    ds_read_b64_tr_b16 v[54:55], v27 offset:10240
    v_mfma_f32_32x32x16_bf16 a[32:47], v[36:39], v[76:79], a[32:47]
    ds_read_b64_tr_b16 v[56:57], v28 offset:8192
    v_mfma_f32_32x32x16_bf16 a[48:63], v[36:39], v[80:83], a[48:63]
    ds_read_b64_tr_b16 v[58:59], v28 offset:10240
    v_mfma_f32_32x32x16_bf16 a[64:79], v[40:43], v[68:71], a[64:79]
    ds_read_b64_tr_b16 v[60:61], v29 offset:8192
    v_mfma_f32_32x32x16_bf16 a[80:95], v[40:43], v[72:75], a[80:95]
    ds_read_b64_tr_b16 v[62:63], v29 offset:10240
    v_mfma_f32_32x32x16_bf16 a[96:111], v[40:43], v[76:79], a[96:111]
    ds_read_b64_tr_b16 v[64:65], v30 offset:8192
    v_mfma_f32_32x32x16_bf16 a[112:127], v[40:43], v[80:83], a[112:127]
    ds_read_b64_tr_b16 v[66:67], v30 offset:10240
    v_mfma_f32_32x32x16_bf16 a[128:143], v[44:47], v[68:71], a[128:143]
    ds_read_b128 v[84:87], v32 offset:0
    v_mfma_f32_32x32x16_bf16 a[144:159], v[44:47], v[72:75], a[144:159]
    ds_read_b128 v[88:91], v32 offset:2048
    v_mfma_f32_32x32x16_bf16 a[160:175], v[44:47], v[76:79], a[160:175]
    ds_read_b128 v[92:95], v32 offset:4096
    v_mfma_f32_32x32x16_bf16 a[176:191], v[44:47], v[80:83], a[176:191]
    ds_read_b128 v[96:99], v32 offset:6144
    v_mfma_f32_32x32x16_bf16 a[192:207], v[48:51], v[68:71], a[192:207]
    v_mfma_f32_32x32x16_bf16 a[208:223], v[48:51], v[72:75], a[208:223]
    v_mfma_f32_32x32x16_bf16 a[224:239], v[48:51], v[76:79], a[224:239]
    v_mfma_f32_32x32x16_bf16 a[240:255], v[48:51], v[80:83], a[240:255]
    s_waitcnt vmcnt(0)
    s_barrier
    v_add_u32 v27, s60, v21
    v_add_u32 v28, s60, v22
    v_add_u32 v29, s60, v23
    v_add_u32 v30, s60, v24
    v_add_u32 v31, s60, v25
    v_add_u32 v32, s60, v26
    s_add_u32 s60, s60, 32768
    s_cmp_ge_u32 s60, 131072
    s_cselect_b32 s60, 0, s60
    s_waitcnt lgkmcnt(0)
    v_mfma_f32_32x32x16_bf16 a[0:15], v[52:55], v[84:87], a[0:15]
    ds_read_b64_tr_b16 v[36:37], v27 offset:0
    v_mfma_f32_32x32x16_bf16 a[16:31], v[52:55], v[88:91], a[16:31]
    ds_read_b64_tr_b16 v[38:39], v27 offset:2048
    v_mfma_f32_32x32x16_bf16 a[32:47], v[52:55], v[92:95], a[32:47]
    ds_read_b64_tr_b16 v[40:41], v28 offset:0
    v_mfma_f32_32x32x16_bf16 a[48:63], v[52:55], v[96:99], a[48:63]
    ds_read_b64_tr_b16 v[42:43], v28 offset:2048
    v_mfma_f32_32x32x16_bf16 a[64:79], v[56:59], v[84:87], a[64:79]
    ds_read_b64_tr_b16 v[44:45], v29 offset:0
    v_mfma_f32_32x32x16_bf16 a[80:95], v[56:59], v[88:91], a[80:95]
    ds_read_b64_tr_b16 v[46:47], v29 offset:2048
    v_mfma_f32_32x32x16_bf16 a[96:111], v[56:59], v[92:95], a[96:111]
    ds_read_b64_tr_b16 v[48:49], v30 offset:0
    v_mfma_f32_32x32x16_bf16 a[112:127], v[56:59], v[96:99], a[112:127]
    ds_read_b64_tr_b16 v[50:51], v30 offset:2048
    v_mfma_f32_32x32x16_bf16 a[128:143], v[60:63], v[84:87], a[128:143]
    ds_read_b128 v[68:71], v31 offset:0
    v_mfma_f32_32x32x16_bf16 a[144:159], v[60:63], v[88:91], a[144:159]
    ds_read_b128 v[72:75], v31 offset:2048
    v_mfma_f32_32x32x16_bf16 a[160:175], v[60:63], v[92:95], a[160:175]
    ds_read_b128 v[76:79], v31 offset:4096
    v_mfma_f32_32x32x16_bf16 a[176:191], v[60:63], v[96:99], a[176:191]
    ds_read_b128 v[80:83], v31 offset:6144
    v_mfma_f32_32x32x16_bf16 a[192:207], v[64:67], v[84:87], a[192:207]
    v_mfma_f32_32x32x16_bf16 a[208:223], v[64:67], v[88:91], a[208:223]
    v_mfma_f32_32x32x16_bf16 a[224:239], v[64:67], v[92:95], a[224:239]
    v_mfma_f32_32x32x16_bf16 a[240:255], v[64:67], v[96:99], a[240:255]
    s_waitcnt lgkmcnt(0)
    v_mfma_f32_32x32x16_bf16 a[0:15], v[36:39], v[68:71], a[0:15]
    ds_read_b64_tr_b16 v[52:53], v27 offset:8192
    v_mfma_f32_32x32x16_bf16 a[16:31], v[36:39], v[72:75], a[16:31]
    ds_read_b64_tr_b16 v[54:55], v27 offset:10240
    v_mfma_f32_32x32x16_bf16 a[32:47], v[36:39], v[76:79], a[32:47]
    ds_read_b64_tr_b16 v[56:57], v28 offset:8192
    v_mfma_f32_32x32x16_bf16 a[48:63], v[36:39], v[80:83], a[48:63]
    ds_read_b64_tr_b16 v[58:59], v28 offset:10240
    v_mfma_f32_32x32x16_bf16 a[64:79], v[40:43], v[68:71], a[64:79]
    ds_read_b64_tr_b16 v[60:61], v29 offset:8192
    v_mfma_f32_32x32x16_bf16 a[80:95], v[40:43], v[72:75], a[80:95]
    ds_read_b64_tr_b16 v[62:63], v29 offset:10240
    v_mfma_f32_32x32x16_bf16 a[96:111], v[40:43], v[76:79], a[96:111]
    ds_read_b64_tr_b16 v[64:65], v30 offset:8192
    v_mfma_f32_32x32x16_bf16 a[112:127], v[40:43], v[80:83], a[112:127]
    ds_read_b64_tr_b16 v[66:67], v30 offset:10240
    v_mfma_f32_32x32x16_bf16 a[128:143], v[44:47], v[68:71], a[128:143]
    ds_read_b128 v[84:87], v32 offset:0
    v_mfma_f32_32x32x16_bf16 a[144:159], v[44:47], v[72:75], a[144:159]
    ds_read_b128 v[88:91], v32 offset:2048
    v_mfma_f32_32x32x16_bf16 a[160:175], v[44:47], v[76:79], a[160:175]
    ds_read_b128 v[92:95], v32 offset:4096
    v_mfma_f32_32x32x16_bf16 a[176:191], v[44:47], v[80:83], a[176:191]
    ds_read_b128 v[96:99], v32 offset:6144
    v_mfma_f32_32x32x16_bf16 a[192:207], v[48:51], v[68:71], a[192:207]
    v_mfma_f32_32x32x16_bf16 a[208:223], v[48:51], v[72:75], a[208:223]
    v_mfma_f32_32x32x16_bf16 a[224:239], v[48:51], v[76:79], a[224:239]
    v_mfma_f32_32x32x16_bf16 a[240:255], v[48:51], v[80:83], a[240:255]
    s_waitcnt lgkmcnt(0)
    v_mfma_f32_32x32x16_bf16 a[0:15], v[52:55], v[84:87], a[0:15]
    v_mfma_f32_32x32x16_bf16 a[16:31], v[52:55], v[88:91], a[16:31]
    v_mfma_f32_32x32x16_bf16 a[32:47], v[52:55], v[92:95], a[32:47]
    v_mfma_f32_32x32x16_bf16 a[48:63], v[52:55], v[96:99], a[48:63]
    v_mfma_f32_32x32x16_bf16 a[64:79], v[56:59], v[84:87], a[64:79]
    v_mfma_f32_32x32x16_bf16 a[80:95], v[56:59], v[88:91], a[80:95]
    v_mfma_f32_32x32x16_bf16 a[96:111], v[56:59], v[92:95], a[96:111]
    v_mfma_f32_32x32x16_bf16 a[112:127], v[56:59], v[96:99], a[112:127]
    v_mfma_f32_32x32x16_bf16 a[128:143], v[60:63], v[84:87], a[128:143]
    v_mfma_f32_32x32x16_bf16 a[144:159], v[60:63], v[88:91], a[144:159]
    v_mfma_f32_32x32x16_bf16 a[160:175], v[60:63], v[92:95], a[160:175]
    v_mfma_f32_32x32x16_bf16 a[176:191], v[60:63], v[96:99], a[176:191]
    v_mfma_f32_32x32x16_bf16 a[192:207], v[64:67], v[84:87], a[192:207]
    v_mfma_f32_32x32x16_bf16 a[208:223], v[64:67], v[88:91], a[208:223]
    v_mfma_f32_32x32x16_bf16 a[224:239], v[64:67], v[92:95], a[224:239]
    v_mfma_f32_32x32x16_bf16 a[240:255], v[64:67], v[96:99], a[240:255]
    s_barrier
    s_mul_i32 s64, s63, 34816
    v_and_b32 v10, 31, v8
    v_mul_u32_u24 v10, 272, v10
    v_lshrrev_b32 v11, 5, v8
    v_lshl_add_u32 v10, v11, 4, v10
    v_add_u32 v13, s64, v10
    v_lshrrev_b32 v10, 4, v8
    v_mul_u32_u24 v10, 272, v10
    v_and_b32 v11, 15, v8
    v_lshl_add_u32 v10, v11, 4, v10
    v_add_u32 v14, s64, v10
    v_accvgpr_read_b32 v36, a0
    v_accvgpr_read_b32 v37, a1
    v_accvgpr_read_b32 v38, a2
    v_accvgpr_read_b32 v39, a3
    v_accvgpr_read_b32 v40, a4
    v_accvgpr_read_b32 v41, a5
    v_accvgpr_read_b32 v42, a6
    v_accvgpr_read_b32 v43, a7
    v_accvgpr_read_b32 v44, a8
    v_accvgpr_read_b32 v45, a9
    v_accvgpr_read_b32 v46, a10
    v_accvgpr_read_b32 v47, a11
    v_accvgpr_read_b32 v48, a12
    v_accvgpr_read_b32 v49, a13
    v_accvgpr_read_b32 v50, a14
    v_accvgpr_read_b32 v51, a15
    v_cvt_pk_bf16_f32 v52, v36, v37
    v_cvt_pk_bf16_f32 v53, v38, v39
    v_cvt_pk_bf16_f32 v54, v40, v41
    v_cvt_pk_bf16_f32 v55, v42, v43
    v_cvt_pk_bf16_f32 v56, v44, v45
    v_cvt_pk_bf16_f32 v57, v46, v47
    v_cvt_pk_bf16_f32 v58, v48, v49
    v_cvt_pk_bf16_f32 v59, v50, v51
    v_permlane32_swap_b32 v52, v54
    v_permlane32_swap_b32 v53, v55
    v_permlane32_swap_b32 v56, v58
    v_permlane32_swap_b32 v57, v59
    ds_write_b128 v13, v[52:55] offset:0
    ds_write_b128 v13, v[56:59] offset:32
    v_accvgpr_read_b32 v60, a16
    v_accvgpr_read_b32 v61, a17
    v_accvgpr_read_b32 v62, a18
    v_accvgpr_read_b32 v63, a19
    v_accvgpr_read_b32 v64, a20
    v_accvgpr_read_b32 v65, a21
    v_accvgpr_read_b32 v66, a22
    v_accvgpr_read_b32 v67, a23
    v_accvgpr_read_b32 v68, a24
    v_accvgpr_read_b32 v69, a25
    v_accvgpr_read_b32 v70, a26
    v_accvgpr_read_b32 v71, a27
    v_accvgpr_read_b32 v72, a28
    v_accvgpr_read_b32 v73, a29
    v_accvgpr_read_b32 v74, a30
    v_accvgpr_read_b32 v75, a31
    v_cvt_pk_bf16_f32 v76, v60, v61
    v_cvt_pk_bf16_f32 v77, v62, v63
    v_cvt_pk_bf16_f32 v78, v64, v65
    v_cvt_pk_bf16_f32 v79, v66, v67
    v_cvt_pk_bf16_f32 v80, v68, v69
    v_cvt_pk_bf16_f32 v81, v70, v71
    v_cvt_pk_bf16_f32 v82, v72, v73
    v_cvt_pk_bf16_f32 v83, v74, v75
    v_permlane32_swap_b32 v76, v78
    v_permlane32_swap_b32 v77, v79
    v_permlane32_swap_b32 v80, v82
    v_permlane32_swap_b32 v81, v83
    ds_write_b128 v13, v[76:79] offset:8704
    ds_write_b128 v13, v[80:83] offset:8736
    v_accvgpr_read_b32 v36, a32
    v_accvgpr_read_b32 v37, a33
    v_accvgpr_read_b32 v38, a34
    v_accvgpr_read_b32 v39, a35
    v_accvgpr_read_b32 v40, a36
    v_accvgpr_read_b32 v41, a37
    v_accvgpr_read_b32 v42, a38
    v_accvgpr_read_b32 v43, a39
    v_accvgpr_read_b32 v44, a40
    v_accvgpr_read_b32 v45, a41
    v_accvgpr_read_b32 v46, a42
    v_accvgpr_read_b32 v47, a43
    v_accvgpr_read_b32 v48, a44
    v_accvgpr_read_b32 v49, a45
    v_accvgpr_read_b32 v50, a46
    v_accvgpr_read_b32 v51, a47
    v_cvt_pk_bf16_f32 v52, v36, v37
    v_cvt_pk_bf16_f32 v53, v38, v39
    v_cvt_pk_bf16_f32 v54, v40, v41
    v_cvt_pk_bf16_f32 v55, v42, v43
    v_cvt_pk_bf16_f32 v56, v44, v45
    v_cvt_pk_bf16_f32 v57, v46, v47
    v_cvt_pk_bf16_f32 v58, v48, v49
    v_cvt_pk_bf16_f32 v59, v50, v51
    v_permlane32_swap_b32 v52, v54
    v_permlane32_swap_b32 v53, v55
    v_permlane32_swap_b32 v56, v58
    v_permlane32_swap_b32 v57, v59
    ds_write_b128 v13, v[52:55] offset:17408
    ds_write_b128 v13, v[56:59] offset:17440
    v_accvgpr_read_b32 v60, a48
    v_accvgpr_read_b32 v61, a49
    v_accvgpr_read_b32 v62, a50
    v_accvgpr_read_b32 v63, a51
    v_accvgpr_read_b32 v64, a52
    v_accvgpr_read_b32 v65, a53
    v_accvgpr_read_b32 v66, a54
    v_accvgpr_read_b32 v67, a55
    v_accvgpr_read_b32 v68, a56
    v_accvgpr_read_b32 v69, a57
    v_accvgpr_read_b32 v70, a58
    v_accvgpr_read_b32 v71, a59
    v_accvgpr_read_b32 v72, a60
    v_accvgpr_read_b32 v73, a61
    v_accvgpr_read_b32 v74, a62
    v_accvgpr_read_b32 v75, a63
    v_cvt_pk_bf16_f32 v76, v60, v61
    v_cvt_pk_bf16_f32 v77, v62, v63
    v_cvt_pk_bf16_f32 v78, v64, v65
    v_cvt_pk_bf16_f32 v79, v66, v67
    v_cvt_pk_bf16_f32 v80, v68, v69
    v_cvt_pk_bf16_f32 v81, v70, v71
    v_cvt_pk_bf16_f32 v82, v72, v73
    v_cvt_pk_bf16_f32 v83, v74, v75
    v_permlane32_swap_b32 v76, v78
    v_permlane32_swap_b32 v77, v79
    v_permlane32_swap_b32 v80, v82
    v_permlane32_swap_b32 v81, v83
    ds_write_b128 v13, v[76:79] offset:26112
    ds_write_b128 v13, v[80:83] offset:26144
    v_accvgpr_read_b32 v36, a64
    v_accvgpr_read_b32 v37, a65
    v_accvgpr_read_b32 v38, a66
    v_accvgpr_read_b32 v39, a67
    v_accvgpr_read_b32 v40, a68
    v_accvgpr_read_b32 v41, a69
    v_accvgpr_read_b32 v42, a70
    v_accvgpr_read_b32 v43, a71
    v_accvgpr_read_b32 v44, a72
    v_accvgpr_read_b32 v45, a73
    v_accvgpr_read_b32 v46, a74
    v_accvgpr_read_b32 v47, a75
    v_accvgpr_read_b32 v48, a76
    v_accvgpr_read_b32 v49, a77
    v_accvgpr_read_b32 v50, a78
    v_accvgpr_read_b32 v51, a79
    v_cvt_pk_bf16_f32 v52, v36, v37
    v_cvt_pk_bf16_f32 v53, v38, v39
    v_cvt_pk_bf16_f32 v54, v40, v41
    v_cvt_pk_bf16_f32 v55, v42, v43
    v_cvt_pk_bf16_f32 v56, v44, v45
    v_cvt_pk_bf16_f32 v57, v46, v47
    v_cvt_pk_bf16_f32 v58, v48, v49
    v_cvt_pk_bf16_f32 v59, v50, v51
    v_permlane32_swap_b32 v52, v54
    v_permlane32_swap_b32 v53, v55
    v_permlane32_swap_b32 v56, v58
    v_permlane32_swap_b32 v57, v59
    ds_write_b128 v13, v[52:55] offset:64
    ds_write_b128 v13, v[56:59] offset:96
    v_accvgpr_read_b32 v60, a80
    v_accvgpr_read_b32 v61, a81
    v_accvgpr_read_b32 v62, a82
    v_accvgpr_read_b32 v63, a83
    v_accvgpr_read_b32 v64, a84
    v_accvgpr_read_b32 v65, a85
    v_accvgpr_read_b32 v66, a86
    v_accvgpr_read_b32 v67, a87
    v_accvgpr_read_b32 v68, a88
    v_accvgpr_read_b32 v69, a89
    v_accvgpr_read_b32 v70, a90
    v_accvgpr_read_b32 v71, a91
    v_accvgpr_read_b32 v72, a92
    v_accvgpr_read_b32 v73, a93
    v_accvgpr_read_b32 v74, a94
    v_accvgpr_read_b32 v75, a95
    v_cvt_pk_bf16_f32 v76, v60, v61
    v_cvt_pk_bf16_f32 v77, v62, v63
    v_cvt_pk_bf16_f32 v78, v64, v65
    v_cvt_pk_bf16_f32 v79, v66, v67
    v_cvt_pk_bf16_f32 v80, v68, v69
    v_cvt_pk_bf16_f32 v81, v70, v71
    v_cvt_pk_bf16_f32 v82, v72, v73
    v_cvt_pk_bf16_f32 v83, v74, v75
    v_permlane32_swap_b32 v76, v78
    v_permlane32_swap_b32 v77, v79
    v_permlane32_swap_b32 v80, v82
    v_permlane32_swap_b32 v81, v83
    ds_write_b128 v13, v[76:79] offset:8768
    ds_write_b128 v13, v[80:83] offset:8800
    v_accvgpr_read_b32 v36, a96
    v_accvgpr_read_b32 v37, a97
    v_accvgpr_read_b32 v38, a98
    v_accvgpr_read_b32 v39, a99
    v_accvgpr_read_b32 v40, a100
    v_accvgpr_read_b32 v41, a101
    v_accvgpr_read_b32 v42, a102
    v_accvgpr_read_b32 v43, a103
    v_accvgpr_read_b32 v44, a104
    v_accvgpr_read_b32 v45, a105
    v_accvgpr_read_b32 v46, a106
    v_accvgpr_read_b32 v47, a107
    v_accvgpr_read_b32 v48, a108
    v_accvgpr_read_b32 v49, a109
    v_accvgpr_read_b32 v50, a110
    v_accvgpr_read_b32 v51, a111
    v_cvt_pk_bf16_f32 v52, v36, v37
    v_cvt_pk_bf16_f32 v53, v38, v39
    v_cvt_pk_bf16_f32 v54, v40, v41
    v_cvt_pk_bf16_f32 v55, v42, v43
    v_cvt_pk_bf16_f32 v56, v44, v45
    v_cvt_pk_bf16_f32 v57, v46, v47
    v_cvt_pk_bf16_f32 v58, v48, v49
    v_cvt_pk_bf16_f32 v59, v50, v51
    v_permlane32_swap_b32 v52, v54
    v_permlane32_swap_b32 v53, v55
    v_permlane32_swap_b32 v56, v58
    v_permlane32_swap_b32 v57, v59
    ds_write_b128 v13, v[52:55] offset:17472
    ds_write_b128 v13, v[56:59] offset:17504
    v_accvgpr_read_b32 v60, a112
    v_accvgpr_read_b32 v61, a113
    v_accvgpr_read_b32 v62, a114
    v_accvgpr_read_b32 v63, a115
    v_accvgpr_read_b32 v64, a116
    v_accvgpr_read_b32 v65, a117
    v_accvgpr_read_b32 v66, a118
    v_accvgpr_read_b32 v67, a119
    v_accvgpr_read_b32 v68, a120
    v_accvgpr_read_b32 v69, a121
    v_accvgpr_read_b32 v70, a122
    v_accvgpr_read_b32 v71, a123
    v_accvgpr_read_b32 v72, a124
    v_accvgpr_read_b32 v73, a125
    v_accvgpr_read_b32 v74, a126
    v_accvgpr_read_b32 v75, a127
    v_cvt_pk_bf16_f32 v76, v60, v61
    v_cvt_pk_bf16_f32 v77, v62, v63
    v_cvt_pk_bf16_f32 v78, v64, v65
    v_cvt_pk_bf16_f32 v79, v66, v67
    v_cvt_pk_bf16_f32 v80, v68, v69
    v_cvt_pk_bf16_f32 v81, v70, v71
    v_cvt_pk_bf16_f32 v82, v72, v73
    v_cvt_pk_bf16_f32 v83, v74, v75
    v_permlane32_swap_b32 v76, v78
    v_permlane32_swap_b32 v77, v79
    v_permlane32_swap_b32 v80, v82
    v_permlane32_swap_b32 v81, v83
    ds_write_b128 v13, v[76:79] offset:26176
    ds_write_b128 v13, v[80:83] offset:26208
    v_accvgpr_read_b32 v36, a128
    v_accvgpr_read_b32 v37, a129
    v_accvgpr_read_b32 v38, a130
    v_accvgpr_read_b32 v39, a131
    v_accvgpr_read_b32 v40, a132
    v_accvgpr_read_b32 v41, a133
    v_accvgpr_read_b32 v42, a134
    v_accvgpr_read_b32 v43, a135
    v_accvgpr_read_b32 v44, a136
    v_accvgpr_read_b32 v45, a137
    v_accvgpr_read_b32 v46, a138
    v_accvgpr_read_b32 v47, a139
    v_accvgpr_read_b32 v48, a140
    v_accvgpr_read_b32 v49, a141
    v_accvgpr_read_b32 v50, a142
    v_accvgpr_read_b32 v51, a143
    v_cvt_pk_bf16_f32 v52, v36, v37
    v_cvt_pk_bf16_f32 v53, v38, v39
    v_cvt_pk_bf16_f32 v54, v40, v41
    v_cvt_pk_bf16_f32 v55, v42, v43
    v_cvt_pk_bf16_f32 v56, v44, v45
    v_cvt_pk_bf16_f32 v57, v46, v47
    v_cvt_pk_bf16_f32 v58, v48, v49
    v_cvt_pk_bf16_f32 v59, v50, v51
    v_permlane32_swap_b32 v52, v54
    v_permlane32_swap_b32 v53, v55
    v_permlane32_swap_b32 v56, v58
    v_permlane32_swap_b32 v57, v59
    ds_write_b128 v13, v[52:55] offset:128
    ds_write_b128 v13, v[56:59] offset:160
    v_accvgpr_read_b32 v60, a144
    v_accvgpr_read_b32 v61, a145
    v_accvgpr_read_b32 v62, a146
    v_accvgpr_read_b32 v63, a147
    v_accvgpr_read_b32 v64, a148
    v_accvgpr_read_b32 v65, a149
    v_accvgpr_read_b32 v66, a150
    v_accvgpr_read_b32 v67, a151
    v_accvgpr_read_b32 v68, a152
    v_accvgpr_read_b32 v69, a153
    v_accvgpr_read_b32 v70, a154
    v_accvgpr_read_b32 v71, a155
    v_accvgpr_read_b32 v72, a156
    v_accvgpr_read_b32 v73, a157
    v_accvgpr_read_b32 v74, a158
    v_accvgpr_read_b32 v75, a159
    v_cvt_pk_bf16_f32 v76, v60, v61
    v_cvt_pk_bf16_f32 v77, v62, v63
    v_cvt_pk_bf16_f32 v78, v64, v65
    v_cvt_pk_bf16_f32 v79, v66, v67
    v_cvt_pk_bf16_f32 v80, v68, v69
    v_cvt_pk_bf16_f32 v81, v70, v71
    v_cvt_pk_bf16_f32 v82, v72, v73
    v_cvt_pk_bf16_f32 v83, v74, v75
    v_permlane32_swap_b32 v76, v78
    v_permlane32_swap_b32 v77, v79
    v_permlane32_swap_b32 v80, v82
    v_permlane32_swap_b32 v81, v83
    ds_write_b128 v13, v[76:79] offset:8832
    ds_write_b128 v13, v[80:83] offset:8864
    v_accvgpr_read_b32 v36, a160
    v_accvgpr_read_b32 v37, a161
    v_accvgpr_read_b32 v38, a162
    v_accvgpr_read_b32 v39, a163
    v_accvgpr_read_b32 v40, a164
    v_accvgpr_read_b32 v41, a165
    v_accvgpr_read_b32 v42, a166
    v_accvgpr_read_b32 v43, a167
    v_accvgpr_read_b32 v44, a168
    v_accvgpr_read_b32 v45, a169
    v_accvgpr_read_b32 v46, a170
    v_accvgpr_read_b32 v47, a171
    v_accvgpr_read_b32 v48, a172
    v_accvgpr_read_b32 v49, a173
    v_accvgpr_read_b32 v50, a174
    v_accvgpr_read_b32 v51, a175
    v_cvt_pk_bf16_f32 v52, v36, v37
    v_cvt_pk_bf16_f32 v53, v38, v39
    v_cvt_pk_bf16_f32 v54, v40, v41
    v_cvt_pk_bf16_f32 v55, v42, v43
    v_cvt_pk_bf16_f32 v56, v44, v45
    v_cvt_pk_bf16_f32 v57, v46, v47
    v_cvt_pk_bf16_f32 v58, v48, v49
    v_cvt_pk_bf16_f32 v59, v50, v51
    v_permlane32_swap_b32 v52, v54
    v_permlane32_swap_b32 v53, v55
    v_permlane32_swap_b32 v56, v58
    v_permlane32_swap_b32 v57, v59
    ds_write_b128 v13, v[52:55] offset:17536
    ds_write_b128 v13, v[56:59] offset:17568
    v_accvgpr_read_b32 v60, a176
    v_accvgpr_read_b32 v61, a177
    v_accvgpr_read_b32 v62, a178
    v_accvgpr_read_b32 v63, a179
    v_accvgpr_read_b32 v64, a180
    v_accvgpr_read_b32 v65, a181
    v_accvgpr_read_b32 v66, a182
    v_accvgpr_read_b32 v67, a183
    v_accvgpr_read_b32 v68, a184
    v_accvgpr_read_b32 v69, a185
    v_accvgpr_read_b32 v70, a186
    v_accvgpr_read_b32 v71, a187
    v_accvgpr_read_b32 v72, a188
    v_accvgpr_read_b32 v73, a189
    v_accvgpr_read_b32 v74, a190
    v_accvgpr_read_b32 v75, a191
    v_cvt_pk_bf16_f32 v76, v60, v61
    v_cvt_pk_bf16_f32 v77, v62, v63
    v_cvt_pk_bf16_f32 v78, v64, v65
    v_cvt_pk_bf16_f32 v79, v66, v67
    v_cvt_pk_bf16_f32 v80, v68, v69
    v_cvt_pk_bf16_f32 v81, v70, v71
    v_cvt_pk_bf16_f32 v82, v72, v73
    v_cvt_pk_bf16_f32 v83, v74, v75
    v_permlane32_swap_b32 v76, v78
    v_permlane32_swap_b32 v77, v79
    v_permlane32_swap_b32 v80, v82
    v_permlane32_swap_b32 v81, v83
    ds_write_b128 v13, v[76:79] offset:26240
    ds_write_b128 v13, v[80:83] offset:26272
    v_accvgpr_read_b32 v36, a192
    v_accvgpr_read_b32 v37, a193
    v_accvgpr_read_b32 v38, a194
    v_accvgpr_read_b32 v39, a195
    v_accvgpr_read_b32 v40, a196
    v_accvgpr_read_b32 v41, a197
    v_accvgpr_read_b32 v42, a198
    v_accvgpr_read_b32 v43, a199
    v_accvgpr_read_b32 v44, a200
    v_accvgpr_read_b32 v45, a201
    v_accvgpr_read_b32 v46, a202
    v_accvgpr_read_b32 v47, a203
    v_accvgpr_read_b32 v48, a204
    v_accvgpr_read_b32 v49, a205
    v_accvgpr_read_b32 v50, a206
    v_accvgpr_read_b32 v51, a207
    v_cvt_pk_bf16_f32 v52, v36, v37
    v_cvt_pk_bf16_f32 v53, v38, v39
    v_cvt_pk_bf16_f32 v54, v40, v41
    v_cvt_pk_bf16_f32 v55, v42, v43
    v_cvt_pk_bf16_f32 v56, v44, v45
    v_cvt_pk_bf16_f32 v57, v46, v47
    v_cvt_pk_bf16_f32 v58, v48, v49
    v_cvt_pk_bf16_f32 v59, v50, v51
    v_permlane32_swap_b32 v52, v54
    v_permlane32_swap_b32 v53, v55
    v_permlane32_swap_b32 v56, v58
    v_permlane32_swap_b32 v57, v59
    ds_write_b128 v13, v[52:55] offset:192
    ds_write_b128 v13, v[56:59] offset:224
    v_accvgpr_read_b32 v60, a208
    v_accvgpr_read_b32 v61, a209
    v_accvgpr_read_b32 v62, a210
    v_accvgpr_read_b32 v63, a211
    v_accvgpr_read_b32 v64, a212
    v_accvgpr_read_b32 v65, a213
    v_accvgpr_read_b32 v66, a214
    v_accvgpr_read_b32 v67, a215
    v_accvgpr_read_b32 v68, a216
    v_accvgpr_read_b32 v69, a217
    v_accvgpr_read_b32 v70, a218
    v_accvgpr_read_b32 v71, a219
    v_accvgpr_read_b32 v72, a220
    v_accvgpr_read_b32 v73, a221
    v_accvgpr_read_b32 v74, a222
    v_accvgpr_read_b32 v75, a223
    v_cvt_pk_bf16_f32 v76, v60, v61
    v_cvt_pk_bf16_f32 v77, v62, v63
    v_cvt_pk_bf16_f32 v78, v64, v65
    v_cvt_pk_bf16_f32 v79, v66, v67
    v_cvt_pk_bf16_f32 v80, v68, v69
    v_cvt_pk_bf16_f32 v81, v70, v71
    v_cvt_pk_bf16_f32 v82, v72, v73
    v_cvt_pk_bf16_f32 v83, v74, v75
    v_permlane32_swap_b32 v76, v78
    v_permlane32_swap_b32 v77, v79
    v_permlane32_swap_b32 v80, v82
    v_permlane32_swap_b32 v81, v83
    ds_write_b128 v13, v[76:79] offset:8896
    ds_write_b128 v13, v[80:83] offset:8928
    v_accvgpr_read_b32 v36, a224
    v_accvgpr_read_b32 v37, a225
    v_accvgpr_read_b32 v38, a226
    v_accvgpr_read_b32 v39, a227
    v_accvgpr_read_b32 v40, a228
    v_accvgpr_read_b32 v41, a229
    v_accvgpr_read_b32 v42, a230
    v_accvgpr_read_b32 v43, a231
    v_accvgpr_read_b32 v44, a232
    v_accvgpr_read_b32 v45, a233
    v_accvgpr_read_b32 v46, a234
    v_accvgpr_read_b32 v47, a235
    v_accvgpr_read_b32 v48, a236
    v_accvgpr_read_b32 v49, a237
    v_accvgpr_read_b32 v50, a238
    v_accvgpr_read_b32 v51, a239
    v_cvt_pk_bf16_f32 v52, v36, v37
    v_cvt_pk_bf16_f32 v53, v38, v39
    v_cvt_pk_bf16_f32 v54, v40, v41
    v_cvt_pk_bf16_f32 v55, v42, v43
    v_cvt_pk_bf16_f32 v56, v44, v45
    v_cvt_pk_bf16_f32 v57, v46, v47
    v_cvt_pk_bf16_f32 v58, v48, v49
    v_cvt_pk_bf16_f32 v59, v50, v51
    v_permlane32_swap_b32 v52, v54
    v_permlane32_swap_b32 v53, v55
    v_permlane32_swap_b32 v56, v58
    v_permlane32_swap_b32 v57, v59
    ds_write_b128 v13, v[52:55] offset:17600
    ds_write_b128 v13, v[56:59] offset:17632
    v_accvgpr_read_b32 v60, a240
    v_accvgpr_read_b32 v61, a241
    v_accvgpr_read_b32 v62, a242
    v_accvgpr_read_b32 v63, a243
    v_accvgpr_read_b32 v64, a244
    v_accvgpr_read_b32 v65, a245
    v_accvgpr_read_b32 v66, a246
    v_accvgpr_read_b32 v67, a247
    v_accvgpr_read_b32 v68, a248
    v_accvgpr_read_b32 v69, a249
    v_accvgpr_read_b32 v70, a250
    v_accvgpr_read_b32 v71, a251
    v_accvgpr_read_b32 v72, a252
    v_accvgpr_read_b32 v73, a253
    v_accvgpr_read_b32 v74, a254
    v_accvgpr_read_b32 v75, a255
    v_cvt_pk_bf16_f32 v76, v60, v61
    v_cvt_pk_bf16_f32 v77, v62, v63
    v_cvt_pk_bf16_f32 v78, v64, v65
    v_cvt_pk_bf16_f32 v79, v66, v67
    v_cvt_pk_bf16_f32 v80, v68, v69
    v_cvt_pk_bf16_f32 v81, v70, v71
    v_cvt_pk_bf16_f32 v82, v72, v73
    v_cvt_pk_bf16_f32 v83, v74, v75
    v_permlane32_swap_b32 v76, v78
    v_permlane32_swap_b32 v77, v79
    v_permlane32_swap_b32 v80, v82
    v_permlane32_swap_b32 v81, v83
    ds_write_b128 v13, v[76:79] offset:26304
    ds_write_b128 v13, v[80:83] offset:26336
    v_lshrrev_b32 v11, 1, v9
    v_mul_u32_u24 v11, 256, v11
    v_and_b32 v12, 15, v8
    v_lshl_add_u32 v15, v12, 4, v11
    v_and_b32 v10, 1, v9
    v_mul_u32_u24 v10, 128, v10
    v_lshrrev_b32 v11, 4, v8
    v_add_u32 v16, v10, v11
    s_waitcnt lgkmcnt(0)
    s_mov_b32 s64, 8192
    ds_read_b128 v[36:39], v14 offset:0
    ds_read_b128 v[40:43], v14 offset:1088
    ds_read_b128 v[44:47], v14 offset:2176
    ds_read_b128 v[48:51], v14 offset:3264
    ds_read_b128 v[52:55], v14 offset:4352
    ds_read_b128 v[56:59], v14 offset:5440
    ds_read_b128 v[60:63], v14 offset:6528
    ds_read_b128 v[64:67], v14 offset:7616
    v_add_u32 v68, 0, v16
    v_mul_lo_u32 v68, v68, s64
    v_add_u32 v68, v68, v15
    v_add_u32 v69, 4, v16
    v_mul_lo_u32 v69, v69, s64
    v_add_u32 v69, v69, v15
    v_add_u32 v70, 8, v16
    v_mul_lo_u32 v70, v70, s64
    v_add_u32 v70, v70, v15
    v_add_u32 v71, 12, v16
    v_mul_lo_u32 v71, v71, s64
    v_add_u32 v71, v71, v15
    v_add_u32 v72, 16, v16
    v_mul_lo_u32 v72, v72, s64
    v_add_u32 v72, v72, v15
    v_add_u32 v73, 20, v16
    v_mul_lo_u32 v73, v73, s64
    v_add_u32 v73, v73, v15
    v_add_u32 v74, 24, v16
    v_mul_lo_u32 v74, v74, s64
    v_add_u32 v74, v74, v15
    v_add_u32 v75, 28, v16
    v_mul_lo_u32 v75, v75, s64
    v_add_u32 v75, v75, v15
    s_waitcnt lgkmcnt(7)
    buffer_store_dwordx4 v[36:39], v68, s[52:55], s68 offen sc1
    s_waitcnt lgkmcnt(6)
    buffer_store_dwordx4 v[40:43], v69, s[52:55], s68 offen sc1
    s_waitcnt lgkmcnt(5)
    buffer_store_dwordx4 v[44:47], v70, s[52:55], s68 offen sc1
    s_waitcnt lgkmcnt(4)
    buffer_store_dwordx4 v[48:51], v71, s[52:55], s68 offen sc1
    s_waitcnt lgkmcnt(3)
    buffer_store_dwordx4 v[52:55], v72, s[52:55], s68 offen sc1
    s_waitcnt lgkmcnt(2)
    buffer_store_dwordx4 v[56:59], v73, s[52:55], s68 offen sc1
    s_waitcnt lgkmcnt(1)
    buffer_store_dwordx4 v[60:63], v74, s[52:55], s68 offen sc1
    s_waitcnt lgkmcnt(0)
    buffer_store_dwordx4 v[64:67], v75, s[52:55], s68 offen sc1
    ds_read_b128 v[36:39], v14 offset:8704
    ds_read_b128 v[40:43], v14 offset:9792
    ds_read_b128 v[44:47], v14 offset:10880
    ds_read_b128 v[48:51], v14 offset:11968
    ds_read_b128 v[52:55], v14 offset:13056
    ds_read_b128 v[56:59], v14 offset:14144
    ds_read_b128 v[60:63], v14 offset:15232
    ds_read_b128 v[64:67], v14 offset:16320
    v_add_u32 v68, 32, v16
    v_mul_lo_u32 v68, v68, s64
    v_add_u32 v68, v68, v15
    v_add_u32 v69, 36, v16
    v_mul_lo_u32 v69, v69, s64
    v_add_u32 v69, v69, v15
    v_add_u32 v70, 40, v16
    v_mul_lo_u32 v70, v70, s64
    v_add_u32 v70, v70, v15
    v_add_u32 v71, 44, v16
    v_mul_lo_u32 v71, v71, s64
    v_add_u32 v71, v71, v15
    v_add_u32 v72, 48, v16
    v_mul_lo_u32 v72, v72, s64
    v_add_u32 v72, v72, v15
    v_add_u32 v73, 52, v16
    v_mul_lo_u32 v73, v73, s64
    v_add_u32 v73, v73, v15
    v_add_u32 v74, 56, v16
    v_mul_lo_u32 v74, v74, s64
    v_add_u32 v74, v74, v15
    v_add_u32 v75, 60, v16
    v_mul_lo_u32 v75, v75, s64
    v_add_u32 v75, v75, v15
    s_waitcnt lgkmcnt(7)
    buffer_store_dwordx4 v[36:39], v68, s[52:55], s68 offen sc1
    s_waitcnt lgkmcnt(6)
    buffer_store_dwordx4 v[40:43], v69, s[52:55], s68 offen sc1
    s_waitcnt lgkmcnt(5)
    buffer_store_dwordx4 v[44:47], v70, s[52:55], s68 offen sc1
    s_waitcnt lgkmcnt(4)
    buffer_store_dwordx4 v[48:51], v71, s[52:55], s68 offen sc1
    s_waitcnt lgkmcnt(3)
    buffer_store_dwordx4 v[52:55], v72, s[52:55], s68 offen sc1
    s_waitcnt lgkmcnt(2)
    buffer_store_dwordx4 v[56:59], v73, s[52:55], s68 offen sc1
    s_waitcnt lgkmcnt(1)
    buffer_store_dwordx4 v[60:63], v74, s[52:55], s68 offen sc1
    s_waitcnt lgkmcnt(0)
    buffer_store_dwordx4 v[64:67], v75, s[52:55], s68 offen sc1
    ds_read_b128 v[36:39], v14 offset:17408
    ds_read_b128 v[40:43], v14 offset:18496
    ds_read_b128 v[44:47], v14 offset:19584
    ds_read_b128 v[48:51], v14 offset:20672
    ds_read_b128 v[52:55], v14 offset:21760
    ds_read_b128 v[56:59], v14 offset:22848
    ds_read_b128 v[60:63], v14 offset:23936
    ds_read_b128 v[64:67], v14 offset:25024
    v_add_u32 v68, 64, v16
    v_mul_lo_u32 v68, v68, s64
    v_add_u32 v68, v68, v15
    v_add_u32 v69, 68, v16
    v_mul_lo_u32 v69, v69, s64
    v_add_u32 v69, v69, v15
    v_add_u32 v70, 72, v16
    v_mul_lo_u32 v70, v70, s64
    v_add_u32 v70, v70, v15
    v_add_u32 v71, 76, v16
    v_mul_lo_u32 v71, v71, s64
    v_add_u32 v71, v71, v15
    v_add_u32 v72, 80, v16
    v_mul_lo_u32 v72, v72, s64
    v_add_u32 v72, v72, v15
    v_add_u32 v73, 84, v16
    v_mul_lo_u32 v73, v73, s64
    v_add_u32 v73, v73, v15
    v_add_u32 v74, 88, v16
    v_mul_lo_u32 v74, v74, s64
    v_add_u32 v74, v74, v15
    v_add_u32 v75, 92, v16
    v_mul_lo_u32 v75, v75, s64
    v_add_u32 v75, v75, v15
    s_waitcnt lgkmcnt(7)
    buffer_store_dwordx4 v[36:39], v68, s[52:55], s68 offen sc1
    s_waitcnt lgkmcnt(6)
    buffer_store_dwordx4 v[40:43], v69, s[52:55], s68 offen sc1
    s_waitcnt lgkmcnt(5)
    buffer_store_dwordx4 v[44:47], v70, s[52:55], s68 offen sc1
    s_waitcnt lgkmcnt(4)
    buffer_store_dwordx4 v[48:51], v71, s[52:55], s68 offen sc1
    s_waitcnt lgkmcnt(3)
    buffer_store_dwordx4 v[52:55], v72, s[52:55], s68 offen sc1
    s_waitcnt lgkmcnt(2)
    buffer_store_dwordx4 v[56:59], v73, s[52:55], s68 offen sc1
    s_waitcnt lgkmcnt(1)
    buffer_store_dwordx4 v[60:63], v74, s[52:55], s68 offen sc1
    s_waitcnt lgkmcnt(0)
    buffer_store_dwordx4 v[64:67], v75, s[52:55], s68 offen sc1
    ds_read_b128 v[36:39], v14 offset:26112
    ds_read_b128 v[40:43], v14 offset:27200
    ds_read_b128 v[44:47], v14 offset:28288
    ds_read_b128 v[48:51], v14 offset:29376
    ds_read_b128 v[52:55], v14 offset:30464
    ds_read_b128 v[56:59], v14 offset:31552
    ds_read_b128 v[60:63], v14 offset:32640
    ds_read_b128 v[64:67], v14 offset:33728
    v_add_u32 v68, 96, v16
    v_mul_lo_u32 v68, v68, s64
    v_add_u32 v68, v68, v15
    v_add_u32 v69, 100, v16
    v_mul_lo_u32 v69, v69, s64
    v_add_u32 v69, v69, v15
    v_add_u32 v70, 104, v16
    v_mul_lo_u32 v70, v70, s64
    v_add_u32 v70, v70, v15
    v_add_u32 v71, 108, v16
    v_mul_lo_u32 v71, v71, s64
    v_add_u32 v71, v71, v15
    v_add_u32 v72, 112, v16
    v_mul_lo_u32 v72, v72, s64
    v_add_u32 v72, v72, v15
    v_add_u32 v73, 116, v16
    v_mul_lo_u32 v73, v73, s64
    v_add_u32 v73, v73, v15
    v_add_u32 v74, 120, v16
    v_mul_lo_u32 v74, v74, s64
    v_add_u32 v74, v74, v15
    v_add_u32 v75, 124, v16
    v_mul_lo_u32 v75, v75, s64
    v_add_u32 v75, v75, v15
    s_waitcnt lgkmcnt(7)
    buffer_store_dwordx4 v[36:39], v68, s[52:55], s68 offen sc1
    s_waitcnt lgkmcnt(6)
    buffer_store_dwordx4 v[40:43], v69, s[52:55], s68 offen sc1
    s_waitcnt lgkmcnt(5)
    buffer_store_dwordx4 v[44:47], v70, s[52:55], s68 offen sc1
    s_waitcnt lgkmcnt(4)
    buffer_store_dwordx4 v[48:51], v71, s[52:55], s68 offen sc1
    s_waitcnt lgkmcnt(3)
    buffer_store_dwordx4 v[52:55], v72, s[52:55], s68 offen sc1
    s_waitcnt lgkmcnt(2)
    buffer_store_dwordx4 v[56:59], v73, s[52:55], s68 offen sc1
    s_waitcnt lgkmcnt(1)
    buffer_store_dwordx4 v[60:63], v74, s[52:55], s68 offen sc1
    s_waitcnt lgkmcnt(0)
    buffer_store_dwordx4 v[64:67], v75, s[52:55], s68 offen sc1
    s_waitcnt vmcnt(0)
    s_barrier
    v_mov_b32 v1, s75
    v_mov_b32 v2, 1
    v_cmp_eq_u32 vcc, 0, v0
    s_nop 0
    s_and_saveexec_b64 s[6:7], vcc
    s_cbranch_execz .sg_43
    global_atomic_add v1, v2, s[38:39]
.sg_43:
    s_mov_b64 exec, s[6:7]
    s_branch .work_8
.task_32:
    s_and_b32 s73, s72, 15
    s_lshr_b32 s75, s72, 4
    s_lshl_b32 s74, s75, 8
    s_lshl_b32 s75, s75, 2
    s_add_u32 s75, s75, 80
    s_branch .big_37
.task_30:
    s_mov_b32 s44, s40
    s_and_b32 s45, s41, 0xffff
    s_mov_b32 s46, 0xfe00000
    s_mov_b32 s47, 0x00020000
    s_mov_b32 s48, s18
    s_and_b32 s49, s19, 0xffff
    s_mov_b32 s50, 0x141000
    s_mov_b32 s51, 0x00020000
    s_mov_b32 s52, s20
    s_and_b32 s53, s21, 0xffff
    s_mov_b32 s54, 0x141000
    s_mov_b32 s55, 0x00020000
    s_lshl_b32 s73, s72, 3
    s_add_u32 s74, s73, 8
    s_min_u32 s74, s74, 1058
.pl_44:
    s_mov_b32 s75, s73
    s_cmp_ge_u32 s75, 400
    s_cbranch_scc1 .pp_45
    s_lshl_b32 s3, s75, 8
    v_add_u32 v1, s3, v0
    s_mov_b32 s4, 51200
    v_cmp_le_u32 s[6:7], s4, v1
    v_subrev_u32 v2, s4, v1
    s_nop 0
    v_cndmask_b32 v1, v1, v2, s[6:7]
    s_mov_b32 s4, 52429
    v_mul_lo_u32 v2, v1, s4
    v_lshrrev_b32 v2, 22, v2
    v_mul_u32_u24 v3, 80, v2
    v_sub_u32 v3, v1, v3
    v_lshlrev_b32 v3, 3, v3
    v_add_u32 v4, 0, v3
    v_cndmask_b32 v5, v2, v4, s[6:7]
    v_cndmask_b32 v6, v4, v2, s[6:7]
    s_movk_i32 s4, 320
    v_cmp_lt_u32 vcc, s4, v5
    v_subrev_u32 v7, s4, v5
    s_nop 0
    v_cndmask_b32 v7, v5, v7, vcc
    v_mul_u32_u24 v8, v7, v6
    s_mov_b32 s4, 0x66667
    v_lshlrev_b32 v9, 4, v8
    v_mul_hi_u32 v9, v9, s4
    v_mul_u32_u24 v9, 640, v9
    v_sub_u32 v8, v8, v9
    v_cvt_f32_u32 v8, v8
    v_mul_f32 v8, 0x3acccccd, v8
    v_cos_f32 v9, v8
    v_sin_f32 v10, v8
    s_nop 0
    v_sub_f32 v10, 0, v10
    v_cndmask_b32 v9, v9, v10, vcc
    v_cmp_eq_u32 s[8:9], 0, v5
    s_movk_i32 s4, 320
    v_cmp_eq_u32 s[10:11], s4, v5
    s_nop 0
    s_or_b64 s[8:9], s[8:9], s[10:11]
    v_mov_b32 v10, 0x3b4ccccd
    v_mov_b32 v11, 0x3acccccd
    v_cndmask_b32 v10, v10, v11, s[8:9]
    v_cndmask_b32 v10, 1.0, v10, s[6:7]
    v_mul_f32 v16, v9, v10
    v_add_u32 v4, 1, v3
    v_cndmask_b32 v5, v2, v4, s[6:7]
    v_cndmask_b32 v6, v4, v2, s[6:7]
    s_movk_i32 s4, 320
    v_cmp_lt_u32 vcc, s4, v5
    v_subrev_u32 v7, s4, v5
    s_nop 0
    v_cndmask_b32 v7, v5, v7, vcc
    v_mul_u32_u24 v8, v7, v6
    s_mov_b32 s4, 0x66667
    v_lshlrev_b32 v9, 4, v8
    v_mul_hi_u32 v9, v9, s4
    v_mul_u32_u24 v9, 640, v9
    v_sub_u32 v8, v8, v9
    v_cvt_f32_u32 v8, v8
    v_mul_f32 v8, 0x3acccccd, v8
    v_cos_f32 v9, v8
    v_sin_f32 v10, v8
    s_nop 0
    v_sub_f32 v10, 0, v10
    v_cndmask_b32 v9, v9, v10, vcc
    v_cmp_eq_u32 s[8:9], 0, v5
    s_movk_i32 s4, 320
    v_cmp_eq_u32 s[10:11], s4, v5
    s_nop 0
    s_or_b64 s[8:9], s[8:9], s[10:11]
    v_mov_b32 v10, 0x3b4ccccd
    v_mov_b32 v11, 0x3acccccd
    v_cndmask_b32 v10, v10, v11, s[8:9]
    v_cndmask_b32 v10, 1.0, v10, s[6:7]
    v_mul_f32 v17, v9, v10
    v_add_u32 v4, 2, v3
    v_cndmask_b32 v5, v2, v4, s[6:7]
    v_cndmask_b32 v6, v4, v2, s[6:7]
    s_movk_i32 s4, 320
    v_cmp_lt_u32 vcc, s4, v5
    v_subrev_u32 v7, s4, v5
    s_nop 0
    v_cndmask_b32 v7, v5, v7, vcc
    v_mul_u32_u24 v8, v7, v6
    s_mov_b32 s4, 0x66667
    v_lshlrev_b32 v9, 4, v8
    v_mul_hi_u32 v9, v9, s4
    v_mul_u32_u24 v9, 640, v9
    v_sub_u32 v8, v8, v9
    v_cvt_f32_u32 v8, v8
    v_mul_f32 v8, 0x3acccccd, v8
    v_cos_f32 v9, v8
    v_sin_f32 v10, v8
    s_nop 0
    v_sub_f32 v10, 0, v10
    v_cndmask_b32 v9, v9, v10, vcc
    v_cmp_eq_u32 s[8:9], 0, v5
    s_movk_i32 s4, 320
    v_cmp_eq_u32 s[10:11], s4, v5
    s_nop 0
    s_or_b64 s[8:9], s[8:9], s[10:11]
    v_mov_b32 v10, 0x3b4ccccd
    v_mov_b32 v11, 0x3acccccd
    v_cndmask_b32 v10, v10, v11, s[8:9]
    v_cndmask_b32 v10, 1.0, v10, s[6:7]
    v_mul_f32 v18, v9, v10
    v_add_u32 v4, 3, v3
    v_cndmask_b32 v5, v2, v4, s[6:7]
    v_cndmask_b32 v6, v4, v2, s[6:7]
    s_movk_i32 s4, 320
    v_cmp_lt_u32 vcc, s4, v5
    v_subrev_u32 v7, s4, v5
    s_nop 0
    v_cndmask_b32 v7, v5, v7, vcc
    v_mul_u32_u24 v8, v7, v6
    s_mov_b32 s4, 0x66667
    v_lshlrev_b32 v9, 4, v8
    v_mul_hi_u32 v9, v9, s4
    v_mul_u32_u24 v9, 640, v9
    v_sub_u32 v8, v8, v9
    v_cvt_f32_u32 v8, v8
    v_mul_f32 v8, 0x3acccccd, v8
    v_cos_f32 v9, v8
    v_sin_f32 v10, v8
    s_nop 0
    v_sub_f32 v10, 0, v10
    v_cndmask_b32 v9, v9, v10, vcc
    v_cmp_eq_u32 s[8:9], 0, v5
    s_movk_i32 s4, 320
    v_cmp_eq_u32 s[10:11], s4, v5
    s_nop 0
    s_or_b64 s[8:9], s[8:9], s[10:11]
    v_mov_b32 v10, 0x3b4ccccd
    v_mov_b32 v11, 0x3acccccd
    v_cndmask_b32 v10, v10, v11, s[8:9]
    v_cndmask_b32 v10, 1.0, v10, s[6:7]
    v_mul_f32 v19, v9, v10
    v_add_u32 v4, 4, v3
    v_cndmask_b32 v5, v2, v4, s[6:7]
    v_cndmask_b32 v6, v4, v2, s[6:7]
    s_movk_i32 s4, 320
    v_cmp_lt_u32 vcc, s4, v5
    v_subrev_u32 v7, s4, v5
    s_nop 0
    v_cndmask_b32 v7, v5, v7, vcc
    v_mul_u32_u24 v8, v7, v6
    s_mov_b32 s4, 0x66667
    v_lshlrev_b32 v9, 4, v8
    v_mul_hi_u32 v9, v9, s4
    v_mul_u32_u24 v9, 640, v9
    v_sub_u32 v8, v8, v9
    v_cvt_f32_u32 v8, v8
    v_mul_f32 v8, 0x3acccccd, v8
    v_cos_f32 v9, v8
    v_sin_f32 v10, v8
    s_nop 0
    v_sub_f32 v10, 0, v10
    v_cndmask_b32 v9, v9, v10, vcc
    v_cmp_eq_u32 s[8:9], 0, v5
    s_movk_i32 s4, 320
    v_cmp_eq_u32 s[10:11], s4, v5
    s_nop 0
    s_or_b64 s[8:9], s[8:9], s[10:11]
    v_mov_b32 v10, 0x3b4ccccd
    v_mov_b32 v11, 0x3acccccd
    v_cndmask_b32 v10, v10, v11, s[8:9]
    v_cndmask_b32 v10, 1.0, v10, s[6:7]
    v_mul_f32 v20, v9, v10
    v_add_u32 v4, 5, v3
    v_cndmask_b32 v5, v2, v4, s[6:7]
    v_cndmask_b32 v6, v4, v2, s[6:7]
    s_movk_i32 s4, 320
    v_cmp_lt_u32 vcc, s4, v5
    v_subrev_u32 v7, s4, v5
    s_nop 0
    v_cndmask_b32 v7, v5, v7, vcc
    v_mul_u32_u24 v8, v7, v6
    s_mov_b32 s4, 0x66667
    v_lshlrev_b32 v9, 4, v8
    v_mul_hi_u32 v9, v9, s4
    v_mul_u32_u24 v9, 640, v9
    v_sub_u32 v8, v8, v9
    v_cvt_f32_u32 v8, v8
    v_mul_f32 v8, 0x3acccccd, v8
    v_cos_f32 v9, v8
    v_sin_f32 v10, v8
    s_nop 0
    v_sub_f32 v10, 0, v10
    v_cndmask_b32 v9, v9, v10, vcc
    v_cmp_eq_u32 s[8:9], 0, v5
    s_movk_i32 s4, 320
    v_cmp_eq_u32 s[10:11], s4, v5
    s_nop 0
    s_or_b64 s[8:9], s[8:9], s[10:11]
    v_mov_b32 v10, 0x3b4ccccd
    v_mov_b32 v11, 0x3acccccd
    v_cndmask_b32 v10, v10, v11, s[8:9]
    v_cndmask_b32 v10, 1.0, v10, s[6:7]
    v_mul_f32 v21, v9, v10
    v_add_u32 v4, 6, v3
    v_cndmask_b32 v5, v2, v4, s[6:7]
    v_cndmask_b32 v6, v4, v2, s[6:7]
    s_movk_i32 s4, 320
    v_cmp_lt_u32 vcc, s4, v5
    v_subrev_u32 v7, s4, v5
    s_nop 0
    v_cndmask_b32 v7, v5, v7, vcc
    v_mul_u32_u24 v8, v7, v6
    s_mov_b32 s4, 0x66667
    v_lshlrev_b32 v9, 4, v8
    v_mul_hi_u32 v9, v9, s4
    v_mul_u32_u24 v9, 640, v9
    v_sub_u32 v8, v8, v9
    v_cvt_f32_u32 v8, v8
    v_mul_f32 v8, 0x3acccccd, v8
    v_cos_f32 v9, v8
    v_sin_f32 v10, v8
    s_nop 0
    v_sub_f32 v10, 0, v10
    v_cndmask_b32 v9, v9, v10, vcc
    v_cmp_eq_u32 s[8:9], 0, v5
    s_movk_i32 s4, 320
    v_cmp_eq_u32 s[10:11], s4, v5
    s_nop 0
    s_or_b64 s[8:9], s[8:9], s[10:11]
    v_mov_b32 v10, 0x3b4ccccd
    v_mov_b32 v11, 0x3acccccd
    v_cndmask_b32 v10, v10, v11, s[8:9]
    v_cndmask_b32 v10, 1.0, v10, s[6:7]
    v_mul_f32 v22, v9, v10
    v_add_u32 v4, 7, v3
    v_cndmask_b32 v5, v2, v4, s[6:7]
    v_cndmask_b32 v6, v4, v2, s[6:7]
    s_movk_i32 s4, 320
    v_cmp_lt_u32 vcc, s4, v5
    v_subrev_u32 v7, s4, v5
    s_nop 0
    v_cndmask_b32 v7, v5, v7, vcc
    v_mul_u32_u24 v8, v7, v6
    s_mov_b32 s4, 0x66667
    v_lshlrev_b32 v9, 4, v8
    v_mul_hi_u32 v9, v9, s4
    v_mul_u32_u24 v9, 640, v9
    v_sub_u32 v8, v8, v9
    v_cvt_f32_u32 v8, v8
    v_mul_f32 v8, 0x3acccccd, v8
    v_cos_f32 v9, v8
    v_sin_f32 v10, v8
    s_nop 0
    v_sub_f32 v10, 0, v10
    v_cndmask_b32 v9, v9, v10, vcc
    v_cmp_eq_u32 s[8:9], 0, v5
    s_movk_i32 s4, 320
    v_cmp_eq_u32 s[10:11], s4, v5
    s_nop 0
    s_or_b64 s[8:9], s[8:9], s[10:11]
    v_mov_b32 v10, 0x3b4ccccd
    v_mov_b32 v11, 0x3acccccd
    v_cndmask_b32 v10, v10, v11, s[8:9]
    v_cndmask_b32 v10, 1.0, v10, s[6:7]
    v_mul_f32 v23, v9, v10
    v_cvt_pk_bf16_f32 v24, v16, v17
    v_cvt_pk_bf16_f32 v25, v18, v19
    v_cvt_pk_bf16_f32 v26, v20, v21
    v_cvt_pk_bf16_f32 v27, v22, v23
    v_lshlrev_b32 v1, 4, v1
    v_mov_b32 v2, 0x5000000
    v_mov_b32 v3, 0x5100000
    v_cndmask_b32 v2, v2, v3, s[6:7]
    v_add_u32 v1, v1, v2
    buffer_store_dwordx4 v[24:27], v1, s[44:47], 0 offen sc1
    s_branch .pp_47
.pp_45:
    s_sub_u32 s75, s75, 400
    s_cmp_ge_u32 s75, 642
    s_cbranch_scc1 .pp_46
    s_lshl_b32 s3, s75, 8
    v_add_u32 v1, s3, v0
    s_mov_b32 s4, 0xcc2a
    s_mov_b32 s4, 13379961
    v_mul_hi_u32 v2, v1, s4
    v_mul_u32_u24 v3, 321, v2
    v_sub_u32 v3, v1, v3
    v_and_b32 v4, 31, v2
    v_bfe_u32 v5, v2, 5, 1
    v_lshrrev_b32 v6, 6, v2
    v_lshlrev_b32 v6, 3, v6
    v_lshl_add_u32 v6, v5, 2, v6
    v_lshl_add_u32 v4, v6, 5, v4
    v_mul_u32_u24 v4, 321, v4
    v_add_u32 v4, v4, v3
    v_lshlrev_b32 v4, 1, v4
    s_mov_b32 s4, 0
    buffer_load_ushort v8, v4, s[48:51], s4 offen
    buffer_load_ushort v12, v4, s[52:55], s4 offen
    s_mov_b32 s4, 20544
    buffer_load_ushort v9, v4, s[48:51], s4 offen
    buffer_load_ushort v13, v4, s[52:55], s4 offen
    s_mov_b32 s4, 41088
    buffer_load_ushort v10, v4, s[48:51], s4 offen
    buffer_load_ushort v14, v4, s[52:55], s4 offen
    s_mov_b32 s4, 61632
    buffer_load_ushort v11, v4, s[48:51], s4 offen
    buffer_load_ushort v15, v4, s[52:55], s4 offen
    s_waitcnt vmcnt(0)
    v_lshl_or_b32 v8, v12, 16, v8
    v_lshl_or_b32 v9, v13, 16, v9
    v_lshl_or_b32 v10, v14, 16, v10
    v_lshl_or_b32 v11, v15, 16, v11
    v_lshlrev_b32 v3, 13, v3
    v_lshl_add_u32 v3, v2, 4, v3
    s_mov_b32 s4, 0x5200000
    buffer_store_dwordx4 v[8:11], v3, s[44:47], s4 offen sc1
    s_branch .pp_47
.pp_46:
    s_sub_u32 s75, s75, 642
    s_lshl_b32 s3, s75, 8
    v_add_u32 v1, s3, v0
    v_lshrrev_b32 v2, 6, v1
    s_nop 0
    v_readfirstlane_b32 s5, v2
    v_and_b32 v3, 31, v0
    v_bfe_u32 v4, v0, 5, 1
    s_cmp_ge_u32 s5, 62
    s_cbranch_scc1 .c2e_48
    s_cmp_ge_u32 s5, 30
    s_cbranch_scc1 .c2t_50
    s_cmp_ge_u32 s5, 6
    s_cbranch_scc1 .c2b_49
    s_lshr_b32 s6, s5, 1
    s_and_b32 s7, s5, 1
    s_lshl_b32 s7, s7, 4
    v_lshl_add_u32 v5, v4, 3, s7
    v_add_u32 v6, 0, v5
    v_mul_u32_u24 v6, v6, v3
    v_and_b32 v6, 31, v6
    v_cvt_f32_u32 v6, v6
    v_mul_f32 v16, 0x3d000000, v6
    v_add_u32 v6, 1, v5
    v_mul_u32_u24 v6, v6, v3
    v_and_b32 v6, 31, v6
    v_cvt_f32_u32 v6, v6
    v_mul_f32 v17, 0x3d000000, v6
    v_add_u32 v6, 2, v5
    v_mul_u32_u24 v6, v6, v3
    v_and_b32 v6, 31, v6
    v_cvt_f32_u32 v6, v6
    v_mul_f32 v18, 0x3d000000, v6
    v_add_u32 v6, 3, v5
    v_mul_u32_u24 v6, v6, v3
    v_and_b32 v6, 31, v6
    v_cvt_f32_u32 v6, v6
    v_mul_f32 v19, 0x3d000000, v6
    v_add_u32 v6, 4, v5
    v_mul_u32_u24 v6, v6, v3
    v_and_b32 v6, 31, v6
    v_cvt_f32_u32 v6, v6
    v_mul_f32 v20, 0x3d000000, v6
    v_add_u32 v6, 5, v5
    v_mul_u32_u24 v6, v6, v3
    v_and_b32 v6, 31, v6
    v_cvt_f32_u32 v6, v6
    v_mul_f32 v21, 0x3d000000, v6
    v_add_u32 v6, 6, v5
    v_mul_u32_u24 v6, v6, v3
    v_and_b32 v6, 31, v6
    v_cvt_f32_u32 v6, v6
    v_mul_f32 v22, 0x3d000000, v6
    v_add_u32 v6, 7, v5
    v_mul_u32_u24 v6, v6, v3
    v_and_b32 v6, 31, v6
    v_cvt_f32_u32 v6, v6
    v_mul_f32 v23, 0x3d000000, v6
    s_branch .c2s_51
.c2b_49:
    s_sub_u32 s8, s5, 6
    s_lshr_b32 s6, s8, 3
    s_bfe_u32 s7, s8, 0x10002
    s_lshl_b32 s7, s7, 5
    v_add_u32 v3, s7, v3
    s_and_b32 s7, s8, 3
    s_lshl_b32 s7, s7, 4
    v_lshl_add_u32 v5, v4, 2, s7
    v_add_u32 v6, 0, v5
    v_mul_u32_u24 v6, v6, v3
    v_and_b32 v6, 63, v6
    v_cvt_f32_u32 v6, v6
    v_mul_f32 v16, 0x3c800000, v6
    v_add_u32 v6, 1, v5
    v_mul_u32_u24 v6, v6, v3
    v_and_b32 v6, 63, v6
    v_cvt_f32_u32 v6, v6
    v_mul_f32 v17, 0x3c800000, v6
    v_add_u32 v6, 2, v5
    v_mul_u32_u24 v6, v6, v3
    v_and_b32 v6, 63, v6
    v_cvt_f32_u32 v6, v6
    v_mul_f32 v18, 0x3c800000, v6
    v_add_u32 v6, 3, v5
    v_mul_u32_u24 v6, v6, v3
    v_and_b32 v6, 63, v6
    v_cvt_f32_u32 v6, v6
    v_mul_f32 v19, 0x3c800000, v6
    v_add_u32 v6, 8, v5
    v_mul_u32_u24 v6, v6, v3
    v_and_b32 v6, 63, v6
    v_cvt_f32_u32 v6, v6
    v_mul_f32 v20, 0x3c800000, v6
    v_add_u32 v6, 9, v5
    v_mul_u32_u24 v6, v6, v3
    v_and_b32 v6, 63, v6
    v_cvt_f32_u32 v6, v6
    v_mul_f32 v21, 0x3c800000, v6
    v_add_u32 v6, 10, v5
    v_mul_u32_u24 v6, v6, v3
    v_and_b32 v6, 63, v6
    v_cvt_f32_u32 v6, v6
    v_mul_f32 v22, 0x3c800000, v6
    v_add_u32 v6, 11, v5
    v_mul_u32_u24 v6, v6, v3
    v_and_b32 v6, 63, v6
    v_cvt_f32_u32 v6, v6
    v_mul_f32 v23, 0x3c800000, v6
.c2s_51:
    s_cmp_eq_u32 s6, 0
    s_cselect_b64 vcc, -1, 0
    s_cmp_eq_u32 s6, 2
    s_cselect_b32 s7, 0xbf800000, 1.0
    v_cos_f32 v6, v16
    v_sin_f32 v7, v16
    s_nop 0
    v_mul_f32 v7, s7, v7
    v_cndmask_b32 v16, v7, v6, vcc
    v_cos_f32 v6, v17
    v_sin_f32 v7, v17
    s_nop 0
    v_mul_f32 v7, s7, v7
    v_cndmask_b32 v17, v7, v6, vcc
    v_cos_f32 v6, v18
    v_sin_f32 v7, v18
    s_nop 0
    v_mul_f32 v7, s7, v7
    v_cndmask_b32 v18, v7, v6, vcc
    v_cos_f32 v6, v19
    v_sin_f32 v7, v19
    s_nop 0
    v_mul_f32 v7, s7, v7
    v_cndmask_b32 v19, v7, v6, vcc
    v_cos_f32 v6, v20
    v_sin_f32 v7, v20
    s_nop 0
    v_mul_f32 v7, s7, v7
    v_cndmask_b32 v20, v7, v6, vcc
    v_cos_f32 v6, v21
    v_sin_f32 v7, v21
    s_nop 0
    v_mul_f32 v7, s7, v7
    v_cndmask_b32 v21, v7, v6, vcc
    v_cos_f32 v6, v22
    v_sin_f32 v7, v22
    s_nop 0
    v_mul_f32 v7, s7, v7
    v_cndmask_b32 v22, v7, v6, vcc
    v_cos_f32 v6, v23
    v_sin_f32 v7, v23
    s_nop 0
    v_mul_f32 v7, s7, v7
    v_cndmask_b32 v23, v7, v6, vcc
    v_cvt_pk_bf16_f32 v24, v16, v17
    v_cvt_pk_bf16_f32 v25, v18, v19
    v_cvt_pk_bf16_f32 v26, v20, v21
    v_cvt_pk_bf16_f32 v27, v22, v23
    s_branch .c2w_52
.c2t_50:
    s_sub_u32 s8, s5, 30
    s_lshr_b32 s6, s8, 4
    s_bfe_u32 s9, s8, 0x10003
    s_bfe_u32 s7, s8, 0x10002
    s_lshl_b32 s7, s7, 5
    s_and_b32 s10, s8, 3
    s_lshl_b32 s10, s10, 3
    v_lshl_add_u32 v5, v4, 2, s10
    s_cmp_eq_u32 s6, 0
    s_cselect_b32 s10, s7, 0
    s_cselect_b32 s11, 0, s7
    s_cselect_b32 s12, 1.0, 0x3a000000
    v_add_u32 v3, s10, v3
    v_add_u32 v5, s11, v5
    s_cmp_eq_u32 s9, 0
    s_cselect_b64 vcc, -1, 0
    v_add_u32 v6, 0, v5
    v_mul_u32_u24 v6, v6, v3
    v_cvt_f32_u32 v6, v6
    v_mul_f32 v6, 0x3a000000, v6
    v_cos_f32 v7, v6
    v_sin_f32 v8, v6
    s_nop 0
    v_cndmask_b32 v7, v8, v7, vcc
    v_mul_f32 v24, s12, v7
    v_add_u32 v6, 1, v5
    v_mul_u32_u24 v6, v6, v3
    v_cvt_f32_u32 v6, v6
    v_mul_f32 v6, 0x3a000000, v6
    v_cos_f32 v7, v6
    v_sin_f32 v8, v6
    s_nop 0
    v_cndmask_b32 v7, v8, v7, vcc
    v_mul_f32 v25, s12, v7
    v_add_u32 v6, 2, v5
    v_mul_u32_u24 v6, v6, v3
    v_cvt_f32_u32 v6, v6
    v_mul_f32 v6, 0x3a000000, v6
    v_cos_f32 v7, v6
    v_sin_f32 v8, v6
    s_nop 0
    v_cndmask_b32 v7, v8, v7, vcc
    v_mul_f32 v26, s12, v7
    v_add_u32 v6, 3, v5
    v_mul_u32_u24 v6, v6, v3
    v_cvt_f32_u32 v6, v6
    v_mul_f32 v6, 0x3a000000, v6
    v_cos_f32 v7, v6
    v_sin_f32 v8, v6
    s_nop 0
    v_cndmask_b32 v7, v8, v7, vcc
    v_mul_f32 v27, s12, v7
.c2w_52:
    v_lshlrev_b32 v1, 4, v1
    s_mov_b32 s4, 0x5800000
    buffer_store_dwordx4 v[24:27], v1, s[44:47], s4 offen sc1
.c2e_48:
.pp_47:
    s_add_u32 s73, s73, 1
    s_cmp_lt_u32 s73, s74
    s_cbranch_scc1 .pl_44
    s_mov_b32 s75, 20
    s_waitcnt vmcnt(0)
    s_barrier
    v_mov_b32 v1, s75
    v_mov_b32 v2, 1
    v_cmp_eq_u32 vcc, 0, v0
    s_nop 0
    s_and_saveexec_b64 s[6:7], vcc
    s_cbranch_execz .sg_53
    global_atomic_add v1, v2, s[38:39]
.sg_53:
    s_mov_b64 exec, s[6:7]
    s_branch .work_8
.task_31:
    s_mov_b32 s73, 20
    s_mov_b32 s74, 133
    v_readfirstlane_b32 s71, v0
    s_nop 0
    s_cmp_ge_u32 s71, 64
    s_cbranch_scc1 .wo_55
    v_mov_b32 v1, s73
    s_mov_b32 s57, 0
.wl_54:
    global_load_dword v2, v1, s[38:39] sc1
    s_waitcnt vmcnt(0)
    v_readfirstlane_b32 s71, v2
    s_nop 0
    s_cmp_ge_u32 s71, s74
    s_cbranch_scc1 .wo_55
    s_sleep 24
    s_add_u32 s57, s57, 1
    s_cmp_lt_u32 s57, 3000000
    s_cbranch_scc1 .wl_54
    s_branch .abort_1
.wo_55:
    s_barrier
    s_and_b32 s56, s72, 15
    s_lshr_b32 s57, s72, 4
    s_mov_b32 s44, s16
    s_and_b32 s45, s17, 0xffff
    s_mov_b32 s46, 0x280000
    s_mov_b32 s47, 0x00020000
    s_mov_b32 s52, s40
    s_and_b32 s53, s41, 0xffff
    s_mov_b32 s54, 0xfe00000
    s_mov_b32 s55, 0x00020000
    s_lshl_b32 s69, s56, 7
    s_mov_b32 s66, 0
    s_mul_i32 s67, s57, 163840
    s_add_u32 s67, s67, 0x5000000
    s_lshl_b32 s68, s57, 19
    s_lshl_b32 s59, s56, 8
    s_add_u32 s68, s68, s59
    s_add_u32 s68, s68, 0x4800000
    v_and_b32 v8, 63, v0
    v_lshrrev_b32 v9, 6, v0
    s_nop 0
    v_readfirstlane_b32 s63, v9
    v_lshrrev_b32 v10, 2, v8
    v_mov_b32 v11, 32
    v_mad_u32_u24 v10, v9, v11, v10
    v_add_u32 v10, s69, v10
    v_and_b32 v11, 31, v10
    v_lshrrev_b32 v10, 5, v10
    v_lshl_add_u32 v10, v11, 6, v10
    s_mov_b32 s64, 1280
    v_mul_lo_u32 v10, v10, s64
    v_lshrrev_b32 v11, 4, v8
    v_xor_b32 v11, v11, v8
    v_and_b32 v11, 3, v11
    v_lshl_add_u32 v13, v11, 4, v10
    v_lshrrev_b32 v10, 2, v8
    v_mov_b32 v11, 32
    v_mad_u32_u24 v10, v9, v11, v10
    v_add_u32 v10, 16, v10
    v_add_u32 v10, s69, v10
    v_and_b32 v11, 31, v10
    v_lshrrev_b32 v10, 5, v10
    v_lshl_add_u32 v10, v11, 6, v10
    s_mov_b32 s64, 1280
    v_mul_lo_u32 v10, v10, s64
    v_lshrrev_b32 v11, 4, v8
    v_xor_b32 v11, v11, v8
    v_and_b32 v11, 3, v11
    v_lshl_add_u32 v14, v11, 4, v10
    v_lshrrev_b32 v10, 2, v8
    v_mov_b32 v11, 32
    v_mad_u32_u24 v10, v9, v11, v10
    s_mov_b32 s64, 1280
    v_mul_lo_u32 v10, v10, s64
    v_lshrrev_b32 v11, 4, v8
    v_xor_b32 v11, v11, v8
    v_and_b32 v11, 3, v11
    v_lshl_add_u32 v15, v11, 4, v10
    v_lshrrev_b32 v10, 2, v8
    v_mov_b32 v11, 32
    v_mad_u32_u24 v10, v9, v11, v10
    v_add_u32 v10, 16, v10
    s_mov_b32 s64, 1280
    v_mul_lo_u32 v10, v10, s64
    v_lshrrev_b32 v11, 4, v8
    v_xor_b32 v11, v11, v8
    v_and_b32 v11, 3, v11
    v_lshl_add_u32 v16, v11, 4, v10
    v_lshrrev_b32 v12, 1, v9
    v_and_b32 v10, 31, v8
    v_lshrrev_b32 v11, 5, v8
    v_bfe_u32 v17, v8, 2, 2
    v_xor_b32 v11, v11, v17
    v_lshlrev_b32 v11, 4, v11
    v_lshl_add_u32 v10, v10, 6, v11
    v_mov_b32 v11, 4096
    v_mad_u32_u24 v10, v12, v11, v10
    v_add_u32 v17, 0, v10
    v_and_b32 v10, 31, v8
    v_lshrrev_b32 v11, 5, v8
    v_add_u32 v11, 2, v11
    v_bfe_u32 v18, v8, 2, 2
    v_xor_b32 v11, v11, v18
    v_lshlrev_b32 v11, 4, v11
    v_lshl_add_u32 v10, v10, 6, v11
    v_mov_b32 v11, 4096
    v_mad_u32_u24 v10, v12, v11, v10
    v_add_u32 v18, 0, v10
    v_and_b32 v12, 1, v9
    v_and_b32 v10, 31, v8
    v_lshrrev_b32 v11, 5, v8
    v_bfe_u32 v19, v8, 2, 2
    v_xor_b32 v11, v11, v19
    v_lshlrev_b32 v11, 4, v11
    v_lshl_add_u32 v10, v10, 6, v11
    v_mov_b32 v11, 4096
    v_mad_u32_u24 v10, v12, v11, v10
    v_add_u32 v19, 8192, v10
    v_and_b32 v10, 31, v8
    v_lshrrev_b32 v11, 5, v8
    v_add_u32 v11, 2, v11
    v_bfe_u32 v20, v8, 2, 2
    v_xor_b32 v11, v11, v20
    v_lshlrev_b32 v11, 4, v11
    v_lshl_add_u32 v10, v10, 6, v11
    v_mov_b32 v11, 4096
    v_mad_u32_u24 v10, v12, v11, v10
    v_add_u32 v20, 8192, v10
    s_mul_i32 s61, s63, 2048
    s_mov_b32 s60, 0
    s_mul_i32 s64, s63, 0
    s_add_u32 s64, s64, s61
    s_add_u32 s64, s64, 8192
    s_add_u32 m0, s61, 0
    s_nop 0
    buffer_load_dwordx4 v13, s[44:47], s66 offen sc1 lds
    s_add_u32 m0, s61, 1024
    s_nop 0
    buffer_load_dwordx4 v14, s[44:47], s66 offen sc1 lds
    s_add_u32 m0, s64, 0
    s_nop 0
    buffer_load_dwordx4 v15, s[52:55], s67 offen sc1 lds
    s_add_u32 m0, s64, 1024
    s_nop 0
    buffer_load_dwordx4 v16, s[52:55], s67 offen sc1 lds
    s_add_u32 s66, s66, 64
    s_add_u32 s67, s67, 64
    s_add_u32 s61, s61, 16384
    s_cmp_ge_u32 s61, 65536
    s_cselect_b32 s65, 65536, 0
    s_sub_u32 s61, s61, s65
    s_mul_i32 s64, s63, 0
    s_add_u32 s64, s64, s61
    s_add_u32 s64, s64, 8192
    s_add_u32 m0, s61, 0
    s_nop 0
    buffer_load_dwordx4 v13, s[44:47], s66 offen sc1 lds
    s_add_u32 m0, s61, 1024
    s_nop 0
    buffer_load_dwordx4 v14, s[44:47], s66 offen sc1 lds
    s_add_u32 m0, s64, 0
    s_nop 0
    buffer_load_dwordx4 v15, s[52:55], s67 offen sc1 lds
    s_add_u32 m0, s64, 1024
    s_nop 0
    buffer_load_dwordx4 v16, s[52:55], s67 offen sc1 lds
    s_add_u32 s66, s66, 64
    s_add_u32 s67, s67, 64
    s_add_u32 s61, s61, 16384
    s_cmp_ge_u32 s61, 65536
    s_cselect_b32 s65, 65536, 0
    s_sub_u32 s61, s61, s65
    s_mul_i32 s64, s63, 0
    s_add_u32 s64, s64, s61
    s_add_u32 s64, s64, 8192
    s_add_u32 m0, s61, 0
    s_nop 0
    buffer_load_dwordx4 v13, s[44:47], s66 offen sc1 lds
    s_add_u32 m0, s61, 1024
    s_nop 0
    buffer_load_dwordx4 v14, s[44:47], s66 offen sc1 lds
    s_add_u32 m0, s64, 0
    s_nop 0
    buffer_load_dwordx4 v15, s[52:55], s67 offen sc1 lds
    s_add_u32 m0, s64, 1024
    s_nop 0
    buffer_load_dwordx4 v16, s[52:55], s67 offen sc1 lds
    s_add_u32 s66, s66, 64
    s_add_u32 s67, s67, 64
    s_add_u32 s61, s61, 16384
    s_cmp_ge_u32 s61, 65536
    s_cselect_b32 s65, 65536, 0
    s_sub_u32 s61, s61, s65
    v_add_u32 v21, s60, v17
    v_add_u32 v22, s60, v18
    v_add_u32 v23, s60, v19
    v_add_u32 v24, s60, v20
    s_add_u32 s60, s60, 16384
    s_cmp_ge_u32 s60, 65536
    s_cselect_b32 s60, 0, s60
    s_waitcnt vmcnt(8)
    s_barrier
    ds_read_b128 v[28:31], v21 offset:0
    ds_read_b128 v[32:35], v21 offset:2048
    ds_read_b128 v[44:47], v23 offset:0
    ds_read_b128 v[48:51], v23 offset:2048
    s_waitcnt lgkmcnt(0)
    v_mfma_f32_32x32x16_bf16 a[0:15], v[28:31], v[44:47], 0
    ds_read_b128 v[36:39], v22 offset:0
    v_mfma_f32_32x32x16_bf16 a[16:31], v[28:31], v[48:51], 0
    ds_read_b128 v[40:43], v22 offset:2048
    v_mfma_f32_32x32x16_bf16 a[32:47], v[32:35], v[44:47], 0
    ds_read_b128 v[52:55], v24 offset:0
    v_mfma_f32_32x32x16_bf16 a[48:63], v[32:35], v[48:51], 0
    ds_read_b128 v[56:59], v24 offset:2048
    s_waitcnt vmcnt(4)
    s_barrier
    v_add_u32 v21, s60, v17
    v_add_u32 v22, s60, v18
    v_add_u32 v23, s60, v19
    v_add_u32 v24, s60, v20
    s_add_u32 s60, s60, 16384
    s_cmp_ge_u32 s60, 65536
    s_cselect_b32 s60, 0, s60
    s_mul_i32 s64, s63, 0
    s_add_u32 s64, s64, s61
    s_add_u32 s64, s64, 8192
    s_waitcnt lgkmcnt(0)
    v_mfma_f32_32x32x16_bf16 a[0:15], v[36:39], v[52:55], a[0:15]
    ds_read_b128 v[28:31], v21 offset:0
    ds_read_b128 v[32:35], v21 offset:2048
    v_mfma_f32_32x32x16_bf16 a[16:31], v[36:39], v[56:59], a[16:31]
    ds_read_b128 v[44:47], v23 offset:0
    ds_read_b128 v[48:51], v23 offset:2048
    v_mfma_f32_32x32x16_bf16 a[32:47], v[40:43], v[52:55], a[32:47]
    s_add_u32 m0, s61, 0
    s_nop 0
    buffer_load_dwordx4 v13, s[44:47], s66 offen sc1 lds
    s_add_u32 m0, s61, 1024
    s_nop 0
    buffer_load_dwordx4 v14, s[44:47], s66 offen sc1 lds
    v_mfma_f32_32x32x16_bf16 a[48:63], v[40:43], v[56:59], a[48:63]
    s_add_u32 m0, s64, 0
    s_nop 0
    buffer_load_dwordx4 v15, s[52:55], s67 offen sc1 lds
    s_add_u32 m0, s64, 1024
    s_nop 0
    buffer_load_dwordx4 v16, s[52:55], s67 offen sc1 lds
    s_add_u32 s66, s66, 64
    s_add_u32 s67, s67, 64
    s_add_u32 s61, s61, 16384
    s_cmp_ge_u32 s61, 65536
    s_cselect_b32 s65, 65536, 0
    s_sub_u32 s61, s61, s65
    s_mov_b32 s62, 16
.gl_56:
    s_waitcnt lgkmcnt(0)
    v_mfma_f32_32x32x16_bf16 a[0:15], v[28:31], v[44:47], a[0:15]
    ds_read_b128 v[36:39], v22 offset:0
    v_mfma_f32_32x32x16_bf16 a[16:31], v[28:31], v[48:51], a[16:31]
    ds_read_b128 v[40:43], v22 offset:2048
    v_mfma_f32_32x32x16_bf16 a[32:47], v[32:35], v[44:47], a[32:47]
    ds_read_b128 v[52:55], v24 offset:0
    v_mfma_f32_32x32x16_bf16 a[48:63], v[32:35], v[48:51], a[48:63]
    ds_read_b128 v[56:59], v24 offset:2048
    s_waitcnt vmcnt(4)
    s_barrier
    v_add_u32 v21, s60, v17
    v_add_u32 v22, s60, v18
    v_add_u32 v23, s60, v19
    v_add_u32 v24, s60, v20
    s_add_u32 s60, s60, 16384
    s_cmp_ge_u32 s60, 65536
    s_cselect_b32 s60, 0, s60
    s_mul_i32 s64, s63, 0
    s_add_u32 s64, s64, s61
    s_add_u32 s64, s64, 8192
    s_waitcnt lgkmcnt(0)
    v_mfma_f32_32x32x16_bf16 a[0:15], v[36:39], v[52:55], a[0:15]
    ds_read_b128 v[28:31], v21 offset:0
    ds_read_b128 v[32:35], v21 offset:2048
    v_mfma_f32_32x32x16_bf16 a[16:31], v[36:39], v[56:59], a[16:31]
    ds_read_b128 v[44:47], v23 offset:0
    ds_read_b128 v[48:51], v23 offset:2048
    v_mfma_f32_32x32x16_bf16 a[32:47], v[40:43], v[52:55], a[32:47]
    s_add_u32 m0, s61, 0
    s_nop 0
    buffer_load_dwordx4 v13, s[44:47], s66 offen sc1 lds
    s_add_u32 m0, s61, 1024
    s_nop 0
    buffer_load_dwordx4 v14, s[44:47], s66 offen sc1 lds
    v_mfma_f32_32x32x16_bf16 a[48:63], v[40:43], v[56:59], a[48:63]
    s_add_u32 m0, s64, 0
    s_nop 0
    buffer_load_dwordx4 v15, s[52:55], s67 offen sc1 lds
    s_add_u32 m0, s64, 1024
    s_nop 0
    buffer_load_dwordx4 v16, s[52:55], s67 offen sc1 lds
    s_add_u32 s66, s66, 64
    s_add_u32 s67, s67, 64
    s_add_u32 s61, s61, 16384
    s_cmp_ge_u32 s61, 65536
    s_cselect_b32 s65, 65536, 0
    s_sub_u32 s61, s61, s65
    s_sub_u32 s62, s62, 1
    s_cmp_lg_u32 s62, 0
    s_cbranch_scc1 .gl_56
    s_waitcnt lgkmcnt(0)
    v_mfma_f32_32x32x16_bf16 a[0:15], v[28:31], v[44:47], a[0:15]
    ds_read_b128 v[36:39], v22 offset:0
    v_mfma_f32_32x32x16_bf16 a[16:31], v[28:31], v[48:51], a[16:31]
    ds_read_b128 v[40:43], v22 offset:2048
    v_mfma_f32_32x32x16_bf16 a[32:47], v[32:35], v[44:47], a[32:47]
    ds_read_b128 v[52:55], v24 offset:0
    v_mfma_f32_32x32x16_bf16 a[48:63], v[32:35], v[48:51], a[48:63]
    ds_read_b128 v[56:59], v24 offset:2048
    s_waitcnt vmcnt(4)
    s_barrier
    v_add_u32 v21, s60, v17
    v_add_u32 v22, s60, v18
    v_add_u32 v23, s60, v19
    v_add_u32 v24, s60, v20
    s_add_u32 s60, s60, 16384
    s_cmp_ge_u32 s60, 65536
    s_cselect_b32 s60, 0, s60
    s_waitcnt lgkmcnt(0)
    v_mfma_f32_32x32x16_bf16 a[0:15], v[36:39], v[52:55], a[0:15]
    ds_read_b128 v[28:31], v21 offset:0
    v_mfma_f32_32x32x16_bf16 a[16:31], v[36:39], v[56:59], a[16:31]
    ds_read_b128 v[32:35], v21 offset:2048
    v_mfma_f32_32x32x16_bf16 a[32:47], v[40:43], v[52:55], a[32:47]
    ds_read_b128 v[44:47], v23 offset:0
    v_mfma_f32_32x32x16_bf16 a[48:63], v[40:43], v[56:59], a[48:63]
    ds_read_b128 v[48:51], v23 offset:2048
    s_waitcnt lgkmcnt(0)
    v_mfma_f32_32x32x16_bf16 a[0:15], v[28:31], v[44:47], a[0:15]
    ds_read_b128 v[36:39], v22 offset:0
    v_mfma_f32_32x32x16_bf16 a[16:31], v[28:31], v[48:51], a[16:31]
    ds_read_b128 v[40:43], v22 offset:2048
    v_mfma_f32_32x32x16_bf16 a[32:47], v[32:35], v[44:47], a[32:47]
    ds_read_b128 v[52:55], v24 offset:0
    v_mfma_f32_32x32x16_bf16 a[48:63], v[32:35], v[48:51], a[48:63]
    ds_read_b128 v[56:59], v24 offset:2048
    s_waitcnt vmcnt(0)
    s_barrier
    v_add_u32 v21, s60, v17
    v_add_u32 v22, s60, v18
    v_add_u32 v23, s60, v19
    v_add_u32 v24, s60, v20
    s_add_u32 s60, s60, 16384
    s_cmp_ge_u32 s60, 65536
    s_cselect_b32 s60, 0, s60
    s_waitcnt lgkmcnt(0)
    v_mfma_f32_32x32x16_bf16 a[0:15], v[36:39], v[52:55], a[0:15]
    ds_read_b128 v[28:31], v21 offset:0
    v_mfma_f32_32x32x16_bf16 a[16:31], v[36:39], v[56:59], a[16:31]
    ds_read_b128 v[32:35], v21 offset:2048
    v_mfma_f32_32x32x16_bf16 a[32:47], v[40:43], v[52:55], a[32:47]
    ds_read_b128 v[44:47], v23 offset:0
    v_mfma_f32_32x32x16_bf16 a[48:63], v[40:43], v[56:59], a[48:63]
    ds_read_b128 v[48:51], v23 offset:2048
    s_waitcnt lgkmcnt(0)
    v_mfma_f32_32x32x16_bf16 a[0:15], v[28:31], v[44:47], a[0:15]
    ds_read_b128 v[36:39], v22 offset:0
    v_mfma_f32_32x32x16_bf16 a[16:31], v[28:31], v[48:51], a[16:31]
    ds_read_b128 v[40:43], v22 offset:2048
    v_mfma_f32_32x32x16_bf16 a[32:47], v[32:35], v[44:47], a[32:47]
    ds_read_b128 v[52:55], v24 offset:0
    v_mfma_f32_32x32x16_bf16 a[48:63], v[32:35], v[48:51], a[48:63]
    ds_read_b128 v[56:59], v24 offset:2048
    s_waitcnt lgkmcnt(0)
    v_mfma_f32_32x32x16_bf16 a[0:15], v[36:39], v[52:55], a[0:15]
    v_mfma_f32_32x32x16_bf16 a[16:31], v[36:39], v[56:59], a[16:31]
    v_mfma_f32_32x32x16_bf16 a[32:47], v[40:43], v[52:55], a[32:47]
    v_mfma_f32_32x32x16_bf16 a[48:63], v[40:43], v[56:59], a[48:63]
    s_barrier
    s_mul_i32 s64, s63, 9216
    v_and_b32 v10, 31, v8
    v_mul_u32_u24 v10, 144, v10
    v_lshrrev_b32 v11, 5, v8
    v_lshl_add_u32 v10, v11, 4, v10
    v_add_u32 v13, s64, v10
    v_lshrrev_b32 v10, 3, v8
    v_mul_u32_u24 v10, 144, v10
    v_and_b32 v11, 7, v8
    v_lshl_add_u32 v10, v11, 4, v10
    v_add_u32 v14, s64, v10
    v_accvgpr_read_b32 v28, a0
    v_accvgpr_read_b32 v29, a1
    v_accvgpr_read_b32 v30, a2
    v_accvgpr_read_b32 v31, a3
    v_accvgpr_read_b32 v32, a4
    v_accvgpr_read_b32 v33, a5
    v_accvgpr_read_b32 v34, a6
    v_accvgpr_read_b32 v35, a7
    v_accvgpr_read_b32 v36, a8
    v_accvgpr_read_b32 v37, a9
    v_accvgpr_read_b32 v38, a10
    v_accvgpr_read_b32 v39, a11
    v_accvgpr_read_b32 v40, a12
    v_accvgpr_read_b32 v41, a13
    v_accvgpr_read_b32 v42, a14
    v_accvgpr_read_b32 v43, a15
    v_cvt_pk_bf16_f32 v44, v28, v29
    v_cvt_pk_bf16_f32 v45, v30, v31
    v_cvt_pk_bf16_f32 v46, v32, v33
    v_cvt_pk_bf16_f32 v47, v34, v35
    v_cvt_pk_bf16_f32 v48, v36, v37
    v_cvt_pk_bf16_f32 v49, v38, v39
    v_cvt_pk_bf16_f32 v50, v40, v41
    v_cvt_pk_bf16_f32 v51, v42, v43
    v_permlane32_swap_b32 v44, v46
    v_permlane32_swap_b32 v45, v47
    v_permlane32_swap_b32 v48, v50
    v_permlane32_swap_b32 v49, v51
    ds_write_b128 v13, v[44:47] offset:0
    ds_write_b128 v13, v[48:51] offset:32
    v_accvgpr_read_b32 v52, a16
    v_accvgpr_read_b32 v53, a17
    v_accvgpr_read_b32 v54, a18
    v_accvgpr_read_b32 v55, a19
    v_accvgpr_read_b32 v56, a20
    v_accvgpr_read_b32 v57, a21
    v_accvgpr_read_b32 v58, a22
    v_accvgpr_read_b32 v59, a23
    v_accvgpr_read_b32 v60, a24
    v_accvgpr_read_b32 v61, a25
    v_accvgpr_read_b32 v62, a26
    v_accvgpr_read_b32 v63, a27
    v_accvgpr_read_b32 v64, a28
    v_accvgpr_read_b32 v65, a29
    v_accvgpr_read_b32 v66, a30
    v_accvgpr_read_b32 v67, a31
    v_cvt_pk_bf16_f32 v68, v52, v53
    v_cvt_pk_bf16_f32 v69, v54, v55
    v_cvt_pk_bf16_f32 v70, v56, v57
    v_cvt_pk_bf16_f32 v71, v58, v59
    v_cvt_pk_bf16_f32 v72, v60, v61
    v_cvt_pk_bf16_f32 v73, v62, v63
    v_cvt_pk_bf16_f32 v74, v64, v65
    v_cvt_pk_bf16_f32 v75, v66, v67
    v_permlane32_swap_b32 v68, v70
    v_permlane32_swap_b32 v69, v71
    v_permlane32_swap_b32 v72, v74
    v_permlane32_swap_b32 v73, v75
    ds_write_b128 v13, v[68:71] offset:4608
    ds_write_b128 v13, v[72:75] offset:4640
    v_accvgpr_read_b32 v28, a32
    v_accvgpr_read_b32 v29, a33
    v_accvgpr_read_b32 v30, a34
    v_accvgpr_read_b32 v31, a35
    v_accvgpr_read_b32 v32, a36
    v_accvgpr_read_b32 v33, a37
    v_accvgpr_read_b32 v34, a38
    v_accvgpr_read_b32 v35, a39
    v_accvgpr_read_b32 v36, a40
    v_accvgpr_read_b32 v37, a41
    v_accvgpr_read_b32 v38, a42
    v_accvgpr_read_b32 v39, a43
    v_accvgpr_read_b32 v40, a44
    v_accvgpr_read_b32 v41, a45
    v_accvgpr_read_b32 v42, a46
    v_accvgpr_read_b32 v43, a47
    v_cvt_pk_bf16_f32 v44, v28, v29
    v_cvt_pk_bf16_f32 v45, v30, v31
    v_cvt_pk_bf16_f32 v46, v32, v33
    v_cvt_pk_bf16_f32 v47, v34, v35
    v_cvt_pk_bf16_f32 v48, v36, v37
    v_cvt_pk_bf16_f32 v49, v38, v39
    v_cvt_pk_bf16_f32 v50, v40, v41
    v_cvt_pk_bf16_f32 v51, v42, v43
    v_permlane32_swap_b32 v44, v46
    v_permlane32_swap_b32 v45, v47
    v_permlane32_swap_b32 v48, v50
    v_permlane32_swap_b32 v49, v51
    ds_write_b128 v13, v[44:47] offset:64
    ds_write_b128 v13, v[48:51] offset:96
    v_accvgpr_read_b32 v52, a48
    v_accvgpr_read_b32 v53, a49
    v_accvgpr_read_b32 v54, a50
    v_accvgpr_read_b32 v55, a51
    v_accvgpr_read_b32 v56, a52
    v_accvgpr_read_b32 v57, a53
    v_accvgpr_read_b32 v58, a54
    v_accvgpr_read_b32 v59, a55
    v_accvgpr_read_b32 v60, a56
    v_accvgpr_read_b32 v61, a57
    v_accvgpr_read_b32 v62, a58
    v_accvgpr_read_b32 v63, a59
    v_accvgpr_read_b32 v64, a60
    v_accvgpr_read_b32 v65, a61
    v_accvgpr_read_b32 v66, a62
    v_accvgpr_read_b32 v67, a63
    v_cvt_pk_bf16_f32 v68, v52, v53
    v_cvt_pk_bf16_f32 v69, v54, v55
    v_cvt_pk_bf16_f32 v70, v56, v57
    v_cvt_pk_bf16_f32 v71, v58, v59
    v_cvt_pk_bf16_f32 v72, v60, v61
    v_cvt_pk_bf16_f32 v73, v62, v63
    v_cvt_pk_bf16_f32 v74, v64, v65
    v_cvt_pk_bf16_f32 v75, v66, v67
    v_permlane32_swap_b32 v68, v70
    v_permlane32_swap_b32 v69, v71
    v_permlane32_swap_b32 v72, v74
    v_permlane32_swap_b32 v73, v75
    ds_write_b128 v13, v[68:71] offset:4672
    ds_write_b128 v13, v[72:75] offset:4704
    v_lshrrev_b32 v11, 1, v9
    v_mul_u32_u24 v11, 128, v11
    v_and_b32 v12, 7, v8
    v_lshl_add_u32 v15, v12, 4, v11
    v_and_b32 v10, 1, v9
    v_mul_u32_u24 v10, 64, v10
    v_lshrrev_b32 v11, 3, v8
    v_add_u32 v16, v10, v11
    s_waitcnt lgkmcnt(0)
    s_mov_b32 s64, 4096
    ds_read_b128 v[28:31], v14 offset:0
    ds_read_b128 v[32:35], v14 offset:1152
    ds_read_b128 v[36:39], v14 offset:2304
    ds_read_b128 v[40:43], v14 offset:3456
    ds_read_b128 v[44:47], v14 offset:4608
    ds_read_b128 v[48:51], v14 offset:5760
    ds_read_b128 v[52:55], v14 offset:6912
    ds_read_b128 v[56:59], v14 offset:8064
    v_add_u32 v60, 0, v16
    v_mul_lo_u32 v60, v60, s64
    v_add_u32 v60, v60, v15
    v_add_u32 v61, 8, v16
    v_mul_lo_u32 v61, v61, s64
    v_add_u32 v61, v61, v15
    v_add_u32 v62, 16, v16
    v_mul_lo_u32 v62, v62, s64
    v_add_u32 v62, v62, v15
    v_add_u32 v63, 24, v16
    v_mul_lo_u32 v63, v63, s64
    v_add_u32 v63, v63, v15
    v_add_u32 v64, 32, v16
    v_mul_lo_u32 v64, v64, s64
    v_add_u32 v64, v64, v15
    v_add_u32 v65, 40, v16
    v_mul_lo_u32 v65, v65, s64
    v_add_u32 v65, v65, v15
    v_add_u32 v66, 48, v16
    v_mul_lo_u32 v66, v66, s64
    v_add_u32 v66, v66, v15
    v_add_u32 v67, 56, v16
    v_mul_lo_u32 v67, v67, s64
    v_add_u32 v67, v67, v15
    s_waitcnt lgkmcnt(7)
    buffer_store_dwordx4 v[28:31], v60, s[52:55], s68 offen sc1
    s_waitcnt lgkmcnt(6)
    buffer_store_dwordx4 v[32:35], v61, s[52:55], s68 offen sc1
    s_waitcnt lgkmcnt(5)
    buffer_store_dwordx4 v[36:39], v62, s[52:55], s68 offen sc1
    s_waitcnt lgkmcnt(4)
    buffer_store_dwordx4 v[40:43], v63, s[52:55], s68 offen sc1
    s_waitcnt lgkmcnt(3)
    buffer_store_dwordx4 v[44:47], v64, s[52:55], s68 offen sc1
    s_waitcnt lgkmcnt(2)
    buffer_store_dwordx4 v[48:51], v65, s[52:55], s68 offen sc1
    s_waitcnt lgkmcnt(1)
    buffer_store_dwordx4 v[52:55], v66, s[52:55], s68 offen sc1
    s_waitcnt lgkmcnt(0)
    buffer_store_dwordx4 v[56:59], v67, s[52:55], s68 offen sc1
    s_mov_b32 s75, 24
    s_waitcnt vmcnt(0)
    s_barrier
    v_mov_b32 v1, s75
    v_mov_b32 v2, 1
    v_cmp_eq_u32 vcc, 0, v0
    s_nop 0
    s_and_saveexec_b64 s[6:7], vcc
    s_cbranch_execz .sg_57
    global_atomic_add v1, v2, s[38:39]
.sg_57:
    s_mov_b64 exec, s[6:7]
    s_branch .work_8
.task_33:
    s_mov_b32 s73, 24
    s_mov_b32 s74, 80
    v_readfirstlane_b32 s71, v0
    s_nop 0
    s_cmp_ge_u32 s71, 64
    s_cbranch_scc1 .wo_59
    v_mov_b32 v1, s73
    s_mov_b32 s57, 0
.wl_58:
    global_load_dword v2, v1, s[38:39] sc1
    s_waitcnt vmcnt(0)
    v_readfirstlane_b32 s71, v2
    s_nop 0
    s_cmp_ge_u32 s71, s74
    s_cbranch_scc1 .wo_59
    s_sleep 24
    s_add_u32 s57, s57, 1
    s_cmp_lt_u32 s57, 3000000
    s_cbranch_scc1 .wl_58
    s_branch .abort_1
.wo_59:
    s_barrier
    v_and_b32 v1, 63, v0
    v_lshrrev_b32 v2, 6, v0
    s_nop 0
    v_readfirstlane_b32 s56, v2
    s_lshl_b32 s57, s72, 2
    s_add_u32 s57, s57, s56
    s_cmp_gt_u32 s57, 320
    s_cbranch_scc1 .a2e_60
    s_mov_b32 s52, s40
    s_and_b32 s53, s41, 0xffff
    s_mov_b32 s54, 0xfe00000
    s_mov_b32 s55, 0x00020000
    s_cmp_eq_u32 s57, 0
    s_cselect_b32 s58, 0, 1
    s_cmp_eq_u32 s57, 320
    s_cselect_b32 s58, 0, s58
    v_lshlrev_b32 v3, 4, v1
    s_mov_b32 s59, 0x5800000
    v_and_b32 v4, 31, v1
    v_lshlrev_b32 v4, 6, v4
    v_lshrrev_b32 v5, 5, v1
    v_lshl_add_u32 v4, v5, 4, v4
    s_lshl_b32 s60, s57, 12
    s_add_u32 s60, s60, 0x4800000
    s_add_u32 s61, s60, 1310720
    buffer_load_dwordx4 v[16:19], v4, s[52:55], s60 offen offset:0 sc1
    buffer_load_dwordx4 v[20:23], v4, s[52:55], s60 offen offset:32 sc1
    buffer_load_dwordx4 v[24:27], v4, s[52:55], s60 offen offset:2048 sc1
    buffer_load_dwordx4 v[28:31], v4, s[52:55], s60 offen offset:2080 sc1
    s_cmp_eq_u32 s58, 0
    s_cbranch_scc1 .a2z_61
    buffer_load_dwordx4 v[32:35], v4, s[52:55], s61 offen offset:0 sc1
    buffer_load_dwordx4 v[36:39], v4, s[52:55], s61 offen offset:32 sc1
    buffer_load_dwordx4 v[40:43], v4, s[52:55], s61 offen offset:2048 sc1
    buffer_load_dwordx4 v[44:47], v4, s[52:55], s61 offen offset:2080 sc1
    s_branch .a2y_62
.a2z_61:
    v_mov_b32 v32, 0
    v_mov_b32 v33, 0
    v_mov_b32 v34, 0
    v_mov_b32 v35, 0
    v_mov_b32 v36, 0
    v_mov_b32 v37, 0
    v_mov_b32 v38, 0
    v_mov_b32 v39, 0
    v_mov_b32 v40, 0
    v_mov_b32 v41, 0
    v_mov_b32 v42, 0
    v_mov_b32 v43, 0
    v_mov_b32 v44, 0
    v_mov_b32 v45, 0
    v_mov_b32 v46, 0
    v_mov_b32 v47, 0
.a2y_62:
    buffer_load_dwordx4 a[0:3], v3, s[52:55], s59 offen offset:0 sc1
    buffer_load_dwordx4 a[4:7], v3, s[52:55], s59 offen offset:1024 sc1
    buffer_load_dwordx4 a[8:11], v3, s[52:55], s59 offen offset:2048 sc1
    buffer_load_dwordx4 a[12:15], v3, s[52:55], s59 offen offset:3072 sc1
    s_add_u32 s59, s59, 4096
    buffer_load_dwordx4 a[16:19], v3, s[52:55], s59 offen offset:0 sc1
    buffer_load_dwordx4 a[20:23], v3, s[52:55], s59 offen offset:1024 sc1
    buffer_load_dwordx4 a[24:27], v3, s[52:55], s59 offen offset:2048 sc1
    buffer_load_dwordx4 a[28:31], v3, s[52:55], s59 offen offset:3072 sc1
    s_add_u32 s59, s59, 4096
    buffer_load_dwordx4 a[32:35], v3, s[52:55], s59 offen offset:0 sc1
    buffer_load_dwordx4 a[36:39], v3, s[52:55], s59 offen offset:1024 sc1
    buffer_load_dwordx4 a[40:43], v3, s[52:55], s59 offen offset:2048 sc1
    buffer_load_dwordx4 a[44:47], v3, s[52:55], s59 offen offset:3072 sc1
    s_add_u32 s59, s59, 4096
    buffer_load_dwordx4 a[48:51], v3, s[52:55], s59 offen offset:0 sc1
    buffer_load_dwordx4 a[52:55], v3, s[52:55], s59 offen offset:1024 sc1
    buffer_load_dwordx4 a[56:59], v3, s[52:55], s59 offen offset:2048 sc1
    buffer_load_dwordx4 a[60:63], v3, s[52:55], s59 offen offset:3072 sc1
    s_add_u32 s59, s59, 4096
    buffer_load_dwordx4 a[64:67], v3, s[52:55], s59 offen offset:0 sc1
    buffer_load_dwordx4 a[68:71], v3, s[52:55], s59 offen offset:1024 sc1
    buffer_load_dwordx4 a[72:75], v3, s[52:55], s59 offen offset:2048 sc1
    buffer_load_dwordx4 a[76:79], v3, s[52:55], s59 offen offset:3072 sc1
    s_add_u32 s59, s59, 4096
    buffer_load_dwordx4 a[80:83], v3, s[52:55], s59 offen offset:0 sc1
    buffer_load_dwordx4 a[84:87], v3, s[52:55], s59 offen offset:1024 sc1
    buffer_load_dwordx4 a[88:91], v3, s[52:55], s59 offen offset:2048 sc1
    buffer_load_dwordx4 a[92:95], v3, s[52:55], s59 offen offset:3072 sc1
    s_add_u32 s59, s59, 4096
    buffer_load_dwordx4 a[96:99], v3, s[52:55], s59 offen offset:0 sc1
    buffer_load_dwordx4 a[100:103], v3, s[52:55], s59 offen offset:1024 sc1
    buffer_load_dwordx4 a[104:107], v3, s[52:55], s59 offen offset:2048 sc1
    buffer_load_dwordx4 a[108:111], v3, s[52:55], s59 offen offset:3072 sc1
    s_add_u32 s59, s59, 4096
    buffer_load_dwordx4 a[112:115], v3, s[52:55], s59 offen offset:0 sc1
    buffer_load_dwordx4 a[116:119], v3, s[52:55], s59 offen offset:1024 sc1
    buffer_load_dwordx4 a[120:123], v3, s[52:55], s59 offen offset:2048 sc1
    buffer_load_dwordx4 a[124:127], v3, s[52:55], s59 offen offset:3072 sc1
    s_add_u32 s59, s59, 4096
    buffer_load_dwordx4 a[128:131], v3, s[52:55], s59 offen offset:0 sc1
    buffer_load_dwordx4 a[132:135], v3, s[52:55], s59 offen offset:1024 sc1
    buffer_load_dwordx4 a[136:139], v3, s[52:55], s59 offen offset:2048 sc1
    buffer_load_dwordx4 a[140:143], v3, s[52:55], s59 offen offset:3072 sc1
    s_add_u32 s59, s59, 4096
    buffer_load_dwordx4 a[144:147], v3, s[52:55], s59 offen offset:0 sc1
    buffer_load_dwordx4 a[148:151], v3, s[52:55], s59 offen offset:1024 sc1
    buffer_load_dwordx4 a[152:155], v3, s[52:55], s59 offen offset:2048 sc1
    buffer_load_dwordx4 a[156:159], v3, s[52:55], s59 offen offset:3072 sc1
    s_add_u32 s59, s59, 4096
    buffer_load_dwordx4 a[160:163], v3, s[52:55], s59 offen offset:0 sc1
    buffer_load_dwordx4 a[164:167], v3, s[52:55], s59 offen offset:1024 sc1
    buffer_load_dwordx4 a[168:171], v3, s[52:55], s59 offen offset:2048 sc1
    buffer_load_dwordx4 a[172:175], v3, s[52:55], s59 offen offset:3072 sc1
    s_add_u32 s59, s59, 4096
    buffer_load_dwordx4 a[176:179], v3, s[52:55], s59 offen offset:0 sc1
    buffer_load_dwordx4 a[180:183], v3, s[52:55], s59 offen offset:1024 sc1
    buffer_load_dwordx4 a[184:187], v3, s[52:55], s59 offen offset:2048 sc1
    buffer_load_dwordx4 a[188:191], v3, s[52:55], s59 offen offset:3072 sc1
    s_add_u32 s59, s59, 4096
    buffer_load_dwordx4 a[192:195], v3, s[52:55], s59 offen offset:0 sc1
    buffer_load_dwordx4 a[196:199], v3, s[52:55], s59 offen offset:1024 sc1
    buffer_load_dwordx4 a[200:203], v3, s[52:55], s59 offen offset:2048 sc1
    buffer_load_dwordx4 a[204:207], v3, s[52:55], s59 offen offset:3072 sc1
    s_add_u32 s59, s59, 4096
    buffer_load_dwordx4 a[208:211], v3, s[52:55], s59 offen offset:0 sc1
    buffer_load_dwordx4 a[212:215], v3, s[52:55], s59 offen offset:1024 sc1
    buffer_load_dwordx4 a[216:219], v3, s[52:55], s59 offen offset:2048 sc1
    buffer_load_dwordx4 a[220:223], v3, s[52:55], s59 offen offset:3072 sc1
    s_add_u32 s59, s59, 4096
    buffer_load_dwordx4 a[224:227], v3, s[52:55], s59 offen offset:0 sc1
    buffer_load_dwordx4 a[228:231], v3, s[52:55], s59 offen offset:1024 sc1
    buffer_load_dwordx4 a[232:235], v3, s[52:55], s59 offen offset:2048 sc1
    buffer_load_dwordx4 a[236:239], v3, s[52:55], s59 offen offset:3072 sc1
    s_add_u32 s59, s59, 4096
    buffer_load_dwordx4 a[240:243], v3, s[52:55], s59 offen offset:0 sc1
    buffer_load_dwordx4 a[244:247], v3, s[52:55], s59 offen offset:1024 sc1
    s_lshl_b32 s59, s57, 13
    s_add_u32 s59, s59, 0x5200000
    buffer_load_dwordx4 v[176:179], v3, s[52:55], s59 offen offset:0 sc1
    buffer_load_dwordx4 v[180:183], v3, s[52:55], s59 offen offset:1024 sc1
    buffer_load_dwordx4 v[184:187], v3, s[52:55], s59 offen offset:2048 sc1
    buffer_load_dwordx4 v[188:191], v3, s[52:55], s59 offen offset:3072 sc1
    s_add_u32 s59, s59, 4096
    buffer_load_dwordx4 v[192:195], v3, s[52:55], s59 offen offset:0 sc1
    buffer_load_dwordx4 v[196:199], v3, s[52:55], s59 offen offset:1024 sc1
    buffer_load_dwordx4 v[200:203], v3, s[52:55], s59 offen offset:2048 sc1
    buffer_load_dwordx4 v[204:207], v3, s[52:55], s59 offen offset:3072 sc1
    s_lshl_b32 s62, s56, 13
    v_and_b32 v6, 31, v1
    v_lshlrev_b32 v7, 6, v6
    v_lshl_add_u32 v7, v5, 3, v7
    v_add_u32 v7, s62, v7
    v_bfe_u32 v8, v1, 2, 2
    v_lshl_add_u32 v8, v5, 2, v8
    v_lshlrev_b32 v8, 6, v8
    v_bfe_u32 v9, v1, 4, 1
    v_lshl_add_u32 v8, v9, 5, v8
    v_and_b32 v10, 3, v1
    v_lshl_add_u32 v8, v10, 3, v8
    v_add_u32 v8, s62, v8
    v_lshlrev_b32 v11, 7, v6
    v_lshl_add_u32 v11, v5, 3, v11
    v_add_u32 v11, s62, v11
    v_bfe_u32 v12, v1, 2, 2
    v_lshl_add_u32 v12, v5, 3, v12
    v_lshlrev_b32 v12, 7, v12
    v_lshl_add_u32 v12, v9, 5, v12
    v_lshl_add_u32 v12, v10, 3, v12
    v_add_u32 v12, s62, v12
    s_waitcnt vmcnt(0)
    v_mfma_f32_32x32x16_bf16 v[48:63], a[0:3], v[16:19], 0
    v_mfma_f32_32x32x16_bf16 v[48:63], a[8:11], v[32:35], v[48:63]
    v_mfma_f32_32x32x16_bf16 v[48:63], a[4:7], v[20:23], v[48:63]
    v_mfma_f32_32x32x16_bf16 v[48:63], a[12:15], v[36:39], v[48:63]
    v_mfma_f32_32x32x16_bf16 v[80:95], a[0:3], v[32:35], 0
    v_mfma_f32_32x32x16_bf16 v[80:95], a[16:19], v[16:19], v[80:95]
    v_mfma_f32_32x32x16_bf16 v[80:95], a[4:7], v[36:39], v[80:95]
    v_mfma_f32_32x32x16_bf16 v[80:95], a[20:23], v[20:23], v[80:95]
    v_mfma_f32_32x32x16_bf16 v[64:79], a[0:3], v[24:27], 0
    v_mfma_f32_32x32x16_bf16 v[64:79], a[8:11], v[40:43], v[64:79]
    v_mfma_f32_32x32x16_bf16 v[64:79], a[4:7], v[28:31], v[64:79]
    v_mfma_f32_32x32x16_bf16 v[64:79], a[12:15], v[44:47], v[64:79]
    v_mfma_f32_32x32x16_bf16 v[96:111], a[0:3], v[40:43], 0
    v_mfma_f32_32x32x16_bf16 v[96:111], a[16:19], v[24:27], v[96:111]
    v_mfma_f32_32x32x16_bf16 v[96:111], a[4:7], v[44:47], v[96:111]
    v_mfma_f32_32x32x16_bf16 v[96:111], a[20:23], v[28:31], v[96:111]
    v_accvgpr_read_b32 v112, a120
    v_accvgpr_read_b32 v113, a152
    v_mul_f32 v114, v48, v112
    s_nop 0
    v_mul_f32 v115, v80, v112
    v_fma_f32 v114, v80, v113, v114
    v_fma_f32 v80, -v48, v113, v115
    v_mov_b32 v48, v114
    v_accvgpr_read_b32 v116, a121
    v_accvgpr_read_b32 v117, a153
    v_mul_f32 v118, v49, v116
    v_mul_f32 v119, v81, v116
    v_fma_f32 v118, v81, v117, v118
    v_fma_f32 v81, -v49, v117, v119
    v_mov_b32 v49, v118
    v_accvgpr_read_b32 v120, a122
    v_accvgpr_read_b32 v121, a154
    v_mul_f32 v122, v50, v120
    v_mul_f32 v123, v82, v120
    v_fma_f32 v122, v82, v121, v122
    v_fma_f32 v82, -v50, v121, v123
    v_mov_b32 v50, v122
    v_accvgpr_read_b32 v124, a123
    v_accvgpr_read_b32 v125, a155
    v_mul_f32 v126, v51, v124
    v_mul_f32 v127, v83, v124
    v_fma_f32 v126, v83, v125, v126
    v_fma_f32 v83, -v51, v125, v127
    v_mov_b32 v51, v126
    v_accvgpr_read_b32 v112, a124
    v_accvgpr_read_b32 v113, a156
    v_mul_f32 v114, v52, v112
    v_mul_f32 v115, v84, v112
    v_fma_f32 v114, v84, v113, v114
    v_fma_f32 v84, -v52, v113, v115
    v_mov_b32 v52, v114
    v_accvgpr_read_b32 v116, a125
    v_accvgpr_read_b32 v117, a157
    v_mul_f32 v118, v53, v116
    v_mul_f32 v119, v85, v116
    v_fma_f32 v118, v85, v117, v118
    v_fma_f32 v85, -v53, v117, v119
    v_mov_b32 v53, v118
    v_accvgpr_read_b32 v120, a126
    v_accvgpr_read_b32 v121, a158
    v_mul_f32 v122, v54, v120
    v_mul_f32 v123, v86, v120
    v_fma_f32 v122, v86, v121, v122
    v_fma_f32 v86, -v54, v121, v123
    v_mov_b32 v54, v122
    v_accvgpr_read_b32 v124, a127
    v_accvgpr_read_b32 v125, a159
    v_mul_f32 v126, v55, v124
    v_mul_f32 v127, v87, v124
    v_fma_f32 v126, v87, v125, v126
    v_fma_f32 v87, -v55, v125, v127
    v_mov_b32 v55, v126
    v_accvgpr_read_b32 v112, a128
    v_accvgpr_read_b32 v113, a160
    v_mul_f32 v114, v56, v112
    v_mul_f32 v115, v88, v112
    v_fma_f32 v114, v88, v113, v114
    v_fma_f32 v88, -v56, v113, v115
    v_mov_b32 v56, v114
    v_accvgpr_read_b32 v116, a129
    v_accvgpr_read_b32 v117, a161
    v_mul_f32 v118, v57, v116
    v_mul_f32 v119, v89, v116
    v_fma_f32 v118, v89, v117, v118
    v_fma_f32 v89, -v57, v117, v119
    v_mov_b32 v57, v118
    v_accvgpr_read_b32 v120, a130
    v_accvgpr_read_b32 v121, a162
    v_mul_f32 v122, v58, v120
    v_mul_f32 v123, v90, v120
    v_fma_f32 v122, v90, v121, v122
    v_fma_f32 v90, -v58, v121, v123
    v_mov_b32 v58, v122
    v_accvgpr_read_b32 v124, a131
    v_accvgpr_read_b32 v125, a163
    v_mul_f32 v126, v59, v124
    v_mul_f32 v127, v91, v124
    v_fma_f32 v126, v91, v125, v126
    v_fma_f32 v91, -v59, v125, v127
    v_mov_b32 v59, v126
    v_accvgpr_read_b32 v112, a132
    v_accvgpr_read_b32 v113, a164
    v_mul_f32 v114, v60, v112
    v_mul_f32 v115, v92, v112
    v_fma_f32 v114, v92, v113, v114
    v_fma_f32 v92, -v60, v113, v115
    v_mov_b32 v60, v114
    v_accvgpr_read_b32 v116, a133
    v_accvgpr_read_b32 v117, a165
    v_mul_f32 v118, v61, v116
    v_mul_f32 v119, v93, v116
    v_fma_f32 v118, v93, v117, v118
    v_fma_f32 v93, -v61, v117, v119
    v_mov_b32 v61, v118
    v_accvgpr_read_b32 v120, a134
    v_accvgpr_read_b32 v121, a166
    v_mul_f32 v122, v62, v120
    v_mul_f32 v123, v94, v120
    v_fma_f32 v122, v94, v121, v122
    v_fma_f32 v94, -v62, v121, v123
    v_mov_b32 v62, v122
    v_accvgpr_read_b32 v124, a135
    v_accvgpr_read_b32 v125, a167
    v_mul_f32 v126, v63, v124
    v_mul_f32 v127, v95, v124
    v_fma_f32 v126, v95, v125, v126
    v_fma_f32 v95, -v63, v125, v127
    v_mov_b32 v63, v126
    v_accvgpr_read_b32 v112, a136
    v_accvgpr_read_b32 v113, a168
    v_mul_f32 v114, v64, v112
    v_mul_f32 v115, v96, v112
    v_fma_f32 v114, v96, v113, v114
    v_fma_f32 v96, -v64, v113, v115
    v_mov_b32 v64, v114
    v_accvgpr_read_b32 v116, a137
    v_accvgpr_read_b32 v117, a169
    v_mul_f32 v118, v65, v116
    v_mul_f32 v119, v97, v116
    v_fma_f32 v118, v97, v117, v118
    v_fma_f32 v97, -v65, v117, v119
    v_mov_b32 v65, v118
    v_accvgpr_read_b32 v120, a138
    v_accvgpr_read_b32 v121, a170
    v_mul_f32 v122, v66, v120
    v_mul_f32 v123, v98, v120
    v_fma_f32 v122, v98, v121, v122
    v_fma_f32 v98, -v66, v121, v123
    v_mov_b32 v66, v122
    v_accvgpr_read_b32 v124, a139
    v_accvgpr_read_b32 v125, a171
    v_mul_f32 v126, v67, v124
    v_mul_f32 v127, v99, v124
    v_fma_f32 v126, v99, v125, v126
    v_fma_f32 v99, -v67, v125, v127
    v_mov_b32 v67, v126
    v_accvgpr_read_b32 v112, a140
    v_accvgpr_read_b32 v113, a172
    v_mul_f32 v114, v68, v112
    v_mul_f32 v115, v100, v112
    v_fma_f32 v114, v100, v113, v114
    v_fma_f32 v100, -v68, v113, v115
    v_mov_b32 v68, v114
    v_accvgpr_read_b32 v116, a141
    v_accvgpr_read_b32 v117, a173
    v_mul_f32 v118, v69, v116
    v_mul_f32 v119, v101, v116
    v_fma_f32 v118, v101, v117, v118
    v_fma_f32 v101, -v69, v117, v119
    v_mov_b32 v69, v118
    v_accvgpr_read_b32 v120, a142
    v_accvgpr_read_b32 v121, a174
    v_mul_f32 v122, v70, v120
    v_mul_f32 v123, v102, v120
    v_fma_f32 v122, v102, v121, v122
    v_fma_f32 v102, -v70, v121, v123
    v_mov_b32 v70, v122
    v_accvgpr_read_b32 v124, a143
    v_accvgpr_read_b32 v125, a175
    v_mul_f32 v126, v71, v124
    v_mul_f32 v127, v103, v124
    v_fma_f32 v126, v103, v125, v126
    v_fma_f32 v103, -v71, v125, v127
    v_mov_b32 v71, v126
    v_accvgpr_read_b32 v112, a144
    v_accvgpr_read_b32 v113, a176
    v_mul_f32 v114, v72, v112
    v_mul_f32 v115, v104, v112
    v_fma_f32 v114, v104, v113, v114
    v_fma_f32 v104, -v72, v113, v115
    v_mov_b32 v72, v114
    v_accvgpr_read_b32 v116, a145
    v_accvgpr_read_b32 v117, a177
    v_mul_f32 v118, v73, v116
    v_mul_f32 v119, v105, v116
    v_fma_f32 v118, v105, v117, v118
    v_fma_f32 v105, -v73, v117, v119
    v_mov_b32 v73, v118
    v_accvgpr_read_b32 v120, a146
    v_accvgpr_read_b32 v121, a178
    v_mul_f32 v122, v74, v120
    v_mul_f32 v123, v106, v120
    v_fma_f32 v122, v106, v121, v122
    v_fma_f32 v106, -v74, v121, v123
    v_mov_b32 v74, v122
    v_accvgpr_read_b32 v124, a147
    v_accvgpr_read_b32 v125, a179
    v_mul_f32 v126, v75, v124
    v_mul_f32 v127, v107, v124
    v_fma_f32 v126, v107, v125, v126
    v_fma_f32 v107, -v75, v125, v127
    v_mov_b32 v75, v126
    v_accvgpr_read_b32 v112, a148
    v_accvgpr_read_b32 v113, a180
    v_mul_f32 v114, v76, v112
    v_mul_f32 v115, v108, v112
    v_fma_f32 v114, v108, v113, v114
    v_fma_f32 v108, -v76, v113, v115
    v_mov_b32 v76, v114
    v_accvgpr_read_b32 v116, a149
    v_accvgpr_read_b32 v117, a181
    v_mul_f32 v118, v77, v116
    v_mul_f32 v119, v109, v116
    v_fma_f32 v118, v109, v117, v118
    v_fma_f32 v109, -v77, v117, v119
    v_mov_b32 v77, v118
    v_accvgpr_read_b32 v120, a150
    v_accvgpr_read_b32 v121, a182
    v_mul_f32 v122, v78, v120
    v_mul_f32 v123, v110, v120
    v_fma_f32 v122, v110, v121, v122
    v_fma_f32 v110, -v78, v121, v123
    v_mov_b32 v78, v122
    v_accvgpr_read_b32 v124, a151
    v_accvgpr_read_b32 v125, a183
    v_mul_f32 v126, v79, v124
    v_mul_f32 v127, v111, v124
    v_fma_f32 v126, v111, v125, v126
    v_fma_f32 v111, -v79, v125, v127
    v_mov_b32 v79, v126
    v_cvt_pk_bf16_f32 v128, v48, v49
    v_cvt_pk_bf16_f32 v129, v50, v51
    ds_write_b64 v7, v[128:129] offset:0
    v_cvt_pk_bf16_f32 v130, v52, v53
    v_cvt_pk_bf16_f32 v131, v54, v55
    ds_write_b64 v7, v[130:131] offset:16
    v_cvt_pk_bf16_f32 v128, v56, v57
    v_cvt_pk_bf16_f32 v129, v58, v59
    ds_write_b64 v7, v[128:129] offset:32
    v_cvt_pk_bf16_f32 v130, v60, v61
    v_cvt_pk_bf16_f32 v131, v62, v63
    ds_write_b64 v7, v[130:131] offset:48
    v_cvt_pk_bf16_f32 v132, v64, v65
    v_cvt_pk_bf16_f32 v133, v66, v67
    ds_write_b64 v7, v[132:133] offset:2048
    v_cvt_pk_bf16_f32 v134, v68, v69
    v_cvt_pk_bf16_f32 v135, v70, v71
    ds_write_b64 v7, v[134:135] offset:2064
    v_cvt_pk_bf16_f32 v132, v72, v73
    v_cvt_pk_bf16_f32 v133, v74, v75
    ds_write_b64 v7, v[132:133] offset:2080
    v_cvt_pk_bf16_f32 v134, v76, v77
    v_cvt_pk_bf16_f32 v135, v78, v79
    ds_write_b64 v7, v[134:135] offset:2096
    v_cvt_pk_bf16_f32 v136, v80, v81
    v_cvt_pk_bf16_f32 v137, v82, v83
    ds_write_b64 v7, v[136:137] offset:4096
    v_cvt_pk_bf16_f32 v138, v84, v85
    v_cvt_pk_bf16_f32 v139, v86, v87
    ds_write_b64 v7, v[138:139] offset:4112
    v_cvt_pk_bf16_f32 v136, v88, v89
    v_cvt_pk_bf16_f32 v137, v90, v91
    ds_write_b64 v7, v[136:137] offset:4128
    v_cvt_pk_bf16_f32 v138, v92, v93
    v_cvt_pk_bf16_f32 v139, v94, v95
    ds_write_b64 v7, v[138:139] offset:4144
    v_cvt_pk_bf16_f32 v140, v96, v97
    v_cvt_pk_bf16_f32 v141, v98, v99
    ds_write_b64 v7, v[140:141] offset:6144
    v_cvt_pk_bf16_f32 v142, v100, v101
    v_cvt_pk_bf16_f32 v143, v102, v103
    ds_write_b64 v7, v[142:143] offset:6160
    v_cvt_pk_bf16_f32 v140, v104, v105
    v_cvt_pk_bf16_f32 v141, v106, v107
    ds_write_b64 v7, v[140:141] offset:6176
    v_cvt_pk_bf16_f32 v142, v108, v109
    v_cvt_pk_bf16_f32 v143, v110, v111
    ds_write_b64 v7, v[142:143] offset:6192
    s_waitcnt lgkmcnt(0)
    ds_read_b64_tr_b16 v[16:17], v8 offset:0
    ds_read_b64_tr_b16 v[18:19], v8 offset:512
    ds_read_b64_tr_b16 v[20:21], v8 offset:1024
    ds_read_b64_tr_b16 v[22:23], v8 offset:1536
    ds_read_b64_tr_b16 v[24:25], v8 offset:2048
    ds_read_b64_tr_b16 v[26:27], v8 offset:2560
    ds_read_b64_tr_b16 v[28:29], v8 offset:3072
    ds_read_b64_tr_b16 v[30:31], v8 offset:3584
    ds_read_b64_tr_b16 v[32:33], v8 offset:4096
    ds_read_b64_tr_b16 v[34:35], v8 offset:4608
    ds_read_b64_tr_b16 v[36:37], v8 offset:5120
    ds_read_b64_tr_b16 v[38:39], v8 offset:5632
    ds_read_b64_tr_b16 v[40:41], v8 offset:6144
    ds_read_b64_tr_b16 v[42:43], v8 offset:6656
    ds_read_b64_tr_b16 v[44:45], v8 offset:7168
    ds_read_b64_tr_b16 v[46:47], v8 offset:7680
    s_waitcnt lgkmcnt(0)
    v_mfma_f32_32x32x16_bf16 v[48:63], a[24:27], v[16:19], 0
    v_mfma_f32_32x32x16_bf16 v[48:63], a[56:59], v[32:35], v[48:63]
    v_mfma_f32_32x32x16_bf16 v[48:63], a[28:31], v[20:23], v[48:63]
    v_mfma_f32_32x32x16_bf16 v[48:63], a[60:63], v[36:39], v[48:63]
    v_mfma_f32_32x32x16_bf16 v[48:63], a[32:35], v[24:27], v[48:63]
    v_mfma_f32_32x32x16_bf16 v[48:63], a[64:67], v[40:43], v[48:63]
    v_mfma_f32_32x32x16_bf16 v[48:63], a[36:39], v[28:31], v[48:63]
    v_mfma_f32_32x32x16_bf16 v[48:63], a[68:71], v[44:47], v[48:63]
    v_mfma_f32_32x32x16_bf16 v[80:95], a[24:27], v[32:35], 0
    v_mfma_f32_32x32x16_bf16 v[80:95], a[88:91], v[16:19], v[80:95]
    v_mfma_f32_32x32x16_bf16 v[80:95], a[28:31], v[36:39], v[80:95]
    v_mfma_f32_32x32x16_bf16 v[80:95], a[92:95], v[20:23], v[80:95]
    v_mfma_f32_32x32x16_bf16 v[80:95], a[32:35], v[40:43], v[80:95]
    v_mfma_f32_32x32x16_bf16 v[80:95], a[96:99], v[24:27], v[80:95]
    v_mfma_f32_32x32x16_bf16 v[80:95], a[36:39], v[44:47], v[80:95]
    v_mfma_f32_32x32x16_bf16 v[80:95], a[100:103], v[28:31], v[80:95]
    v_mfma_f32_32x32x16_bf16 v[64:79], a[40:43], v[16:19], 0
    v_mfma_f32_32x32x16_bf16 v[64:79], a[72:75], v[32:35], v[64:79]
    v_mfma_f32_32x32x16_bf16 v[64:79], a[44:47], v[20:23], v[64:79]
    v_mfma_f32_32x32x16_bf16 v[64:79], a[76:79], v[36:39], v[64:79]
    v_mfma_f32_32x32x16_bf16 v[64:79], a[48:51], v[24:27], v[64:79]
    v_mfma_f32_32x32x16_bf16 v[64:79], a[80:83], v[40:43], v[64:79]
    v_mfma_f32_32x32x16_bf16 v[64:79], a[52:55], v[28:31], v[64:79]
    v_mfma_f32_32x32x16_bf16 v[64:79], a[84:87], v[44:47], v[64:79]
    v_mfma_f32_32x32x16_bf16 v[96:111], a[40:43], v[32:35], 0
    v_mfma_f32_32x32x16_bf16 v[96:111], a[104:107], v[16:19], v[96:111]
    v_mfma_f32_32x32x16_bf16 v[96:111], a[44:47], v[36:39], v[96:111]
    v_mfma_f32_32x32x16_bf16 v[96:111], a[108:111], v[20:23], v[96:111]
    v_mfma_f32_32x32x16_bf16 v[96:111], a[48:51], v[40:43], v[96:111]
    v_mfma_f32_32x32x16_bf16 v[96:111], a[112:115], v[24:27], v[96:111]
    v_mfma_f32_32x32x16_bf16 v[96:111], a[52:55], v[44:47], v[96:111]
    v_mfma_f32_32x32x16_bf16 v[96:111], a[116:119], v[28:31], v[96:111]
    v_lshlrev_b32 v112, 16, v176
    v_and_b32 v113, 0xffff0000, v176
    v_mul_f32 v114, v48, v112
    v_mul_f32 v115, v80, v112
    v_fma_f32 v114, -v80, v113, v114
    v_fma_f32 v80, v48, v113, v115
    v_mov_b32 v48, v114
    v_lshlrev_b32 v116, 16, v177
    v_and_b32 v117, 0xffff0000, v177
    v_mul_f32 v118, v49, v116
    v_mul_f32 v119, v81, v116
    v_fma_f32 v118, -v81, v117, v118
    v_fma_f32 v81, v49, v117, v119
    v_mov_b32 v49, v118
    v_lshlrev_b32 v120, 16, v178
    v_and_b32 v121, 0xffff0000, v178
    v_mul_f32 v122, v50, v120
    v_mul_f32 v123, v82, v120
    v_fma_f32 v122, -v82, v121, v122
    v_fma_f32 v82, v50, v121, v123
    v_mov_b32 v50, v122
    v_lshlrev_b32 v124, 16, v179
    v_and_b32 v125, 0xffff0000, v179
    v_mul_f32 v126, v51, v124
    v_mul_f32 v127, v83, v124
    v_fma_f32 v126, -v83, v125, v126
    v_fma_f32 v83, v51, v125, v127
    v_mov_b32 v51, v126
    v_lshlrev_b32 v112, 16, v180
    v_and_b32 v113, 0xffff0000, v180
    v_mul_f32 v114, v52, v112
    v_mul_f32 v115, v84, v112
    v_fma_f32 v114, -v84, v113, v114
    v_fma_f32 v84, v52, v113, v115
    v_mov_b32 v52, v114
    v_lshlrev_b32 v116, 16, v181
    v_and_b32 v117, 0xffff0000, v181
    v_mul_f32 v118, v53, v116
    v_mul_f32 v119, v85, v116
    v_fma_f32 v118, -v85, v117, v118
    v_fma_f32 v85, v53, v117, v119
    v_mov_b32 v53, v118
    v_lshlrev_b32 v120, 16, v182
    v_and_b32 v121, 0xffff0000, v182
    v_mul_f32 v122, v54, v120
    v_mul_f32 v123, v86, v120
    v_fma_f32 v122, -v86, v121, v122
    v_fma_f32 v86, v54, v121, v123
    v_mov_b32 v54, v122
    v_lshlrev_b32 v124, 16, v183
    v_and_b32 v125, 0xffff0000, v183
    v_mul_f32 v126, v55, v124
    v_mul_f32 v127, v87, v124
    v_fma_f32 v126, -v87, v125, v126
    v_fma_f32 v87, v55, v125, v127
    v_mov_b32 v55, v126
    v_lshlrev_b32 v112, 16, v184
    v_and_b32 v113, 0xffff0000, v184
    v_mul_f32 v114, v56, v112
    v_mul_f32 v115, v88, v112
    v_fma_f32 v114, -v88, v113, v114
    v_fma_f32 v88, v56, v113, v115
    v_mov_b32 v56, v114
    v_lshlrev_b32 v116, 16, v185
    v_and_b32 v117, 0xffff0000, v185
    v_mul_f32 v118, v57, v116
    v_mul_f32 v119, v89, v116
    v_fma_f32 v118, -v89, v117, v118
    v_fma_f32 v89, v57, v117, v119
    v_mov_b32 v57, v118
    v_lshlrev_b32 v120, 16, v186
    v_and_b32 v121, 0xffff0000, v186
    v_mul_f32 v122, v58, v120
    v_mul_f32 v123, v90, v120
    v_fma_f32 v122, -v90, v121, v122
    v_fma_f32 v90, v58, v121, v123
    v_mov_b32 v58, v122
    v_lshlrev_b32 v124, 16, v187
    v_and_b32 v125, 0xffff0000, v187
    v_mul_f32 v126, v59, v124
    v_mul_f32 v127, v91, v124
    v_fma_f32 v126, -v91, v125, v126
    v_fma_f32 v91, v59, v125, v127
    v_mov_b32 v59, v126
    v_lshlrev_b32 v112, 16, v188
    v_and_b32 v113, 0xffff0000, v188
    v_mul_f32 v114, v60, v112
    v_mul_f32 v115, v92, v112
    v_fma_f32 v114, -v92, v113, v114
    v_fma_f32 v92, v60, v113, v115
    v_mov_b32 v60, v114
    v_lshlrev_b32 v116, 16, v189
    v_and_b32 v117, 0xffff0000, v189
    v_mul_f32 v118, v61, v116
    v_mul_f32 v119, v93, v116
    v_fma_f32 v118, -v93, v117, v118
    v_fma_f32 v93, v61, v117, v119
    v_mov_b32 v61, v118
    v_lshlrev_b32 v120, 16, v190
    v_and_b32 v121, 0xffff0000, v190
    v_mul_f32 v122, v62, v120
    v_mul_f32 v123, v94, v120
    v_fma_f32 v122, -v94, v121, v122
    v_fma_f32 v94, v62, v121, v123
    v_mov_b32 v62, v122
    v_lshlrev_b32 v124, 16, v191
    v_and_b32 v125, 0xffff0000, v191
    v_mul_f32 v126, v63, v124
    v_mul_f32 v127, v95, v124
    v_fma_f32 v126, -v95, v125, v126
    v_fma_f32 v95, v63, v125, v127
    v_mov_b32 v63, v126
    v_lshlrev_b32 v112, 16, v192
    v_and_b32 v113, 0xffff0000, v192
    v_mul_f32 v114, v64, v112
    v_mul_f32 v115, v96, v112
    v_fma_f32 v114, -v96, v113, v114
    v_fma_f32 v96, v64, v113, v115
    v_mov_b32 v64, v114
    v_lshlrev_b32 v116, 16, v193
    v_and_b32 v117, 0xffff0000, v193
    v_mul_f32 v118, v65, v116
    v_mul_f32 v119, v97, v116
    v_fma_f32 v118, -v97, v117, v118
    v_fma_f32 v97, v65, v117, v119
    v_mov_b32 v65, v118
    v_lshlrev_b32 v120, 16, v194
    v_and_b32 v121, 0xffff0000, v194
    v_mul_f32 v122, v66, v120
    v_mul_f32 v123, v98, v120
    v_fma_f32 v122, -v98, v121, v122
    v_fma_f32 v98, v66, v121, v123
    v_mov_b32 v66, v122
    v_lshlrev_b32 v124, 16, v195
    v_and_b32 v125, 0xffff0000, v195
    v_mul_f32 v126, v67, v124
    v_mul_f32 v127, v99, v124
    v_fma_f32 v126, -v99, v125, v126
    v_fma_f32 v99, v67, v125, v127
    v_mov_b32 v67, v126
    v_lshlrev_b32 v112, 16, v196
    v_and_b32 v113, 0xffff0000, v196
    v_mul_f32 v114, v68, v112
    v_mul_f32 v115, v100, v112
    v_fma_f32 v114, -v100, v113, v114
    v_fma_f32 v100, v68, v113, v115
    v_mov_b32 v68, v114
    v_lshlrev_b32 v116, 16, v197
    v_and_b32 v117, 0xffff0000, v197
    v_mul_f32 v118, v69, v116
    v_mul_f32 v119, v101, v116
    v_fma_f32 v118, -v101, v117, v118
    v_fma_f32 v101, v69, v117, v119
    v_mov_b32 v69, v118
    v_lshlrev_b32 v120, 16, v198
    v_and_b32 v121, 0xffff0000, v198
    v_mul_f32 v122, v70, v120
    v_mul_f32 v123, v102, v120
    v_fma_f32 v122, -v102, v121, v122
    v_fma_f32 v102, v70, v121, v123
    v_mov_b32 v70, v122
    v_lshlrev_b32 v124, 16, v199
    v_and_b32 v125, 0xffff0000, v199
    v_mul_f32 v126, v71, v124
    v_mul_f32 v127, v103, v124
    v_fma_f32 v126, -v103, v125, v126
    v_fma_f32 v103, v71, v125, v127
    v_mov_b32 v71, v126
    v_lshlrev_b32 v112, 16, v200
    v_and_b32 v113, 0xffff0000, v200
    v_mul_f32 v114, v72, v112
    v_mul_f32 v115, v104, v112
    v_fma_f32 v114, -v104, v113, v114
    v_fma_f32 v104, v72, v113, v115
    v_mov_b32 v72, v114
    v_lshlrev_b32 v116, 16, v201
    v_and_b32 v117, 0xffff0000, v201
    v_mul_f32 v118, v73, v116
    v_mul_f32 v119, v105, v116
    v_fma_f32 v118, -v105, v117, v118
    v_fma_f32 v105, v73, v117, v119
    v_mov_b32 v73, v118
    v_lshlrev_b32 v120, 16, v202
    v_and_b32 v121, 0xffff0000, v202
    v_mul_f32 v122, v74, v120
    v_mul_f32 v123, v106, v120
    v_fma_f32 v122, -v106, v121, v122
    v_fma_f32 v106, v74, v121, v123
    v_mov_b32 v74, v122
    v_lshlrev_b32 v124, 16, v203
    v_and_b32 v125, 0xffff0000, v203
    v_mul_f32 v126, v75, v124
    v_mul_f32 v127, v107, v124
    v_fma_f32 v126, -v107, v125, v126
    v_fma_f32 v107, v75, v125, v127
    v_mov_b32 v75, v126
    v_lshlrev_b32 v112, 16, v204
    v_and_b32 v113, 0xffff0000, v204
    v_mul_f32 v114, v76, v112
    v_mul_f32 v115, v108, v112
    v_fma_f32 v114, -v108, v113, v114
    v_fma_f32 v108, v76, v113, v115
    v_mov_b32 v76, v114
    v_lshlrev_b32 v116, 16, v205
    v_and_b32 v117, 0xffff0000, v205
    v_mul_f32 v118, v77, v116
    v_mul_f32 v119, v109, v116
    v_fma_f32 v118, -v109, v117, v118
    v_fma_f32 v109, v77, v117, v119
    v_mov_b32 v77, v118
    v_lshlrev_b32 v120, 16, v206
    v_and_b32 v121, 0xffff0000, v206
    v_mul_f32 v122, v78, v120
    v_mul_f32 v123, v110, v120
    v_fma_f32 v122, -v110, v121, v122
    v_fma_f32 v110, v78, v121, v123
    v_mov_b32 v78, v122
    v_lshlrev_b32 v124, 16, v207
    v_and_b32 v125, 0xffff0000, v207
    v_mul_f32 v126, v79, v124
    v_mul_f32 v127, v111, v124
    v_fma_f32 v126, -v111, v125, v126
    v_fma_f32 v111, v79, v125, v127
    v_mov_b32 v79, v126
    v_cvt_pk_bf16_f32 v16, v48, v49
    v_cvt_pk_bf16_f32 v17, v50, v51
    v_cvt_pk_bf16_f32 v18, v52, v53
    v_cvt_pk_bf16_f32 v19, v54, v55
    v_cvt_pk_bf16_f32 v20, v56, v57
    v_cvt_pk_bf16_f32 v21, v58, v59
    v_cvt_pk_bf16_f32 v22, v60, v61
    v_cvt_pk_bf16_f32 v23, v62, v63
    v_cvt_pk_bf16_f32 v24, v64, v65
    v_cvt_pk_bf16_f32 v25, v66, v67
    v_cvt_pk_bf16_f32 v26, v68, v69
    v_cvt_pk_bf16_f32 v27, v70, v71
    v_cvt_pk_bf16_f32 v28, v72, v73
    v_cvt_pk_bf16_f32 v29, v74, v75
    v_cvt_pk_bf16_f32 v30, v76, v77
    v_cvt_pk_bf16_f32 v31, v78, v79
    v_cvt_pk_bf16_f32 v32, v80, v81
    v_cvt_pk_bf16_f32 v33, v82, v83
    v_cvt_pk_bf16_f32 v34, v84, v85
    v_cvt_pk_bf16_f32 v35, v86, v87
    v_cvt_pk_bf16_f32 v36, v88, v89
    v_cvt_pk_bf16_f32 v37, v90, v91
    v_cvt_pk_bf16_f32 v38, v92, v93
    v_cvt_pk_bf16_f32 v39, v94, v95
    v_cvt_pk_bf16_f32 v40, v96, v97
    v_cvt_pk_bf16_f32 v41, v98, v99
    v_cvt_pk_bf16_f32 v42, v100, v101
    v_cvt_pk_bf16_f32 v43, v102, v103
    v_cvt_pk_bf16_f32 v44, v104, v105
    v_cvt_pk_bf16_f32 v45, v106, v107
    v_cvt_pk_bf16_f32 v46, v108, v109
    v_cvt_pk_bf16_f32 v47, v110, v111
    v_mfma_f32_32x32x16_bf16 v[48:63], a[24:27], v[16:19], 0
    v_mfma_f32_32x32x16_bf16 v[48:63], a[88:91], v[32:35], v[48:63]
    v_mfma_f32_32x32x16_bf16 v[48:63], a[28:31], v[20:23], v[48:63]
    v_mfma_f32_32x32x16_bf16 v[48:63], a[92:95], v[36:39], v[48:63]
    v_mfma_f32_32x32x16_bf16 v[48:63], a[32:35], v[24:27], v[48:63]
    v_mfma_f32_32x32x16_bf16 v[48:63], a[96:99], v[40:43], v[48:63]
    v_mfma_f32_32x32x16_bf16 v[48:63], a[36:39], v[28:31], v[48:63]
    v_mfma_f32_32x32x16_bf16 v[48:63], a[100:103], v[44:47], v[48:63]
    v_mfma_f32_32x32x16_bf16 v[80:95], a[24:27], v[32:35], 0
    v_mfma_f32_32x32x16_bf16 v[80:95], a[56:59], v[16:19], v[80:95]
    v_mfma_f32_32x32x16_bf16 v[80:95], a[28:31], v[36:39], v[80:95]
    v_mfma_f32_32x32x16_bf16 v[80:95], a[60:63], v[20:23], v[80:95]
    v_mfma_f32_32x32x16_bf16 v[80:95], a[32:35], v[40:43], v[80:95]
    v_mfma_f32_32x32x16_bf16 v[80:95], a[64:67], v[24:27], v[80:95]
    v_mfma_f32_32x32x16_bf16 v[80:95], a[36:39], v[44:47], v[80:95]
    v_mfma_f32_32x32x16_bf16 v[80:95], a[68:71], v[28:31], v[80:95]
    v_mfma_f32_32x32x16_bf16 v[64:79], a[40:43], v[16:19], 0
    v_mfma_f32_32x32x16_bf16 v[64:79], a[104:107], v[32:35], v[64:79]
    v_mfma_f32_32x32x16_bf16 v[64:79], a[44:47], v[20:23], v[64:79]
    v_mfma_f32_32x32x16_bf16 v[64:79], a[108:111], v[36:39], v[64:79]
    v_mfma_f32_32x32x16_bf16 v[64:79], a[48:51], v[24:27], v[64:79]
    v_mfma_f32_32x32x16_bf16 v[64:79], a[112:115], v[40:43], v[64:79]
    v_mfma_f32_32x32x16_bf16 v[64:79], a[52:55], v[28:31], v[64:79]
    v_mfma_f32_32x32x16_bf16 v[64:79], a[116:119], v[44:47], v[64:79]
    v_mfma_f32_32x32x16_bf16 v[96:111], a[40:43], v[32:35], 0
    v_mfma_f32_32x32x16_bf16 v[96:111], a[72:75], v[16:19], v[96:111]
    v_mfma_f32_32x32x16_bf16 v[96:111], a[44:47], v[36:39], v[96:111]
    v_mfma_f32_32x32x16_bf16 v[96:111], a[76:79], v[20:23], v[96:111]
    v_mfma_f32_32x32x16_bf16 v[96:111], a[48:51], v[40:43], v[96:111]
    v_mfma_f32_32x32x16_bf16 v[96:111], a[80:83], v[24:27], v[96:111]
    v_mfma_f32_32x32x16_bf16 v[96:111], a[52:55], v[44:47], v[96:111]
    v_mfma_f32_32x32x16_bf16 v[96:111], a[84:87], v[28:31], v[96:111]
    v_accvgpr_read_b32 v112, a184
    v_accvgpr_read_b32 v113, a216
    v_mul_f32 v114, v48, v112
    v_mul_f32 v115, v80, v112
    v_fma_f32 v114, -v80, v113, v114
    v_fma_f32 v80, v48, v113, v115
    v_mov_b32 v48, v114
    v_accvgpr_read_b32 v116, a185
    v_accvgpr_read_b32 v117, a217
    v_mul_f32 v118, v49, v116
    v_mul_f32 v119, v81, v116
    v_fma_f32 v118, -v81, v117, v118
    v_fma_f32 v81, v49, v117, v119
    v_mov_b32 v49, v118
    v_accvgpr_read_b32 v120, a186
    v_accvgpr_read_b32 v121, a218
    v_mul_f32 v122, v50, v120
    v_mul_f32 v123, v82, v120
    v_fma_f32 v122, -v82, v121, v122
    v_fma_f32 v82, v50, v121, v123
    v_mov_b32 v50, v122
    v_accvgpr_read_b32 v124, a187
    v_accvgpr_read_b32 v125, a219
    v_mul_f32 v126, v51, v124
    v_mul_f32 v127, v83, v124
    v_fma_f32 v126, -v83, v125, v126
    v_fma_f32 v83, v51, v125, v127
    v_mov_b32 v51, v126
    v_accvgpr_read_b32 v112, a188
    v_accvgpr_read_b32 v113, a220
    v_mul_f32 v114, v52, v112
    v_mul_f32 v115, v84, v112
    v_fma_f32 v114, -v84, v113, v114
    v_fma_f32 v84, v52, v113, v115
    v_mov_b32 v52, v114
    v_accvgpr_read_b32 v116, a189
    v_accvgpr_read_b32 v117, a221
    v_mul_f32 v118, v53, v116
    v_mul_f32 v119, v85, v116
    v_fma_f32 v118, -v85, v117, v118
    v_fma_f32 v85, v53, v117, v119
    v_mov_b32 v53, v118
    v_accvgpr_read_b32 v120, a190
    v_accvgpr_read_b32 v121, a222
    v_mul_f32 v122, v54, v120
    v_mul_f32 v123, v86, v120
    v_fma_f32 v122, -v86, v121, v122
    v_fma_f32 v86, v54, v121, v123
    v_mov_b32 v54, v122
    v_accvgpr_read_b32 v124, a191
    v_accvgpr_read_b32 v125, a223
    v_mul_f32 v126, v55, v124
    v_mul_f32 v127, v87, v124
    v_fma_f32 v126, -v87, v125, v126
    v_fma_f32 v87, v55, v125, v127
    v_mov_b32 v55, v126
    v_accvgpr_read_b32 v112, a192
    v_accvgpr_read_b32 v113, a224
    v_mul_f32 v114, v56, v112
    v_mul_f32 v115, v88, v112
    v_fma_f32 v114, -v88, v113, v114
    v_fma_f32 v88, v56, v113, v115
    v_mov_b32 v56, v114
    v_accvgpr_read_b32 v116, a193
    v_accvgpr_read_b32 v117, a225
    v_mul_f32 v118, v57, v116
    v_mul_f32 v119, v89, v116
    v_fma_f32 v118, -v89, v117, v118
    v_fma_f32 v89, v57, v117, v119
    v_mov_b32 v57, v118
    v_accvgpr_read_b32 v120, a194
    v_accvgpr_read_b32 v121, a226
    v_mul_f32 v122, v58, v120
    v_mul_f32 v123, v90, v120
    v_fma_f32 v122, -v90, v121, v122
    v_fma_f32 v90, v58, v121, v123
    v_mov_b32 v58, v122
    v_accvgpr_read_b32 v124, a195
    v_accvgpr_read_b32 v125, a227
    v_mul_f32 v126, v59, v124
    v_mul_f32 v127, v91, v124
    v_fma_f32 v126, -v91, v125, v126
    v_fma_f32 v91, v59, v125, v127
    v_mov_b32 v59, v126
    v_accvgpr_read_b32 v112, a196
    v_accvgpr_read_b32 v113, a228
    v_mul_f32 v114, v60, v112
    v_mul_f32 v115, v92, v112
    v_fma_f32 v114, -v92, v113, v114
    v_fma_f32 v92, v60, v113, v115
    v_mov_b32 v60, v114
    v_accvgpr_read_b32 v116, a197
    v_accvgpr_read_b32 v117, a229
    v_mul_f32 v118, v61, v116
    v_mul_f32 v119, v93, v116
    v_fma_f32 v118, -v93, v117, v118
    v_fma_f32 v93, v61, v117, v119
    v_mov_b32 v61, v118
    v_accvgpr_read_b32 v120, a198
    v_accvgpr_read_b32 v121, a230
    v_mul_f32 v122, v62, v120
    v_mul_f32 v123, v94, v120
    v_fma_f32 v122, -v94, v121, v122
    v_fma_f32 v94, v62, v121, v123
    v_mov_b32 v62, v122
    v_accvgpr_read_b32 v124, a199
    v_accvgpr_read_b32 v125, a231
    v_mul_f32 v126, v63, v124
    v_mul_f32 v127, v95, v124
    v_fma_f32 v126, -v95, v125, v126
    v_fma_f32 v95, v63, v125, v127
    v_mov_b32 v63, v126
    v_accvgpr_read_b32 v112, a200
    v_accvgpr_read_b32 v113, a232
    v_mul_f32 v114, v64, v112
    v_mul_f32 v115, v96, v112
    v_fma_f32 v114, -v96, v113, v114
    v_fma_f32 v96, v64, v113, v115
    v_mov_b32 v64, v114
    v_accvgpr_read_b32 v116, a201
    v_accvgpr_read_b32 v117, a233
    v_mul_f32 v118, v65, v116
    v_mul_f32 v119, v97, v116
    v_fma_f32 v118, -v97, v117, v118
    v_fma_f32 v97, v65, v117, v119
    v_mov_b32 v65, v118
    v_accvgpr_read_b32 v120, a202
    v_accvgpr_read_b32 v121, a234
    v_mul_f32 v122, v66, v120
    v_mul_f32 v123, v98, v120
    v_fma_f32 v122, -v98, v121, v122
    v_fma_f32 v98, v66, v121, v123
    v_mov_b32 v66, v122
    v_accvgpr_read_b32 v124, a203
    v_accvgpr_read_b32 v125, a235
    v_mul_f32 v126, v67, v124
    v_mul_f32 v127, v99, v124
    v_fma_f32 v126, -v99, v125, v126
    v_fma_f32 v99, v67, v125, v127
    v_mov_b32 v67, v126
    v_accvgpr_read_b32 v112, a204
    v_accvgpr_read_b32 v113, a236
    v_mul_f32 v114, v68, v112
    v_mul_f32 v115, v100, v112
    v_fma_f32 v114, -v100, v113, v114
    v_fma_f32 v100, v68, v113, v115
    v_mov_b32 v68, v114
    v_accvgpr_read_b32 v116, a205
    v_accvgpr_read_b32 v117, a237
    v_mul_f32 v118, v69, v116
    v_mul_f32 v119, v101, v116
    v_fma_f32 v118, -v101, v117, v118
    v_fma_f32 v101, v69, v117, v119
    v_mov_b32 v69, v118
    v_accvgpr_read_b32 v120, a206
    v_accvgpr_read_b32 v121, a238
    v_mul_f32 v122, v70, v120
    v_mul_f32 v123, v102, v120
    v_fma_f32 v122, -v102, v121, v122
    v_fma_f32 v102, v70, v121, v123
    v_mov_b32 v70, v122
    v_accvgpr_read_b32 v124, a207
    v_accvgpr_read_b32 v125, a239
    v_mul_f32 v126, v71, v124
    v_mul_f32 v127, v103, v124
    v_fma_f32 v126, -v103, v125, v126
    v_fma_f32 v103, v71, v125, v127
    v_mov_b32 v71, v126
    v_accvgpr_read_b32 v112, a208
    v_accvgpr_read_b32 v113, a240
    v_mul_f32 v114, v72, v112
    v_mul_f32 v115, v104, v112
    v_fma_f32 v114, -v104, v113, v114
    v_fma_f32 v104, v72, v113, v115
    v_mov_b32 v72, v114
    v_accvgpr_read_b32 v116, a209
    v_accvgpr_read_b32 v117, a241
    v_mul_f32 v118, v73, v116
    v_mul_f32 v119, v105, v116
    v_fma_f32 v118, -v105, v117, v118
    v_fma_f32 v105, v73, v117, v119
    v_mov_b32 v73, v118
    v_accvgpr_read_b32 v120, a210
    v_accvgpr_read_b32 v121, a242
    v_mul_f32 v122, v74, v120
    v_mul_f32 v123, v106, v120
    v_fma_f32 v122, -v106, v121, v122
    v_fma_f32 v106, v74, v121, v123
    v_mov_b32 v74, v122
    v_accvgpr_read_b32 v124, a211
    v_accvgpr_read_b32 v125, a243
    v_mul_f32 v126, v75, v124
    v_mul_f32 v127, v107, v124
    v_fma_f32 v126, -v107, v125, v126
    v_fma_f32 v107, v75, v125, v127
    v_mov_b32 v75, v126
    v_accvgpr_read_b32 v112, a212
    v_accvgpr_read_b32 v113, a244
    v_mul_f32 v114, v76, v112
    v_mul_f32 v115, v108, v112
    v_fma_f32 v114, -v108, v113, v114
    v_fma_f32 v108, v76, v113, v115
    v_mov_b32 v76, v114
    v_accvgpr_read_b32 v116, a213
    v_accvgpr_read_b32 v117, a245
    v_mul_f32 v118, v77, v116
    v_mul_f32 v119, v109, v116
    v_fma_f32 v118, -v109, v117, v118
    v_fma_f32 v109, v77, v117, v119
    v_mov_b32 v77, v118
    v_accvgpr_read_b32 v120, a214
    v_accvgpr_read_b32 v121, a246
    v_mul_f32 v122, v78, v120
    v_mul_f32 v123, v110, v120
    v_fma_f32 v122, -v110, v121, v122
    v_fma_f32 v110, v78, v121, v123
    v_mov_b32 v78, v122
    v_accvgpr_read_b32 v124, a215
    v_accvgpr_read_b32 v125, a247
    v_mul_f32 v126, v79, v124
    v_mul_f32 v127, v111, v124
    v_fma_f32 v126, -v111, v125, v126
    v_fma_f32 v111, v79, v125, v127
    v_mov_b32 v79, v126
    v_cvt_pk_bf16_f32 v128, v48, v49
    v_cvt_pk_bf16_f32 v129, v50, v51
    ds_write_b64 v11, v[128:129] offset:0
    v_cvt_pk_bf16_f32 v130, v52, v53
    v_cvt_pk_bf16_f32 v131, v54, v55
    ds_write_b64 v11, v[130:131] offset:16
    v_cvt_pk_bf16_f32 v128, v56, v57
    v_cvt_pk_bf16_f32 v129, v58, v59
    ds_write_b64 v11, v[128:129] offset:32
    v_cvt_pk_bf16_f32 v130, v60, v61
    v_cvt_pk_bf16_f32 v131, v62, v63
    ds_write_b64 v11, v[130:131] offset:48
    v_cvt_pk_bf16_f32 v132, v64, v65
    v_cvt_pk_bf16_f32 v133, v66, v67
    ds_write_b64 v11, v[132:133] offset:64
    v_cvt_pk_bf16_f32 v134, v68, v69
    v_cvt_pk_bf16_f32 v135, v70, v71
    ds_write_b64 v11, v[134:135] offset:80
    v_cvt_pk_bf16_f32 v132, v72, v73
    v_cvt_pk_bf16_f32 v133, v74, v75
    ds_write_b64 v11, v[132:133] offset:96
    v_cvt_pk_bf16_f32 v134, v76, v77
    v_cvt_pk_bf16_f32 v135, v78, v79
    ds_write_b64 v11, v[134:135] offset:112
    v_cvt_pk_bf16_f32 v136, v80, v81
    v_cvt_pk_bf16_f32 v137, v82, v83
    ds_write_b64 v11, v[136:137] offset:4096
    v_cvt_pk_bf16_f32 v138, v84, v85
    v_cvt_pk_bf16_f32 v139, v86, v87
    ds_write_b64 v11, v[138:139] offset:4112
    v_cvt_pk_bf16_f32 v136, v88, v89
    v_cvt_pk_bf16_f32 v137, v90, v91
    ds_write_b64 v11, v[136:137] offset:4128
    v_cvt_pk_bf16_f32 v138, v92, v93
    v_cvt_pk_bf16_f32 v139, v94, v95
    ds_write_b64 v11, v[138:139] offset:4144
    v_cvt_pk_bf16_f32 v140, v96, v97
    v_cvt_pk_bf16_f32 v141, v98, v99
    ds_write_b64 v11, v[140:141] offset:4160
    v_cvt_pk_bf16_f32 v142, v100, v101
    v_cvt_pk_bf16_f32 v143, v102, v103
    ds_write_b64 v11, v[142:143] offset:4176
    v_cvt_pk_bf16_f32 v140, v104, v105
    v_cvt_pk_bf16_f32 v141, v106, v107
    ds_write_b64 v11, v[140:141] offset:4192
    v_cvt_pk_bf16_f32 v142, v108, v109
    v_cvt_pk_bf16_f32 v143, v110, v111
    ds_write_b64 v11, v[142:143] offset:4208
    s_waitcnt lgkmcnt(0)
    ds_read_b64_tr_b16 v[16:17], v12 offset:0
    ds_read_b64_tr_b16 v[18:19], v12 offset:512
    ds_read_b64_tr_b16 v[20:21], v12 offset:2048
    ds_read_b64_tr_b16 v[22:23], v12 offset:2560
    ds_read_b64_tr_b16 v[24:25], v12 offset:64
    ds_read_b64_tr_b16 v[26:27], v12 offset:576
    ds_read_b64_tr_b16 v[28:29], v12 offset:2112
    ds_read_b64_tr_b16 v[30:31], v12 offset:2624
    ds_read_b64_tr_b16 v[32:33], v12 offset:4096
    ds_read_b64_tr_b16 v[34:35], v12 offset:4608
    ds_read_b64_tr_b16 v[36:37], v12 offset:6144
    ds_read_b64_tr_b16 v[38:39], v12 offset:6656
    ds_read_b64_tr_b16 v[40:41], v12 offset:4160
    ds_read_b64_tr_b16 v[42:43], v12 offset:4672
    ds_read_b64_tr_b16 v[44:45], v12 offset:6208
    ds_read_b64_tr_b16 v[46:47], v12 offset:6720
    s_waitcnt lgkmcnt(0)
    v_mfma_f32_32x32x16_bf16 v[48:63], a[0:3], v[16:19], 0
    v_mfma_f32_32x32x16_bf16 v[48:63], a[16:19], v[32:35], v[48:63]
    v_mfma_f32_32x32x16_bf16 v[48:63], a[4:7], v[20:23], v[48:63]
    v_mfma_f32_32x32x16_bf16 v[48:63], a[20:23], v[36:39], v[48:63]
    v_mfma_f32_32x32x16_bf16 v[80:95], a[0:3], v[32:35], 0
    v_mfma_f32_32x32x16_bf16 v[80:95], a[8:11], v[16:19], v[80:95]
    v_mfma_f32_32x32x16_bf16 v[80:95], a[4:7], v[36:39], v[80:95]
    v_mfma_f32_32x32x16_bf16 v[80:95], a[12:15], v[20:23], v[80:95]
    v_mfma_f32_32x32x16_bf16 v[64:79], a[0:3], v[24:27], 0
    v_mfma_f32_32x32x16_bf16 v[64:79], a[16:19], v[40:43], v[64:79]
    v_mfma_f32_32x32x16_bf16 v[64:79], a[4:7], v[28:31], v[64:79]
    v_mfma_f32_32x32x16_bf16 v[64:79], a[20:23], v[44:47], v[64:79]
    v_mfma_f32_32x32x16_bf16 v[96:111], a[0:3], v[40:43], 0
    v_mfma_f32_32x32x16_bf16 v[96:111], a[8:11], v[24:27], v[96:111]
    v_mfma_f32_32x32x16_bf16 v[96:111], a[4:7], v[44:47], v[96:111]
    v_mfma_f32_32x32x16_bf16 v[96:111], a[12:15], v[28:31], v[96:111]
    s_lshl_b32 s60, s57, 12
    s_add_u32 s60, s60, 0x4c00000
    s_add_u32 s61, s60, 1310720
    v_cvt_pk_bf16_f32 v112, v48, v49
    v_cvt_pk_bf16_f32 v113, v50, v51
    v_cvt_pk_bf16_f32 v114, v52, v53
    v_cvt_pk_bf16_f32 v115, v54, v55
    v_cvt_pk_bf16_f32 v116, v56, v57
    v_cvt_pk_bf16_f32 v117, v58, v59
    v_cvt_pk_bf16_f32 v118, v60, v61
    v_cvt_pk_bf16_f32 v119, v62, v63
    v_permlane32_swap_b32 v112, v114
    v_permlane32_swap_b32 v113, v115
    v_permlane32_swap_b32 v116, v118
    v_permlane32_swap_b32 v117, v119
    buffer_store_dwordx4 v[112:115], v4, s[52:55], s60 offen offset:0 sc1
    buffer_store_dwordx4 v[116:119], v4, s[52:55], s60 offen offset:32 sc1
    v_cvt_pk_bf16_f32 v120, v64, v65
    v_cvt_pk_bf16_f32 v121, v66, v67
    v_cvt_pk_bf16_f32 v122, v68, v69
    v_cvt_pk_bf16_f32 v123, v70, v71
    v_cvt_pk_bf16_f32 v124, v72, v73
    v_cvt_pk_bf16_f32 v125, v74, v75
    v_cvt_pk_bf16_f32 v126, v76, v77
    v_cvt_pk_bf16_f32 v127, v78, v79
    v_permlane32_swap_b32 v120, v122
    v_permlane32_swap_b32 v121, v123
    v_permlane32_swap_b32 v124, v126
    v_permlane32_swap_b32 v125, v127
    buffer_store_dwordx4 v[120:123], v4, s[52:55], s60 offen offset:2048 sc1
    buffer_store_dwordx4 v[124:127], v4, s[52:55], s60 offen offset:2080 sc1
    s_cmp_eq_u32 s58, 0
    s_cbranch_scc1 .a2e_60
    v_cvt_pk_bf16_f32 v128, v80, v81
    v_cvt_pk_bf16_f32 v129, v82, v83
    v_cvt_pk_bf16_f32 v130, v84, v85
    v_cvt_pk_bf16_f32 v131, v86, v87
    v_cvt_pk_bf16_f32 v132, v88, v89
    v_cvt_pk_bf16_f32 v133, v90, v91
    v_cvt_pk_bf16_f32 v134, v92, v93
    v_cvt_pk_bf16_f32 v135, v94, v95
    v_permlane32_swap_b32 v128, v130
    v_permlane32_swap_b32 v129, v131
    v_permlane32_swap_b32 v132, v134
    v_permlane32_swap_b32 v133, v135
    buffer_store_dwordx4 v[128:131], v4, s[52:55], s61 offen offset:0 sc1
    buffer_store_dwordx4 v[132:135], v4, s[52:55], s61 offen offset:32 sc1
    v_cvt_pk_bf16_f32 v136, v96, v97
    v_cvt_pk_bf16_f32 v137, v98, v99
    v_cvt_pk_bf16_f32 v138, v100, v101
    v_cvt_pk_bf16_f32 v139, v102, v103
    v_cvt_pk_bf16_f32 v140, v104, v105
    v_cvt_pk_bf16_f32 v141, v106, v107
    v_cvt_pk_bf16_f32 v142, v108, v109
    v_cvt_pk_bf16_f32 v143, v110, v111
    v_permlane32_swap_b32 v136, v138
    v_permlane32_swap_b32 v137, v139
    v_permlane32_swap_b32 v140, v142
    v_permlane32_swap_b32 v141, v143
    buffer_store_dwordx4 v[136:139], v4, s[52:55], s61 offen offset:2048 sc1
    buffer_store_dwordx4 v[140:143], v4, s[52:55], s61 offen offset:2080 sc1
.a2e_60:
    s_mov_b32 s75, 28
    s_waitcnt vmcnt(0)
    s_barrier
    v_mov_b32 v1, s75
    v_mov_b32 v2, 1
    v_cmp_eq_u32 vcc, 0, v0
    s_nop 0
    s_and_saveexec_b64 s[6:7], vcc
    s_cbranch_execz .sg_63
    global_atomic_add v1, v2, s[38:39]
.sg_63:
    s_mov_b64 exec, s[6:7]
    s_branch .work_8
.task_34:
    s_mov_b32 s73, 28
    s_mov_b32 s74, 81
    v_readfirstlane_b32 s71, v0
    s_nop 0
    s_cmp_ge_u32 s71, 64
    s_cbranch_scc1 .wo_65
    v_mov_b32 v1, s73
    s_mov_b32 s57, 0
.wl_64:
    global_load_dword v2, v1, s[38:39] sc1
    s_waitcnt vmcnt(0)
    v_readfirstlane_b32 s71, v2
    s_nop 0
    s_cmp_ge_u32 s71, s74
    s_cbranch_scc1 .wo_65
    s_sleep 24
    s_add_u32 s57, s57, 1
    s_cmp_lt_u32 s57, 3000000
    s_cbranch_scc1 .wl_64
    s_branch .abort_1
.wo_65:
    s_barrier
    s_and_b32 s56, s72, 15
    s_lshr_b32 s57, s72, 4
    s_mov_b32 s44, s36
    s_and_b32 s45, s37, 0xffff
    s_mov_b32 s46, 0x500000
    s_mov_b32 s47, 0x00020000
    s_mov_b32 s52, s40
    s_and_b32 s53, s41, 0xffff
    s_mov_b32 s54, 0xfe00000
    s_mov_b32 s55, 0x00020000
    s_lshl_b32 s69, s56, 7
    s_mul_i32 s66, s57, 163840
    s_add_u32 s66, s66, 0x5100000
    s_lshl_b32 s67, s56, 8
    s_add_u32 s67, s67, 0x4c00000
    s_lshl_b32 s68, s57, 8
    v_and_b32 v8, 63, v0
    v_lshrrev_b32 v9, 6, v0
    s_nop 0
    v_readfirstlane_b32 s63, v9
    v_lshrrev_b32 v10, 2, v8
    v_mov_b32 v11, 32
    v_mad_u32_u24 v10, v9, v11, v10
    s_mov_b32 s64, 1280
    v_mul_lo_u32 v10, v10, s64
    v_lshrrev_b32 v11, 4, v8
    v_xor_b32 v11, v11, v8
    v_and_b32 v11, 3, v11
    v_lshl_add_u32 v13, v11, 4, v10
    v_lshrrev_b32 v10, 2, v8
    v_mov_b32 v11, 32
    v_mad_u32_u24 v10, v9, v11, v10
    v_add_u32 v10, 16, v10
    s_mov_b32 s64, 1280
    v_mul_lo_u32 v10, v10, s64
    v_lshrrev_b32 v11, 4, v8
    v_xor_b32 v11, v11, v8
    v_and_b32 v11, 3, v11
    v_lshl_add_u32 v14, v11, 4, v10
    v_mov_b32 v11, 128
    v_mad_u32_u24 v10, v9, v11, v8
    v_lshrrev_b32 v11, 4, v10
    v_and_b32 v10, 15, v10
    v_and_b32 v12, 3, v11
    v_lshlrev_b32 v12, 2, v12
    v_xor_b32 v10, v10, v12
    s_mov_b32 s64, 4096
    v_mul_lo_u32 v11, v11, s64
    v_lshl_add_u32 v15, v10, 4, v11
    v_mov_b32 v11, 128
    v_mad_u32_u24 v10, v9, v11, v8
    v_add_u32 v10, 64, v10
    v_lshrrev_b32 v11, 4, v10
    v_and_b32 v10, 15, v10
    v_and_b32 v12, 3, v11
    v_lshlrev_b32 v12, 2, v12
    v_xor_b32 v10, v10, v12
    s_mov_b32 s64, 4096
    v_mul_lo_u32 v11, v11, s64
    v_lshl_add_u32 v16, v10, 4, v11
    v_lshrrev_b32 v12, 1, v9
    v_and_b32 v10, 31, v8
    v_lshrrev_b32 v11, 5, v8
    v_bfe_u32 v17, v8, 2, 2
    v_xor_b32 v11, v11, v17
    v_lshlrev_b32 v11, 4, v11
    v_lshl_add_u32 v10, v10, 6, v11
    v_mov_b32 v11, 4096
    v_mad_u32_u24 v10, v12, v11, v10
    v_add_u32 v17, 0, v10
    v_and_b32 v10, 31, v8
    v_lshrrev_b32 v11, 5, v8
    v_add_u32 v11, 2, v11
    v_bfe_u32 v18, v8, 2, 2
    v_xor_b32 v11, v11, v18
    v_lshlrev_b32 v11, 4, v11
    v_lshl_add_u32 v10, v10, 6, v11
    v_mov_b32 v11, 4096
    v_mad_u32_u24 v10, v12, v11, v10
    v_add_u32 v18, 0, v10
    v_and_b32 v12, 1, v9
    v_bfe_u32 v10, v8, 2, 2
    v_mov_b32 v11, 2
    v_mad_u32_u24 v11, v12, v11, 0
    v_xor_b32 v11, v11, v10
    v_lshlrev_b32 v11, 6, v11
    v_lshrrev_b32 v19, 5, v8
    v_lshl_add_u32 v10, v19, 3, v10
    v_mov_b32 v19, 256
    v_mad_u32_u24 v11, v10, v19, v11
    v_bfe_u32 v10, v8, 4, 1
    v_lshl_add_u32 v11, v10, 5, v11
    v_and_b32 v10, 3, v8
    v_lshl_add_u32 v11, v10, 3, v11
    v_add_u32 v19, 8192, v11
    v_bfe_u32 v10, v8, 2, 2
    v_mov_b32 v11, 2
    v_mad_u32_u24 v11, v12, v11, 1
    v_xor_b32 v11, v11, v10
    v_lshlrev_b32 v11, 6, v11
    v_lshrrev_b32 v20, 5, v8
    v_lshl_add_u32 v10, v20, 3, v10
    v_mov_b32 v20, 256
    v_mad_u32_u24 v11, v10, v20, v11
    v_bfe_u32 v10, v8, 4, 1
    v_lshl_add_u32 v11, v10, 5, v11
    v_and_b32 v10, 3, v8
    v_lshl_add_u32 v11, v10, 3, v11
    v_add_u32 v20, 8192, v11
    s_mul_i32 s61, s63, 2048
    s_mov_b32 s60, 0
    s_mul_i32 s64, s63, 0
    s_add_u32 s64, s64, s61
    s_add_u32 s64, s64, 8192
    s_add_u32 m0, s61, 0
    s_nop 0
    buffer_load_dwordx4 v13, s[52:55], s66 offen sc1 lds
    s_add_u32 m0, s61, 1024
    s_nop 0
    buffer_load_dwordx4 v14, s[52:55], s66 offen sc1 lds
    s_add_u32 m0, s64, 0
    s_nop 0
    buffer_load_dwordx4 v15, s[52:55], s67 offen sc1 lds
    s_add_u32 m0, s64, 1024
    s_nop 0
    buffer_load_dwordx4 v16, s[52:55], s67 offen sc1 lds
    s_add_u32 s66, s66, 64
    s_add_u32 s67, s67, 131072
    s_add_u32 s61, s61, 16384
    s_cmp_ge_u32 s61, 65536
    s_cselect_b32 s65, 65536, 0
    s_sub_u32 s61, s61, s65
    s_mul_i32 s64, s63, 0
    s_add_u32 s64, s64, s61
    s_add_u32 s64, s64, 8192
    s_add_u32 m0, s61, 0
    s_nop 0
    buffer_load_dwordx4 v13, s[52:55], s66 offen sc1 lds
    s_add_u32 m0, s61, 1024
    s_nop 0
    buffer_load_dwordx4 v14, s[52:55], s66 offen sc1 lds
    s_add_u32 m0, s64, 0
    s_nop 0
    buffer_load_dwordx4 v15, s[52:55], s67 offen sc1 lds
    s_add_u32 m0, s64, 1024
    s_nop 0
    buffer_load_dwordx4 v16, s[52:55], s67 offen sc1 lds
    s_add_u32 s66, s66, 64
    s_add_u32 s67, s67, 131072
    s_add_u32 s61, s61, 16384
    s_cmp_ge_u32 s61, 65536
    s_cselect_b32 s65, 65536, 0
    s_sub_u32 s61, s61, s65
    s_mul_i32 s64, s63, 0
    s_add_u32 s64, s64, s61
    s_add_u32 s64, s64, 8192
    s_add_u32 m0, s61, 0
    s_nop 0
    buffer_load_dwordx4 v13, s[52:55], s66 offen sc1 lds
    s_add_u32 m0, s61, 1024
    s_nop 0
    buffer_load_dwordx4 v14, s[52:55], s66 offen sc1 lds
    s_add_u32 m0, s64, 0
    s_nop 0
    buffer_load_dwordx4 v15, s[52:55], s67 offen sc1 lds
    s_add_u32 m0, s64, 1024
    s_nop 0
    buffer_load_dwordx4 v16, s[52:55], s67 offen sc1 lds
    s_add_u32 s66, s66, 64
    s_add_u32 s67, s67, 131072
    s_add_u32 s61, s61, 16384
    s_cmp_ge_u32 s61, 65536
    s_cselect_b32 s65, 65536, 0
    s_sub_u32 s61, s61, s65
    v_add_u32 v21, s60, v17
    v_add_u32 v22, s60, v18
    v_add_u32 v23, s60, v19
    v_add_u32 v24, s60, v20
    s_add_u32 s60, s60, 16384
    s_cmp_ge_u32 s60, 65536
    s_cselect_b32 s60, 0, s60
    s_waitcnt vmcnt(8)
    s_barrier
    ds_read_b128 v[28:31], v21 offset:0
    ds_read_b128 v[32:35], v21 offset:2048
    ds_read_b64_tr_b16 v[44:45], v23 offset:0
    ds_read_b64_tr_b16 v[46:47], v23 offset:1024
    ds_read_b64_tr_b16 v[48:49], v24 offset:0
    ds_read_b64_tr_b16 v[50:51], v24 offset:1024
    s_waitcnt lgkmcnt(0)
    v_mfma_f32_32x32x16_bf16 a[0:15], v[28:31], v[44:47], 0
    ds_read_b128 v[36:39], v22 offset:0
    ds_read_b128 v[40:43], v22 offset:2048
    v_mfma_f32_32x32x16_bf16 a[16:31], v[28:31], v[48:51], 0
    ds_read_b64_tr_b16 v[52:53], v23 offset:4096
    ds_read_b64_tr_b16 v[54:55], v23 offset:5120
    v_mfma_f32_32x32x16_bf16 a[32:47], v[32:35], v[44:47], 0
    ds_read_b64_tr_b16 v[56:57], v24 offset:4096
    ds_read_b64_tr_b16 v[58:59], v24 offset:5120
    v_mfma_f32_32x32x16_bf16 a[48:63], v[32:35], v[48:51], 0
    s_waitcnt vmcnt(4)
    s_barrier
    v_add_u32 v21, s60, v17
    v_add_u32 v22, s60, v18
    v_add_u32 v23, s60, v19
    v_add_u32 v24, s60, v20
    s_add_u32 s60, s60, 16384
    s_cmp_ge_u32 s60, 65536
    s_cselect_b32 s60, 0, s60
    s_mul_i32 s64, s63, 0
    s_add_u32 s64, s64, s61
    s_add_u32 s64, s64, 8192
    s_waitcnt lgkmcnt(0)
    v_mfma_f32_32x32x16_bf16 a[0:15], v[36:39], v[52:55], a[0:15]
    ds_read_b128 v[28:31], v21 offset:0
    ds_read_b128 v[32:35], v21 offset:2048
    ds_read_b64_tr_b16 v[44:45], v23 offset:0
    v_mfma_f32_32x32x16_bf16 a[16:31], v[36:39], v[56:59], a[16:31]
    ds_read_b64_tr_b16 v[46:47], v23 offset:1024
    ds_read_b64_tr_b16 v[48:49], v24 offset:0
    ds_read_b64_tr_b16 v[50:51], v24 offset:1024
    v_mfma_f32_32x32x16_bf16 a[32:47], v[40:43], v[52:55], a[32:47]
    s_add_u32 m0, s61, 0
    s_nop 0
    buffer_load_dwordx4 v13, s[52:55], s66 offen sc1 lds
    s_add_u32 m0, s61, 1024
    s_nop 0
    buffer_load_dwordx4 v14, s[52:55], s66 offen sc1 lds
    s_add_u32 m0, s64, 0
    s_nop 0
    buffer_load_dwordx4 v15, s[52:55], s67 offen sc1 lds
    v_mfma_f32_32x32x16_bf16 a[48:63], v[40:43], v[56:59], a[48:63]
    s_add_u32 m0, s64, 1024
    s_nop 0
    buffer_load_dwordx4 v16, s[52:55], s67 offen sc1 lds
    s_add_u32 s66, s66, 64
    s_add_u32 s67, s67, 131072
    s_add_u32 s61, s61, 16384
    s_cmp_ge_u32 s61, 65536
    s_cselect_b32 s65, 65536, 0
    s_sub_u32 s61, s61, s65
    s_mov_b32 s62, 16
.gl_66:
    s_waitcnt lgkmcnt(0)
    v_mfma_f32_32x32x16_bf16 a[0:15], v[28:31], v[44:47], a[0:15]
    ds_read_b128 v[36:39], v22 offset:0
    ds_read_b128 v[40:43], v22 offset:2048
    v_mfma_f32_32x32x16_bf16 a[16:31], v[28:31], v[48:51], a[16:31]
    ds_read_b64_tr_b16 v[52:53], v23 offset:4096
    ds_read_b64_tr_b16 v[54:55], v23 offset:5120
    v_mfma_f32_32x32x16_bf16 a[32:47], v[32:35], v[44:47], a[32:47]
    ds_read_b64_tr_b16 v[56:57], v24 offset:4096
    ds_read_b64_tr_b16 v[58:59], v24 offset:5120
    v_mfma_f32_32x32x16_bf16 a[48:63], v[32:35], v[48:51], a[48:63]
    s_waitcnt vmcnt(4)
    s_barrier
    v_add_u32 v21, s60, v17
    v_add_u32 v22, s60, v18
    v_add_u32 v23, s60, v19
    v_add_u32 v24, s60, v20
    s_add_u32 s60, s60, 16384
    s_cmp_ge_u32 s60, 65536
    s_cselect_b32 s60, 0, s60
    s_mul_i32 s64, s63, 0
    s_add_u32 s64, s64, s61
    s_add_u32 s64, s64, 8192
    s_waitcnt lgkmcnt(0)
    v_mfma_f32_32x32x16_bf16 a[0:15], v[36:39], v[52:55], a[0:15]
    ds_read_b128 v[28:31], v21 offset:0
    ds_read_b128 v[32:35], v21 offset:2048
    ds_read_b64_tr_b16 v[44:45], v23 offset:0
    v_mfma_f32_32x32x16_bf16 a[16:31], v[36:39], v[56:59], a[16:31]
    ds_read_b64_tr_b16 v[46:47], v23 offset:1024
    ds_read_b64_tr_b16 v[48:49], v24 offset:0
    ds_read_b64_tr_b16 v[50:51], v24 offset:1024
    v_mfma_f32_32x32x16_bf16 a[32:47], v[40:43], v[52:55], a[32:47]
    s_add_u32 m0, s61, 0
    s_nop 0
    buffer_load_dwordx4 v13, s[52:55], s66 offen sc1 lds
    s_add_u32 m0, s61, 1024
    s_nop 0
    buffer_load_dwordx4 v14, s[52:55], s66 offen sc1 lds
    s_add_u32 m0, s64, 0
    s_nop 0
    buffer_load_dwordx4 v15, s[52:55], s67 offen sc1 lds
    v_mfma_f32_32x32x16_bf16 a[48:63], v[40:43], v[56:59], a[48:63]
    s_add_u32 m0, s64, 1024
    s_nop 0
    buffer_load_dwordx4 v16, s[52:55], s67 offen sc1 lds
    s_add_u32 s66, s66, 64
    s_add_u32 s67, s67, 131072
    s_add_u32 s61, s61, 16384
    s_cmp_ge_u32 s61, 65536
    s_cselect_b32 s65, 65536, 0
    s_sub_u32 s61, s61, s65
    s_sub_u32 s62, s62, 1
    s_cmp_lg_u32 s62, 0
    s_cbranch_scc1 .gl_66
    s_waitcnt lgkmcnt(0)
    v_mfma_f32_32x32x16_bf16 a[0:15], v[28:31], v[44:47], a[0:15]
    ds_read_b128 v[36:39], v22 offset:0
    ds_read_b128 v[40:43], v22 offset:2048
    v_mfma_f32_32x32x16_bf16 a[16:31], v[28:31], v[48:51], a[16:31]
    ds_read_b64_tr_b16 v[52:53], v23 offset:4096
    ds_read_b64_tr_b16 v[54:55], v23 offset:5120
    v_mfma_f32_32x32x16_bf16 a[32:47], v[32:35], v[44:47], a[32:47]
    ds_read_b64_tr_b16 v[56:57], v24 offset:4096
    ds_read_b64_tr_b16 v[58:59], v24 offset:5120
    v_mfma_f32_32x32x16_bf16 a[48:63], v[32:35], v[48:51], a[48:63]
    s_waitcnt vmcnt(4)
    s_barrier
    v_add_u32 v21, s60, v17
    v_add_u32 v22, s60, v18
    v_add_u32 v23, s60, v19
    v_add_u32 v24, s60, v20
    s_add_u32 s60, s60, 16384
    s_cmp_ge_u32 s60, 65536
    s_cselect_b32 s60, 0, s60
    s_waitcnt lgkmcnt(0)
    v_mfma_f32_32x32x16_bf16 a[0:15], v[36:39], v[52:55], a[0:15]
    ds_read_b128 v[28:31], v21 offset:0
    ds_read_b128 v[32:35], v21 offset:2048
    v_mfma_f32_32x32x16_bf16 a[16:31], v[36:39], v[56:59], a[16:31]
    ds_read_b64_tr_b16 v[44:45], v23 offset:0
    ds_read_b64_tr_b16 v[46:47], v23 offset:1024
    v_mfma_f32_32x32x16_bf16 a[32:47], v[40:43], v[52:55], a[32:47]
    ds_read_b64_tr_b16 v[48:49], v24 offset:0
    ds_read_b64_tr_b16 v[50:51], v24 offset:1024
    v_mfma_f32_32x32x16_bf16 a[48:63], v[40:43], v[56:59], a[48:63]
    s_waitcnt lgkmcnt(0)
    v_mfma_f32_32x32x16_bf16 a[0:15], v[28:31], v[44:47], a[0:15]
    ds_read_b128 v[36:39], v22 offset:0
    ds_read_b128 v[40:43], v22 offset:2048
    v_mfma_f32_32x32x16_bf16 a[16:31], v[28:31], v[48:51], a[16:31]
    ds_read_b64_tr_b16 v[52:53], v23 offset:4096
    ds_read_b64_tr_b16 v[54:55], v23 offset:5120
    v_mfma_f32_32x32x16_bf16 a[32:47], v[32:35], v[44:47], a[32:47]
    ds_read_b64_tr_b16 v[56:57], v24 offset:4096
    ds_read_b64_tr_b16 v[58:59], v24 offset:5120
    v_mfma_f32_32x32x16_bf16 a[48:63], v[32:35], v[48:51], a[48:63]
    s_waitcnt vmcnt(0)
    s_barrier
    v_add_u32 v21, s60, v17
    v_add_u32 v22, s60, v18
    v_add_u32 v23, s60, v19
    v_add_u32 v24, s60, v20
    s_add_u32 s60, s60, 16384
    s_cmp_ge_u32 s60, 65536
    s_cselect_b32 s60, 0, s60
    s_waitcnt lgkmcnt(0)
    v_mfma_f32_32x32x16_bf16 a[0:15], v[36:39], v[52:55], a[0:15]
    ds_read_b128 v[28:31], v21 offset:0
    ds_read_b128 v[32:35], v21 offset:2048
    v_mfma_f32_32x32x16_bf16 a[16:31], v[36:39], v[56:59], a[16:31]
    ds_read_b64_tr_b16 v[44:45], v23 offset:0
    ds_read_b64_tr_b16 v[46:47], v23 offset:1024
    v_mfma_f32_32x32x16_bf16 a[32:47], v[40:43], v[52:55], a[32:47]
    ds_read_b64_tr_b16 v[48:49], v24 offset:0
    ds_read_b64_tr_b16 v[50:51], v24 offset:1024
    v_mfma_f32_32x32x16_bf16 a[48:63], v[40:43], v[56:59], a[48:63]
    s_waitcnt lgkmcnt(0)
    v_mfma_f32_32x32x16_bf16 a[0:15], v[28:31], v[44:47], a[0:15]
    ds_read_b128 v[36:39], v22 offset:0
    ds_read_b128 v[40:43], v22 offset:2048
    v_mfma_f32_32x32x16_bf16 a[16:31], v[28:31], v[48:51], a[16:31]
    ds_read_b64_tr_b16 v[52:53], v23 offset:4096
    ds_read_b64_tr_b16 v[54:55], v23 offset:5120
    v_mfma_f32_32x32x16_bf16 a[32:47], v[32:35], v[44:47], a[32:47]
    ds_read_b64_tr_b16 v[56:57], v24 offset:4096
    ds_read_b64_tr_b16 v[58:59], v24 offset:5120
    v_mfma_f32_32x32x16_bf16 a[48:63], v[32:35], v[48:51], a[48:63]
    s_waitcnt lgkmcnt(0)
    v_mfma_f32_32x32x16_bf16 a[0:15], v[36:39], v[52:55], a[0:15]
    v_mfma_f32_32x32x16_bf16 a[16:31], v[36:39], v[56:59], a[16:31]
    v_mfma_f32_32x32x16_bf16 a[32:47], v[40:43], v[52:55], a[32:47]
    v_mfma_f32_32x32x16_bf16 a[48:63], v[40:43], v[56:59], a[48:63]
    s_barrier
    s_mul_i32 s64, s63, 9216
    v_and_b32 v10, 31, v8
    v_mul_u32_u24 v10, 144, v10
    v_lshrrev_b32 v11, 5, v8
    v_lshl_add_u32 v10, v11, 4, v10
    v_add_u32 v13, s64, v10
    v_lshrrev_b32 v10, 3, v8
    v_mul_u32_u24 v10, 144, v10
    v_and_b32 v11, 7, v8
    v_lshl_add_u32 v10, v11, 4, v10
    v_add_u32 v14, s64, v10
    v_accvgpr_read_b32 v28, a0
    v_accvgpr_read_b32 v29, a1
    v_accvgpr_read_b32 v30, a2
    v_accvgpr_read_b32 v31, a3
    v_accvgpr_read_b32 v32, a4
    v_accvgpr_read_b32 v33, a5
    v_accvgpr_read_b32 v34, a6
    v_accvgpr_read_b32 v35, a7
    v_accvgpr_read_b32 v36, a8
    v_accvgpr_read_b32 v37, a9
    v_accvgpr_read_b32 v38, a10
    v_accvgpr_read_b32 v39, a11
    v_accvgpr_read_b32 v40, a12
    v_accvgpr_read_b32 v41, a13
    v_accvgpr_read_b32 v42, a14
    v_accvgpr_read_b32 v43, a15
    v_cvt_pk_bf16_f32 v44, v28, v29
    v_cvt_pk_bf16_f32 v45, v30, v31
    v_cvt_pk_bf16_f32 v46, v32, v33
    v_cvt_pk_bf16_f32 v47, v34, v35
    v_cvt_pk_bf16_f32 v48, v36, v37
    v_cvt_pk_bf16_f32 v49, v38, v39
    v_cvt_pk_bf16_f32 v50, v40, v41
    v_cvt_pk_bf16_f32 v51, v42, v43
    v_permlane32_swap_b32 v44, v46
    v_permlane32_swap_b32 v45, v47
    v_permlane32_swap_b32 v48, v50
    v_permlane32_swap_b32 v49, v51
    ds_write_b128 v13, v[44:47] offset:0
    ds_write_b128 v13, v[48:51] offset:32
    v_accvgpr_read_b32 v52, a16
    v_accvgpr_read_b32 v53, a17
    v_accvgpr_read_b32 v54, a18
    v_accvgpr_read_b32 v55, a19
    v_accvgpr_read_b32 v56, a20
    v_accvgpr_read_b32 v57, a21
    v_accvgpr_read_b32 v58, a22
    v_accvgpr_read_b32 v59, a23
    v_accvgpr_read_b32 v60, a24
    v_accvgpr_read_b32 v61, a25
    v_accvgpr_read_b32 v62, a26
    v_accvgpr_read_b32 v63, a27
    v_accvgpr_read_b32 v64, a28
    v_accvgpr_read_b32 v65, a29
    v_accvgpr_read_b32 v66, a30
    v_accvgpr_read_b32 v67, a31
    v_cvt_pk_bf16_f32 v68, v52, v53
    v_cvt_pk_bf16_f32 v69, v54, v55
    v_cvt_pk_bf16_f32 v70, v56, v57
    v_cvt_pk_bf16_f32 v71, v58, v59
    v_cvt_pk_bf16_f32 v72, v60, v61
    v_cvt_pk_bf16_f32 v73, v62, v63
    v_cvt_pk_bf16_f32 v74, v64, v65
    v_cvt_pk_bf16_f32 v75, v66, v67
    v_permlane32_swap_b32 v68, v70
    v_permlane32_swap_b32 v69, v71
    v_permlane32_swap_b32 v72, v74
    v_permlane32_swap_b32 v73, v75
    ds_write_b128 v13, v[68:71] offset:4608
    ds_write_b128 v13, v[72:75] offset:4640
    v_accvgpr_read_b32 v28, a32
    v_accvgpr_read_b32 v29, a33
    v_accvgpr_read_b32 v30, a34
    v_accvgpr_read_b32 v31, a35
    v_accvgpr_read_b32 v32, a36
    v_accvgpr_read_b32 v33, a37
    v_accvgpr_read_b32 v34, a38
    v_accvgpr_read_b32 v35, a39
    v_accvgpr_read_b32 v36, a40
    v_accvgpr_read_b32 v37, a41
    v_accvgpr_read_b32 v38, a42
    v_accvgpr_read_b32 v39, a43
    v_accvgpr_read_b32 v40, a44
    v_accvgpr_read_b32 v41, a45
    v_accvgpr_read_b32 v42, a46
    v_accvgpr_read_b32 v43, a47
    v_cvt_pk_bf16_f32 v44, v28, v29
    v_cvt_pk_bf16_f32 v45, v30, v31
    v_cvt_pk_bf16_f32 v46, v32, v33
    v_cvt_pk_bf16_f32 v47, v34, v35
    v_cvt_pk_bf16_f32 v48, v36, v37
    v_cvt_pk_bf16_f32 v49, v38, v39
    v_cvt_pk_bf16_f32 v50, v40, v41
    v_cvt_pk_bf16_f32 v51, v42, v43
    v_permlane32_swap_b32 v44, v46
    v_permlane32_swap_b32 v45, v47
    v_permlane32_swap_b32 v48, v50
    v_permlane32_swap_b32 v49, v51
    ds_write_b128 v13, v[44:47] offset:64
    ds_write_b128 v13, v[48:51] offset:96
    v_accvgpr_read_b32 v52, a48
    v_accvgpr_read_b32 v53, a49
    v_accvgpr_read_b32 v54, a50
    v_accvgpr_read_b32 v55, a51
    v_accvgpr_read_b32 v56, a52
    v_accvgpr_read_b32 v57, a53
    v_accvgpr_read_b32 v58, a54
    v_accvgpr_read_b32 v59, a55
    v_accvgpr_read_b32 v60, a56
    v_accvgpr_read_b32 v61, a57
    v_accvgpr_read_b32 v62, a58
    v_accvgpr_read_b32 v63, a59
    v_accvgpr_read_b32 v64, a60
    v_accvgpr_read_b32 v65, a61
    v_accvgpr_read_b32 v66, a62
    v_accvgpr_read_b32 v67, a63
    v_cvt_pk_bf16_f32 v68, v52, v53
    v_cvt_pk_bf16_f32 v69, v54, v55
    v_cvt_pk_bf16_f32 v70, v56, v57
    v_cvt_pk_bf16_f32 v71, v58, v59
    v_cvt_pk_bf16_f32 v72, v60, v61
    v_cvt_pk_bf16_f32 v73, v62, v63
    v_cvt_pk_bf16_f32 v74, v64, v65
    v_cvt_pk_bf16_f32 v75, v66, v67
    v_permlane32_swap_b32 v68, v70
    v_permlane32_swap_b32 v69, v71
    v_permlane32_swap_b32 v72, v74
    v_permlane32_swap_b32 v73, v75
    ds_write_b128 v13, v[68:71] offset:4672
    ds_write_b128 v13, v[72:75] offset:4704
    v_lshrrev_b32 v11, 1, v9
    v_mul_u32_u24 v11, 128, v11
    v_and_b32 v12, 7, v8
    v_lshl_add_u32 v15, v12, 4, v11
    v_and_b32 v10, 1, v9
    v_mul_u32_u24 v10, 64, v10
    v_lshrrev_b32 v11, 3, v8
    v_add_u32 v16, v10, v11
    s_waitcnt lgkmcnt(0)
    s_mov_b32 s64, 2560
    ds_read_b128 v[28:31], v14 offset:0
    ds_read_b128 v[32:35], v14 offset:1152
    ds_read_b128 v[36:39], v14 offset:2304
    ds_read_b128 v[40:43], v14 offset:3456
    ds_read_b128 v[44:47], v14 offset:4608
    ds_read_b128 v[48:51], v14 offset:5760
    ds_read_b128 v[52:55], v14 offset:6912
    ds_read_b128 v[56:59], v14 offset:8064
    v_add_u32 v60, 0, v16
    v_add_u32 v60, s69, v60
    v_and_b32 v11, 31, v60
    v_lshrrev_b32 v60, 5, v60
    v_lshl_add_u32 v60, v11, 6, v60
    v_mul_lo_u32 v60, v60, s64
    v_add_u32 v60, v60, v15
    v_add_u32 v61, 8, v16
    v_add_u32 v61, s69, v61
    v_and_b32 v11, 31, v61
    v_lshrrev_b32 v61, 5, v61
    v_lshl_add_u32 v61, v11, 6, v61
    v_mul_lo_u32 v61, v61, s64
    v_add_u32 v61, v61, v15
    v_add_u32 v62, 16, v16
    v_add_u32 v62, s69, v62
    v_and_b32 v11, 31, v62
    v_lshrrev_b32 v62, 5, v62
    v_lshl_add_u32 v62, v11, 6, v62
    v_mul_lo_u32 v62, v62, s64
    v_add_u32 v62, v62, v15
    v_add_u32 v63, 24, v16
    v_add_u32 v63, s69, v63
    v_and_b32 v11, 31, v63
    v_lshrrev_b32 v63, 5, v63
    v_lshl_add_u32 v63, v11, 6, v63
    v_mul_lo_u32 v63, v63, s64
    v_add_u32 v63, v63, v15
    v_add_u32 v64, 32, v16
    v_add_u32 v64, s69, v64
    v_and_b32 v11, 31, v64
    v_lshrrev_b32 v64, 5, v64
    v_lshl_add_u32 v64, v11, 6, v64
    v_mul_lo_u32 v64, v64, s64
    v_add_u32 v64, v64, v15
    v_add_u32 v65, 40, v16
    v_add_u32 v65, s69, v65
    v_and_b32 v11, 31, v65
    v_lshrrev_b32 v65, 5, v65
    v_lshl_add_u32 v65, v11, 6, v65
    v_mul_lo_u32 v65, v65, s64
    v_add_u32 v65, v65, v15
    v_add_u32 v66, 48, v16
    v_add_u32 v66, s69, v66
    v_and_b32 v11, 31, v66
    v_lshrrev_b32 v66, 5, v66
    v_lshl_add_u32 v66, v11, 6, v66
    v_mul_lo_u32 v66, v66, s64
    v_add_u32 v66, v66, v15
    v_add_u32 v67, 56, v16
    v_add_u32 v67, s69, v67
    v_and_b32 v11, 31, v67
    v_lshrrev_b32 v67, 5, v67
    v_lshl_add_u32 v67, v11, 6, v67
    v_mul_lo_u32 v67, v67, s64
    v_add_u32 v67, v67, v15
    s_waitcnt lgkmcnt(7)
    buffer_store_dwordx4 v[28:31], v60, s[44:47], s68 offen
    s_waitcnt lgkmcnt(6)
    buffer_store_dwordx4 v[32:35], v61, s[44:47], s68 offen
    s_waitcnt lgkmcnt(5)
    buffer_store_dwordx4 v[36:39], v62, s[44:47], s68 offen
    s_waitcnt lgkmcnt(4)
    buffer_store_dwordx4 v[40:43], v63, s[44:47], s68 offen
    s_waitcnt lgkmcnt(3)
    buffer_store_dwordx4 v[44:47], v64, s[44:47], s68 offen
    s_waitcnt lgkmcnt(2)
    buffer_store_dwordx4 v[48:51], v65, s[44:47], s68 offen
    s_waitcnt lgkmcnt(1)
    buffer_store_dwordx4 v[52:55], v66, s[44:47], s68 offen
    s_waitcnt lgkmcnt(0)
    buffer_store_dwordx4 v[56:59], v67, s[44:47], s68 offen
    s_waitcnt vmcnt(0)
    s_branch .work_8
.task_35:
    s_lshr_b32 s75, s72, 3
    s_lshr_b32 s84, s75, 3
    s_cmp_eq_u32 s84, s83
    s_cbranch_scc1 .rdy_67
    s_lshl_b32 s73, s84, 2
    s_add_u32 s73, s73, 80
    s_mov_b32 s74, 16
    v_readfirstlane_b32 s71, v0
    s_nop 0
    s_cmp_ge_u32 s71, 64
    s_cbranch_scc1 .wo_69
    v_mov_b32 v1, s73
    s_mov_b32 s57, 0
.wl_68:
    global_load_dword v2, v1, s[38:39] sc1
    s_waitcnt vmcnt(0)
    v_readfirstlane_b32 s71, v2
    s_nop 0
    s_cmp_ge_u32 s71, s74
    s_cbranch_scc1 .wo_69
    s_sleep 24
    s_add_u32 s57, s57, 1
    s_cmp_lt_u32 s57, 3000000
    s_cbranch_scc1 .wl_68
    s_branch .abort_1
.wo_69:
    s_barrier
    s_lshr_b32 s73, s75, 3
    s_lshl_b32 s73, s73, 2
    s_add_u32 s73, s73, 32
    s_cmp_lt_u32 s75, 8
    s_cselect_b32 s74, 64, 32
    v_readfirstlane_b32 s71, v0
    s_nop 0
    s_cmp_ge_u32 s71, 64
    s_cbranch_scc1 .wo_71
    v_mov_b32 v1, s73
    s_mov_b32 s57, 0
.wl_70:
    global_load_dword v2, v1, s[38:39] sc1
    s_waitcnt vmcnt(0)
    v_readfirstlane_b32 s71, v2
    s_nop 0
    s_cmp_ge_u32 s71, s74
    s_cbranch_scc1 .wo_71
    s_sleep 24
    s_add_u32 s57, s57, 1
    s_cmp_lt_u32 s57, 3000000
    s_cbranch_scc1 .wl_70
    s_branch .abort_1
.wo_71:
    s_barrier
    s_mov_b32 s73, 116
    s_mov_b32 s74, 34
    v_readfirstlane_b32 s71, v0
    s_nop 0
    s_cmp_ge_u32 s71, 64
    s_cbranch_scc1 .wo_73
    v_mov_b32 v1, s73
    s_mov_b32 s57, 0
.wl_72:
    global_load_dword v2, v1, s[38:39] sc1
    s_waitcnt vmcnt(0)
    v_readfirstlane_b32 s71, v2
    s_nop 0
    s_cmp_ge_u32 s71, s74
    s_cbranch_scc1 .wo_73
    s_sleep 24
    s_add_u32 s57, s57, 1
    s_cmp_lt_u32 s57, 3000000
    s_cbranch_scc1 .wl_72
    s_branch .abort_1
.wo_73:
    s_barrier
    s_mov_b32 s83, s84
.rdy_67:
    v_and_b32 v1, 63, v0
    v_lshrrev_b32 v2, 6, v0
    s_nop 0
    v_readfirstlane_b32 s56, v2
    s_lshr_b32 s57, s72, 3
    s_and_b32 s58, s72, 7
    s_lshl_b32 s58, s58, 2
    s_add_u32 s58, s58, s56
    s_mov_b32 s52, s40
    s_and_b32 s53, s41, 0xffff
    s_mov_b32 s54, 0xfe00000
    s_mov_b32 s55, 0x00020000
    s_lshl_b32 s59, s57, 18
    s_lshl_b32 s60, s58, 8
    s_add_u32 s59, s59, s60
    v_and_b32 v3, 31, v1
    v_lshrrev_b32 v4, 5, v1
    v_lshlrev_b32 v5, 13, v3
    v_lshl_add_u32 v5, v4, 4, v5
    s_lshl_b32 s65, s56, 14
    s_add_u32 s65, s65, 32768
    v_lshrrev_b32 v8, 4, v1
    v_and_b32 v9, 15, v1
    v_xor_b32 v9, v9, v8
    v_lshlrev_b32 v9, 4, v9
    v_lshl_add_u32 v9, v8, 13, v9
    v_xor_b32 v10, 0, v9
    s_add_u32 m0, s65, 0
    s_add_u32 s62, s59, 0x0
    buffer_load_dwordx4 v10, s[52:55], s62 offen sc1 lds
    v_xor_b32 v11, 64, v9
    s_add_u32 m0, s65, 1024
    s_add_u32 s62, s59, 0x8000
    buffer_load_dwordx4 v11, s[52:55], s62 offen sc1 lds
    v_xor_b32 v10, 128, v9
    s_add_u32 m0, s65, 2048
    s_add_u32 s62, s59, 0x10000
    buffer_load_dwordx4 v10, s[52:55], s62 offen sc1 lds
    v_xor_b32 v11, 192, v9
    s_add_u32 m0, s65, 3072
    s_add_u32 s62, s59, 0x18000
    buffer_load_dwordx4 v11, s[52:55], s62 offen sc1 lds
    v_xor_b32 v10, 0, v9
    s_add_u32 m0, s65, 4096
    s_add_u32 s62, s59, 0x20000
    buffer_load_dwordx4 v10, s[52:55], s62 offen sc1 lds
    v_xor_b32 v11, 64, v9
    s_add_u32 m0, s65, 5120
    s_add_u32 s62, s59, 0x28000
    buffer_load_dwordx4 v11, s[52:55], s62 offen sc1 lds
    v_xor_b32 v10, 128, v9
    s_add_u32 m0, s65, 6144
    s_add_u32 s62, s59, 0x30000
    buffer_load_dwordx4 v10, s[52:55], s62 offen sc1 lds
    v_xor_b32 v11, 192, v9
    s_add_u32 m0, s65, 7168
    s_add_u32 s62, s59, 0x38000
    buffer_load_dwordx4 v11, s[52:55], s62 offen sc1 lds
    v_xor_b32 v10, 0, v9
    s_add_u32 m0, s65, 8192
    s_add_u32 s62, s59, 0x1000000
    buffer_load_dwordx4 v10, s[52:55], s62 offen sc1 lds
    v_xor_b32 v11, 64, v9
    s_add_u32 m0, s65, 9216
    s_add_u32 s62, s59, 0x1008000
    buffer_load_dwordx4 v11, s[52:55], s62 offen sc1 lds
    v_xor_b32 v10, 128, v9
    s_add_u32 m0, s65, 10240
    s_add_u32 s62, s59, 0x1010000
    buffer_load_dwordx4 v10, s[52:55], s62 offen sc1 lds
    v_xor_b32 v11, 192, v9
    s_add_u32 m0, s65, 11264
    s_add_u32 s62, s59, 0x1018000
    buffer_load_dwordx4 v11, s[52:55], s62 offen sc1 lds
    v_xor_b32 v10, 0, v9
    s_add_u32 m0, s65, 12288
    s_add_u32 s62, s59, 0x1020000
    buffer_load_dwordx4 v10, s[52:55], s62 offen sc1 lds
    v_xor_b32 v11, 64, v9
    s_add_u32 m0, s65, 13312
    s_add_u32 s62, s59, 0x1028000
    buffer_load_dwordx4 v11, s[52:55], s62 offen sc1 lds
    v_xor_b32 v10, 128, v9
    s_add_u32 m0, s65, 14336
    s_add_u32 s62, s59, 0x1030000
    buffer_load_dwordx4 v10, s[52:55], s62 offen sc1 lds
    v_xor_b32 v11, 192, v9
    s_add_u32 m0, s65, 15360
    s_add_u32 s62, s59, 0x1038000
    buffer_load_dwordx4 v11, s[52:55], s62 offen sc1 lds
    s_lshl_b32 s63, s56, 13
    v_lshrrev_b32 v8, 4, v1
    v_and_b32 v9, 15, v1
    v_lshlrev_b32 v10, 2, v8
    v_xor_b32 v9, v9, v10
    v_lshlrev_b32 v9, 4, v9
    v_lshl_add_u32 v9, v8, 13, v9
    s_add_u32 s61, s59, 0x2000000
    s_add_u32 m0, s63, 0
    s_add_u32 s62, s61, 0
    buffer_load_dwordx4 v9, s[52:55], s62 offen sc1 lds
    s_add_u32 m0, s63, 1024
    s_add_u32 s62, s61, 32768
    buffer_load_dwordx4 v9, s[52:55], s62 offen sc1 lds
    s_add_u32 m0, s63, 2048
    s_add_u32 s62, s61, 65536
    buffer_load_dwordx4 v9, s[52:55], s62 offen sc1 lds
    s_add_u32 m0, s63, 3072
    s_add_u32 s62, s61, 98304
    buffer_load_dwordx4 v9, s[52:55], s62 offen sc1 lds
    s_add_u32 m0, s63, 4096
    s_add_u32 s62, s61, 131072
    buffer_load_dwordx4 v9, s[52:55], s62 offen sc1 lds
    s_add_u32 m0, s63, 5120
    s_add_u32 s62, s61, 163840
    buffer_load_dwordx4 v9, s[52:55], s62 offen sc1 lds
    s_add_u32 m0, s63, 6144
    s_add_u32 s62, s61, 196608
    buffer_load_dwordx4 v9, s[52:55], s62 offen sc1 lds
    s_add_u32 m0, s63, 7168
    s_add_u32 s62, s61, 229376
    buffer_load_dwordx4 v9, s[52:55], s62 offen sc1 lds
    v_bfe_u32 v8, v1, 2, 2
    v_lshl_add_u32 v10, v4, 2, v8
    v_lshlrev_b32 v10, 8, v10
    v_lshl_add_u32 v10, v8, 6, v10
    v_bfe_u32 v11, v1, 4, 1
    v_lshl_add_u32 v10, v11, 5, v10
    v_and_b32 v11, 3, v1
    v_lshl_add_u32 v10, v11, 3, v10
    v_add_u32 v10, s63, v10
    v_and_b32 v12, 15, v3
    v_xor_b32 v12, v12, v4
    v_lshlrev_b32 v12, 4, v12
    v_lshl_add_u32 v12, v3, 8, v12
    v_add_u32 v12, s65, v12
    s_waitcnt vmcnt(8)
    v_xor_b32 v11, 0, v12
    ds_read_b128 v[16:19], v11
    ds_read_b128 v[48:51], v11 offset:8192
    v_xor_b32 v11, 32, v12
    ds_read_b128 v[20:23], v11
    ds_read_b128 v[52:55], v11 offset:8192
    v_xor_b32 v11, 64, v12
    ds_read_b128 v[24:27], v11
    ds_read_b128 v[56:59], v11 offset:8192
    v_xor_b32 v11, 96, v12
    ds_read_b128 v[28:31], v11
    ds_read_b128 v[60:63], v11 offset:8192
    v_xor_b32 v11, 128, v12
    ds_read_b128 v[32:35], v11
    ds_read_b128 v[64:67], v11 offset:8192
    v_xor_b32 v11, 160, v12
    ds_read_b128 v[36:39], v11
    ds_read_b128 v[68:71], v11 offset:8192
    v_xor_b32 v11, 192, v12
    ds_read_b128 v[40:43], v11
    ds_read_b128 v[72:75], v11 offset:8192
    v_xor_b32 v11, 224, v12
    ds_read_b128 v[44:47], v11
    ds_read_b128 v[76:79], v11 offset:8192
    s_waitcnt lgkmcnt(14)
    v_mfma_f32_32x32x16_bf16 v[128:143], v[48:51], v[16:19], 0
    s_waitcnt lgkmcnt(12)
    v_mfma_f32_32x32x16_bf16 v[128:143], v[52:55], v[20:23], v[128:143]
    s_waitcnt lgkmcnt(10)
    v_mfma_f32_32x32x16_bf16 v[128:143], v[56:59], v[24:27], v[128:143]
    s_waitcnt lgkmcnt(8)
    v_mfma_f32_32x32x16_bf16 v[128:143], v[60:63], v[28:31], v[128:143]
    s_waitcnt lgkmcnt(6)
    v_mfma_f32_32x32x16_bf16 v[128:143], v[64:67], v[32:35], v[128:143]
    s_waitcnt lgkmcnt(4)
    v_mfma_f32_32x32x16_bf16 v[128:143], v[68:71], v[36:39], v[128:143]
    s_waitcnt lgkmcnt(2)
    v_mfma_f32_32x32x16_bf16 v[128:143], v[72:75], v[40:43], v[128:143]
    s_waitcnt lgkmcnt(0)
    v_mfma_f32_32x32x16_bf16 v[128:143], v[76:79], v[44:47], v[128:143]
    s_mov_b32 s64, s57
    s_lshl_b32 s73, s75, 2
    s_add_u32 s73, s73, 0x5a0c100
    s_mov_b32 s74, 31
    v_readfirstlane_b32 s71, v0
    s_nop 0
    s_cmp_ge_u32 s71, 64
    s_cbranch_scc1 .wo_75
    v_mov_b32 v14, s73
    s_mov_b32 s57, 0
.wl_74:
    global_load_dword v15, v14, s[40:41] sc1
    s_waitcnt vmcnt(0)
    v_readfirstlane_b32 s71, v15
    s_nop 0
    s_cmp_ge_i32 s71, s74
    s_cbranch_scc1 .wo_75
    s_sleep 8
    s_add_u32 s57, s57, 1
    s_cmp_lt_u32 s57, 3000000
    s_cbranch_scc1 .wl_74
    s_branch .abort_1
.wo_75:
    s_barrier
    s_mov_b32 s57, s64
    v_and_b32 v6, 7, v1
    v_lshlrev_b32 v6, 8, v6
    v_lshl_add_u32 v6, v4, 4, v6
    s_lshl_b32 s61, s57, 16
    s_lshl_b32 s62, s58, 11
    s_add_u32 s61, s61, s62
    s_add_u32 s62, s61, 0x4000000
    buffer_load_dwordx4 v[80:83], v6, s[52:55], s62 offen offset:0 sc1
    buffer_load_dwordx4 v[84:87], v6, s[52:55], s62 offen offset:32 sc1
    buffer_load_dwordx4 v[88:91], v6, s[52:55], s62 offen offset:64 sc1
    buffer_load_dwordx4 v[92:95], v6, s[52:55], s62 offen offset:96 sc1
    buffer_load_dwordx4 v[96:99], v6, s[52:55], s62 offen offset:128 sc1
    buffer_load_dwordx4 v[100:103], v6, s[52:55], s62 offen offset:160 sc1
    buffer_load_dwordx4 v[104:107], v6, s[52:55], s62 offen offset:192 sc1
    buffer_load_dwordx4 v[108:111], v6, s[52:55], s62 offen offset:224 sc1
    v_bfe_u32 v7, v1, 4, 1
    v_lshlrev_b32 v7, 5, v7
    v_lshl_add_u32 v7, v4, 4, v7
    v_and_b32 v13, 15, v1
    v_add_u32 v7, v7, v13
    v_lshlrev_b32 v7, 3, v7
    s_add_u32 s62, s61, 0x4400000
    buffer_load_dwordx2 v[112:113], v7, s[52:55], s62 offen offset:0 sc1
    buffer_load_dwordx2 v[114:115], v7, s[52:55], s62 offen offset:512 sc1
    buffer_load_dwordx2 v[116:117], v7, s[52:55], s62 offen offset:1024 sc1
    buffer_load_dwordx2 v[118:119], v7, s[52:55], s62 offen offset:1536 sc1
    s_waitcnt vmcnt(4)
    v_mfma_f32_32x32x16_bf16 v[144:159], v[80:83], v[16:19], 0
    v_mfma_f32_32x32x16_bf16 v[144:159], v[84:87], v[20:23], v[144:159]
    v_mfma_f32_32x32x16_bf16 v[144:159], v[88:91], v[24:27], v[144:159]
    v_mfma_f32_32x32x16_bf16 v[144:159], v[92:95], v[28:31], v[144:159]
    v_mfma_f32_32x32x16_bf16 v[144:159], v[96:99], v[32:35], v[144:159]
    v_mfma_f32_32x32x16_bf16 v[144:159], v[100:103], v[36:39], v[144:159]
    v_mfma_f32_32x32x16_bf16 v[144:159], v[104:107], v[40:43], v[144:159]
    v_mfma_f32_32x32x16_bf16 v[144:159], v[108:111], v[44:47], v[144:159]
    s_waitcnt vmcnt(0)
    v_xor_b32 v11, 0, v10
    ds_read_b64_tr_b16 v[160:161], v11 offset:0
    ds_read_b64_tr_b16 v[162:163], v11 offset:2048
    ds_read_b64_tr_b16 v[164:165], v11 offset:4096
    ds_read_b64_tr_b16 v[166:167], v11 offset:6144
    v_xor_b32 v11, 64, v10
    ds_read_b64_tr_b16 v[168:169], v11 offset:0
    ds_read_b64_tr_b16 v[170:171], v11 offset:2048
    ds_read_b64_tr_b16 v[172:173], v11 offset:4096
    ds_read_b64_tr_b16 v[174:175], v11 offset:6144
    v_xor_b32 v11, 128, v10
    ds_read_b64_tr_b16 v[176:177], v11 offset:0
    ds_read_b64_tr_b16 v[178:179], v11 offset:2048
    ds_read_b64_tr_b16 v[180:181], v11 offset:4096
    ds_read_b64_tr_b16 v[182:183], v11 offset:6144
    v_xor_b32 v11, 192, v10
    ds_read_b64_tr_b16 v[184:185], v11 offset:0
    ds_read_b64_tr_b16 v[186:187], v11 offset:2048
    ds_read_b64_tr_b16 v[188:189], v11 offset:4096
    ds_read_b64_tr_b16 v[190:191], v11 offset:6144
    v_lshlrev_b32 v12, 2, v4
    v_sub_u32 v12, v3, v12
    v_mov_b32 v13, 0xff7fffff
    v_cmp_le_i32 vcc, 0, v12
    s_nop 1
    v_cndmask_b32 v128, v13, v128, vcc
    v_cmp_le_i32 vcc, 1, v12
    s_nop 1
    v_cndmask_b32 v129, v13, v129, vcc
    v_cmp_le_i32 vcc, 2, v12
    s_nop 1
    v_cndmask_b32 v130, v13, v130, vcc
    v_cmp_le_i32 vcc, 3, v12
    s_nop 1
    v_cndmask_b32 v131, v13, v131, vcc
    v_cmp_le_i32 vcc, 8, v12
    s_nop 1
    v_cndmask_b32 v132, v13, v132, vcc
    v_cmp_le_i32 vcc, 9, v12
    s_nop 1
    v_cndmask_b32 v133, v13, v133, vcc
    v_cmp_le_i32 vcc, 10, v12
    s_nop 1
    v_cndmask_b32 v134, v13, v134, vcc
    v_cmp_le_i32 vcc, 11, v12
    s_nop 1
    v_cndmask_b32 v135, v13, v135, vcc
    v_cmp_le_i32 vcc, 16, v12
    s_nop 1
    v_cndmask_b32 v136, v13, v136, vcc
    v_cmp_le_i32 vcc, 17, v12
    s_nop 1
    v_cndmask_b32 v137, v13, v137, vcc
    v_cmp_le_i32 vcc, 18, v12
    s_nop 1
    v_cndmask_b32 v138, v13, v138, vcc
    v_cmp_le_i32 vcc, 19, v12
    s_nop 1
    v_cndmask_b32 v139, v13, v139, vcc
    v_cmp_le_i32 vcc, 24, v12
    s_nop 1
    v_cndmask_b32 v140, v13, v140, vcc
    v_cmp_le_i32 vcc, 25, v12
    s_nop 1
    v_cndmask_b32 v141, v13, v141, vcc
    v_cmp_le_i32 vcc, 26, v12
    s_nop 1
    v_cndmask_b32 v142, v13, v142, vcc
    v_cmp_le_i32 vcc, 27, v12
    s_nop 1
    v_cndmask_b32 v143, v13, v143, vcc
    v_max3_f32 v14, v144, v145, v146
    v_max_f32 v14, v14, v147
    v_max3_f32 v14, v14, v128, v129
    v_max3_f32 v14, v14, v130, v131
    v_max3_f32 v14, v14, v132, v133
    v_max3_f32 v14, v14, v134, v135
    v_max3_f32 v14, v14, v136, v137
    v_max3_f32 v14, v14, v138, v139
    v_max3_f32 v14, v14, v140, v141
    v_max3_f32 v14, v14, v142, v143
    v_mov_b32 v15, v14
    s_nop 1
    v_permlane32_swap_b32 v14, v15
    v_max_f32 v14, v14, v15
    s_mov_b32 s62, 0x3e0293ee
    v_mul_f32 v14, s62, v14
    v_fma_f32 v128, v128, s62, -v14
    v_fma_f32 v129, v129, s62, -v14
    v_fma_f32 v130, v130, s62, -v14
    v_fma_f32 v131, v131, s62, -v14
    v_fma_f32 v132, v132, s62, -v14
    v_fma_f32 v133, v133, s62, -v14
    v_fma_f32 v134, v134, s62, -v14
    v_fma_f32 v135, v135, s62, -v14
    v_fma_f32 v136, v136, s62, -v14
    v_fma_f32 v137, v137, s62, -v14
    v_fma_f32 v138, v138, s62, -v14
    v_fma_f32 v139, v139, s62, -v14
    v_fma_f32 v140, v140, s62, -v14
    v_fma_f32 v141, v141, s62, -v14
    v_fma_f32 v142, v142, s62, -v14
    v_fma_f32 v143, v143, s62, -v14
    v_fma_f32 v144, v144, s62, -v14
    v_fma_f32 v145, v145, s62, -v14
    v_fma_f32 v146, v146, s62, -v14
    v_fma_f32 v147, v147, s62, -v14
    v_exp_f32 v128, v128
    v_exp_f32 v129, v129
    v_exp_f32 v130, v130
    v_exp_f32 v131, v131
    v_exp_f32 v132, v132
    v_exp_f32 v133, v133
    v_exp_f32 v134, v134
    v_exp_f32 v135, v135
    v_exp_f32 v136, v136
    v_exp_f32 v137, v137
    v_exp_f32 v138, v138
    v_exp_f32 v139, v139
    v_exp_f32 v140, v140
    v_exp_f32 v141, v141
    v_exp_f32 v142, v142
    v_exp_f32 v143, v143
    v_exp_f32 v144, v144
    v_exp_f32 v145, v145
    v_exp_f32 v146, v146
    v_exp_f32 v147, v147
    v_add_f32 v14, v128, v129
    v_add_f32 v14, v14, v130
    v_add_f32 v14, v14, v131
    v_add_f32 v14, v14, v132
    v_add_f32 v14, v14, v133
    v_add_f32 v14, v14, v134
    v_add_f32 v14, v14, v135
    v_add_f32 v14, v14, v136
    v_add_f32 v14, v14, v137
    v_add_f32 v14, v14, v138
    v_add_f32 v14, v14, v139
    v_add_f32 v14, v14, v140
    v_add_f32 v14, v14, v141
    v_add_f32 v14, v14, v142
    v_add_f32 v14, v14, v143
    v_add_f32 v14, v14, v144
    v_add_f32 v14, v14, v145
    v_add_f32 v14, v14, v146
    v_add_f32 v14, v14, v147
    v_mov_b32 v15, v14
    s_nop 1
    v_permlane32_swap_b32 v14, v15
    v_add_f32 v14, v14, v15
    v_rcp_f32 v14, v14
    v_cvt_pk_bf16_f32 v16, v128, v129
    v_cvt_pk_bf16_f32 v17, v130, v131
    v_cvt_pk_bf16_f32 v18, v132, v133
    v_cvt_pk_bf16_f32 v19, v134, v135
    v_cvt_pk_bf16_f32 v20, v136, v137
    v_cvt_pk_bf16_f32 v21, v138, v139
    v_cvt_pk_bf16_f32 v22, v140, v141
    v_cvt_pk_bf16_f32 v23, v142, v143
    v_cvt_pk_bf16_f32 v24, v144, v145
    v_cvt_pk_bf16_f32 v25, v146, v147
    s_waitcnt lgkmcnt(0)
    v_mfma_f32_32x32x16_bf16 v[32:47], v[160:163], v[16:19], 0
    v_mfma_f32_32x32x16_bf16 v[32:47], v[164:167], v[20:23], v[32:47]
    v_mfma_f32_32x32x8_bf16 v[32:47], v[112:113], v[24:25], v[32:47]
    v_mfma_f32_32x32x16_bf16 v[48:63], v[168:171], v[16:19], 0
    v_mfma_f32_32x32x16_bf16 v[48:63], v[172:175], v[20:23], v[48:63]
    v_mfma_f32_32x32x8_bf16 v[48:63], v[114:115], v[24:25], v[48:63]
    v_mfma_f32_32x32x16_bf16 v[64:79], v[176:179], v[16:19], 0
    v_mfma_f32_32x32x16_bf16 v[64:79], v[180:183], v[20:23], v[64:79]
    v_mfma_f32_32x32x8_bf16 v[64:79], v[116:117], v[24:25], v[64:79]
    v_mfma_f32_32x32x16_bf16 v[80:95], v[184:187], v[16:19], 0
    v_mfma_f32_32x32x16_bf16 v[80:95], v[188:191], v[20:23], v[80:95]
    v_mfma_f32_32x32x8_bf16 v[80:95], v[118:119], v[24:25], v[80:95]
    s_add_u32 s61, s59, 0x3000000
    v_and_b32 v12, 15, v3
    v_xor_b32 v12, v12, v4
    v_lshlrev_b32 v12, 4, v12
    v_lshl_add_u32 v12, v3, 8, v12
    v_add_u32 v12, s63, v12
    v_mul_f32 v32, v32, v14
    v_mul_f32 v33, v33, v14
    v_mul_f32 v34, v34, v14
    v_mul_f32 v35, v35, v14
    v_mul_f32 v36, v36, v14
    v_mul_f32 v37, v37, v14
    v_mul_f32 v38, v38, v14
    v_mul_f32 v39, v39, v14
    v_mul_f32 v40, v40, v14
    v_mul_f32 v41, v41, v14
    v_mul_f32 v42, v42, v14
    v_mul_f32 v43, v43, v14
    v_mul_f32 v44, v44, v14
    v_mul_f32 v45, v45, v14
    v_mul_f32 v46, v46, v14
    v_mul_f32 v47, v47, v14
    v_cvt_pk_bf16_f32 v96, v32, v33
    v_cvt_pk_bf16_f32 v97, v34, v35
    v_cvt_pk_bf16_f32 v98, v36, v37
    v_cvt_pk_bf16_f32 v99, v38, v39
    v_cvt_pk_bf16_f32 v100, v40, v41
    v_cvt_pk_bf16_f32 v101, v42, v43
    v_cvt_pk_bf16_f32 v102, v44, v45
    v_cvt_pk_bf16_f32 v103, v46, v47
    v_permlane32_swap_b32 v96, v98
    v_permlane32_swap_b32 v97, v99
    v_permlane32_swap_b32 v100, v102
    v_permlane32_swap_b32 v101, v103
    v_xor_b32 v11, 0, v12
    ds_write_b128 v11, v[96:99]
    v_xor_b32 v11, 32, v12
    ds_write_b128 v11, v[100:103]
    v_mul_f32 v48, v48, v14
    v_mul_f32 v49, v49, v14
    v_mul_f32 v50, v50, v14
    v_mul_f32 v51, v51, v14
    v_mul_f32 v52, v52, v14
    v_mul_f32 v53, v53, v14
    v_mul_f32 v54, v54, v14
    v_mul_f32 v55, v55, v14
    v_mul_f32 v56, v56, v14
    v_mul_f32 v57, v57, v14
    v_mul_f32 v58, v58, v14
    v_mul_f32 v59, v59, v14
    v_mul_f32 v60, v60, v14
    v_mul_f32 v61, v61, v14
    v_mul_f32 v62, v62, v14
    v_mul_f32 v63, v63, v14
    v_cvt_pk_bf16_f32 v104, v48, v49
    v_cvt_pk_bf16_f32 v105, v50, v51
    v_cvt_pk_bf16_f32 v106, v52, v53
    v_cvt_pk_bf16_f32 v107, v54, v55
    v_cvt_pk_bf16_f32 v108, v56, v57
    v_cvt_pk_bf16_f32 v109, v58, v59
    v_cvt_pk_bf16_f32 v110, v60, v61
    v_cvt_pk_bf16_f32 v111, v62, v63
    v_permlane32_swap_b32 v104, v106
    v_permlane32_swap_b32 v105, v107
    v_permlane32_swap_b32 v108, v110
    v_permlane32_swap_b32 v109, v111
    v_xor_b32 v11, 64, v12
    ds_write_b128 v11, v[104:107]
    v_xor_b32 v11, 96, v12
    ds_write_b128 v11, v[108:111]
    v_mul_f32 v64, v64, v14
    v_mul_f32 v65, v65, v14
    v_mul_f32 v66, v66, v14
    v_mul_f32 v67, v67, v14
    v_mul_f32 v68, v68, v14
    v_mul_f32 v69, v69, v14
    v_mul_f32 v70, v70, v14
    v_mul_f32 v71, v71, v14
    v_mul_f32 v72, v72, v14
    v_mul_f32 v73, v73, v14
    v_mul_f32 v74, v74, v14
    v_mul_f32 v75, v75, v14
    v_mul_f32 v76, v76, v14
    v_mul_f32 v77, v77, v14
    v_mul_f32 v78, v78, v14
    v_mul_f32 v79, v79, v14
    v_cvt_pk_bf16_f32 v96, v64, v65
    v_cvt_pk_bf16_f32 v97, v66, v67
    v_cvt_pk_bf16_f32 v98, v68, v69
    v_cvt_pk_bf16_f32 v99, v70, v71
    v_cvt_pk_bf16_f32 v100, v72, v73
    v_cvt_pk_bf16_f32 v101, v74, v75
    v_cvt_pk_bf16_f32 v102, v76, v77
    v_cvt_pk_bf16_f32 v103, v78, v79
    v_permlane32_swap_b32 v96, v98
    v_permlane32_swap_b32 v97, v99
    v_permlane32_swap_b32 v100, v102
    v_permlane32_swap_b32 v101, v103
    v_xor_b32 v11, 128, v12
    ds_write_b128 v11, v[96:99]
    v_xor_b32 v11, 160, v12
    ds_write_b128 v11, v[100:103]
    v_mul_f32 v80, v80, v14
    v_mul_f32 v81, v81, v14
    v_mul_f32 v82, v82, v14
    v_mul_f32 v83, v83, v14
    v_mul_f32 v84, v84, v14
    v_mul_f32 v85, v85, v14
    v_mul_f32 v86, v86, v14
    v_mul_f32 v87, v87, v14
    v_mul_f32 v88, v88, v14
    v_mul_f32 v89, v89, v14
    v_mul_f32 v90, v90, v14
    v_mul_f32 v91, v91, v14
    v_mul_f32 v92, v92, v14
    v_mul_f32 v93, v93, v14
    v_mul_f32 v94, v94, v14
    v_mul_f32 v95, v95, v14
    v_cvt_pk_bf16_f32 v104, v80, v81
    v_cvt_pk_bf16_f32 v105, v82, v83
    v_cvt_pk_bf16_f32 v106, v84, v85
    v_cvt_pk_bf16_f32 v107, v86, v87
    v_cvt_pk_bf16_f32 v108, v88, v89
    v_cvt_pk_bf16_f32 v109, v90, v91
    v_cvt_pk_bf16_f32 v110, v92, v93
    v_cvt_pk_bf16_f32 v111, v94, v95
    v_permlane32_swap_b32 v104, v106
    v_permlane32_swap_b32 v105, v107
    v_permlane32_swap_b32 v108, v110
    v_permlane32_swap_b32 v109, v111
    v_xor_b32 v11, 192, v12
    ds_write_b128 v11, v[104:107]
    v_xor_b32 v11, 224, v12
    ds_write_b128 v11, v[108:111]
    v_lshrrev_b32 v8, 4, v1
    v_and_b32 v9, 15, v1
    v_lshlrev_b32 v13, 13, v8
    v_lshl_add_u32 v13, v9, 4, v13
    v_xor_b32 v9, v9, v8
    v_lshlrev_b32 v9, 4, v9
    v_lshl_add_u32 v9, v8, 8, v9
    v_add_u32 v9, s63, v9
    s_waitcnt lgkmcnt(0)
    v_xor_b32 v11, 0, v9
    ds_read_b128 v[32:35], v11 offset:0
    v_xor_b32 v11, 64, v9
    ds_read_b128 v[36:39], v11 offset:1024
    v_xor_b32 v11, 128, v9
    ds_read_b128 v[40:43], v11 offset:2048
    v_xor_b32 v11, 192, v9
    ds_read_b128 v[44:47], v11 offset:3072
    v_xor_b32 v11, 0, v9
    ds_read_b128 v[48:51], v11 offset:4096
    v_xor_b32 v11, 64, v9
    ds_read_b128 v[52:55], v11 offset:5120
    v_xor_b32 v11, 128, v9
    ds_read_b128 v[56:59], v11 offset:6144
    v_xor_b32 v11, 192, v9
    ds_read_b128 v[60:63], v11 offset:7168
    s_add_u32 s62, s61, 0
    s_waitcnt lgkmcnt(7)
    buffer_store_dwordx4 v[32:35], v13, s[52:55], s62 offen sc1
    s_add_u32 s62, s61, 32768
    s_waitcnt lgkmcnt(6)
    buffer_store_dwordx4 v[36:39], v13, s[52:55], s62 offen sc1
    s_add_u32 s62, s61, 65536
    s_waitcnt lgkmcnt(5)
    buffer_store_dwordx4 v[40:43], v13, s[52:55], s62 offen sc1
    s_add_u32 s62, s61, 98304
    s_waitcnt lgkmcnt(4)
    buffer_store_dwordx4 v[44:47], v13, s[52:55], s62 offen sc1
    s_add_u32 s62, s61, 131072
    s_waitcnt lgkmcnt(3)
    buffer_store_dwordx4 v[48:51], v13, s[52:55], s62 offen sc1
    s_add_u32 s62, s61, 163840
    s_waitcnt lgkmcnt(2)
    buffer_store_dwordx4 v[52:55], v13, s[52:55], s62 offen sc1
    s_add_u32 s62, s61, 196608
    s_waitcnt lgkmcnt(1)
    buffer_store_dwordx4 v[56:59], v13, s[52:55], s62 offen sc1
    s_add_u32 s62, s61, 229376
    s_waitcnt lgkmcnt(0)
    buffer_store_dwordx4 v[60:63], v13, s[52:55], s62 offen sc1
    s_lshl_b32 s75, s75, 2
    s_add_u32 s75, s75, 0x5a0c000
    s_waitcnt vmcnt(0)
    s_barrier
    v_mov_b32 v1, s75
    v_mov_b32 v2, 1
    v_cmp_eq_u32 vcc, 0, v0
    s_nop 0
    s_and_saveexec_b64 s[6:7], vcc
    s_cbranch_execz .sg_76
    global_atomic_add v1, v2, s[40:41]
.sg_76:
    s_mov_b64 exec, s[6:7]
    s_branch .attnq_3
.orole_7:
    s_mov_b32 s72, s52
    s_mov_b32 s73, 116
    s_mov_b32 s74, 34
    v_readfirstlane_b32 s71, v0
    s_nop 0
    s_cmp_ge_u32 s71, 64
    s_cbranch_scc1 .wo_78
    v_mov_b32 v1, s73
    s_mov_b32 s57, 0
.wl_77:
    global_load_dword v2, v1, s[38:39] sc1
    s_waitcnt vmcnt(0)
    v_readfirstlane_b32 s71, v2
    s_nop 0
    s_cmp_ge_u32 s71, s74
    s_cbranch_scc1 .wo_78
    s_sleep 24
    s_add_u32 s57, s57, 1
    s_cmp_lt_u32 s57, 3000000
    s_cbranch_scc1 .wl_77
    s_branch .abort_1
.wo_78:
    s_barrier
    v_and_b32 v1, 63, v0
    v_lshrrev_b32 v2, 6, v0
    s_nop 0
    v_readfirstlane_b32 s56, v2
    s_mul_i32 s58, s72, 3277
    s_lshr_b32 s58, s58, 16
    s_mul_i32 s59, s58, 20
    s_sub_u32 s57, s72, s59
    s_mov_b32 s44, s32
    s_and_b32 s45, s33, 0xffff
    s_mov_b32 s46, 0x500000
    s_mov_b32 s47, 0x00020000
    s_mov_b32 s48, s36
    s_and_b32 s49, s37, 0xffff
    s_mov_b32 s50, 0x500000
    s_mov_b32 s51, 0x00020000
    s_mov_b32 s52, s40
    s_and_b32 s53, s41, 0xffff
    s_mov_b32 s54, 0xfe00000
    s_mov_b32 s55, 0x00020000
    s_lshl_b32 s61, s56, 15
    v_lshrrev_b32 v3, 2, v1
    v_mul_u32_u24 v3, 1280, v3
    v_and_b32 v4, 3, v1
    v_lshl_add_u32 v3, v4, 4, v3
    s_mul_i32 s59, s56, 1310720
    s_lshl_b32 s60, s57, 6
    s_add_u32 s59, s59, s60
    v_lshrrev_b32 v5, 5, v1
    v_bfe_u32 v6, v1, 2, 2
    v_lshl_add_u32 v6, v5, 3, v6
    v_lshlrev_b32 v6, 6, v6
    v_bfe_u32 v7, v1, 4, 1
    v_lshl_add_u32 v6, v7, 5, v6
    v_lshl_add_u32 v6, v4, 3, v6
    v_add_u32 v6, s61, v6
    s_add_u32 m0, s61, 0
    s_add_u32 s60, s59, 0
    buffer_load_dwordx4 v3, s[44:47], s60 offen lds
    s_add_u32 m0, s61, 1024
    s_add_u32 s60, s59, 20480
    buffer_load_dwordx4 v3, s[44:47], s60 offen lds
    s_add_u32 m0, s61, 2048
    s_add_u32 s60, s59, 40960
    buffer_load_dwordx4 v3, s[44:47], s60 offen lds
    s_add_u32 m0, s61, 3072
    s_add_u32 s60, s59, 61440
    buffer_load_dwordx4 v3, s[44:47], s60 offen lds
    s_add_u32 m0, s61, 4096
    s_add_u32 s60, s59, 81920
    buffer_load_dwordx4 v3, s[44:47], s60 offen lds
    s_add_u32 m0, s61, 5120
    s_add_u32 s60, s59, 102400
    buffer_load_dwordx4 v3, s[44:47], s60 offen lds
    s_add_u32 m0, s61, 6144
    s_add_u32 s60, s59, 122880
    buffer_load_dwordx4 v3, s[44:47], s60 offen lds
    s_add_u32 m0, s61, 7168
    s_add_u32 s60, s59, 143360
    buffer_load_dwordx4 v3, s[44:47], s60 offen lds
    s_add_u32 m0, s61, 8192
    s_add_u32 s60, s59, 163840
    buffer_load_dwordx4 v3, s[44:47], s60 offen lds
    s_add_u32 m0, s61, 9216
    s_add_u32 s60, s59, 184320
    buffer_load_dwordx4 v3, s[44:47], s60 offen lds
    s_add_u32 m0, s61, 10240
    s_add_u32 s60, s59, 204800
    buffer_load_dwordx4 v3, s[44:47], s60 offen lds
    s_add_u32 m0, s61, 11264
    s_add_u32 s60, s59, 225280
    buffer_load_dwordx4 v3, s[44:47], s60 offen lds
    s_add_u32 m0, s61, 12288
    s_add_u32 s60, s59, 245760
    buffer_load_dwordx4 v3, s[44:47], s60 offen lds
    s_add_u32 m0, s61, 13312
    s_add_u32 s60, s59, 266240
    buffer_load_dwordx4 v3, s[44:47], s60 offen lds
    s_add_u32 m0, s61, 14336
    s_add_u32 s60, s59, 286720
    buffer_load_dwordx4 v3, s[44:47], s60 offen lds
    s_add_u32 m0, s61, 15360
    s_add_u32 s60, s59, 307200
    buffer_load_dwordx4 v3, s[44:47], s60 offen lds
    s_add_u32 m0, s61, 16384
    s_add_u32 s60, s59, 327680
    buffer_load_dwordx4 v3, s[44:47], s60 offen lds
    s_add_u32 m0, s61, 17408
    s_add_u32 s60, s59, 348160
    buffer_load_dwordx4 v3, s[44:47], s60 offen lds
    s_add_u32 m0, s61, 18432
    s_add_u32 s60, s59, 368640
    buffer_load_dwordx4 v3, s[44:47], s60 offen lds
    s_add_u32 m0, s61, 19456
    s_add_u32 s60, s59, 389120
    buffer_load_dwordx4 v3, s[44:47], s60 offen lds
    s_add_u32 m0, s61, 20480
    s_add_u32 s60, s59, 409600
    buffer_load_dwordx4 v3, s[44:47], s60 offen lds
    s_add_u32 m0, s61, 21504
    s_add_u32 s60, s59, 430080
    buffer_load_dwordx4 v3, s[44:47], s60 offen lds
    s_add_u32 m0, s61, 22528
    s_add_u32 s60, s59, 450560
    buffer_load_dwordx4 v3, s[44:47], s60 offen lds
    s_add_u32 m0, s61, 23552
    s_add_u32 s60, s59, 471040
    buffer_load_dwordx4 v3, s[44:47], s60 offen lds
    s_add_u32 m0, s61, 24576
    s_add_u32 s60, s59, 491520
    buffer_load_dwordx4 v3, s[44:47], s60 offen lds
    s_add_u32 m0, s61, 25600
    s_add_u32 s60, s59, 512000
    buffer_load_dwordx4 v3, s[44:47], s60 offen lds
    s_add_u32 m0, s61, 26624
    s_add_u32 s60, s59, 532480
    buffer_load_dwordx4 v3, s[44:47], s60 offen lds
    s_add_u32 m0, s61, 27648
    s_add_u32 s60, s59, 552960
    buffer_load_dwordx4 v3, s[44:47], s60 offen lds
    s_add_u32 m0, s61, 28672
    s_add_u32 s60, s59, 573440
    buffer_load_dwordx4 v3, s[44:47], s60 offen lds
    s_add_u32 m0, s61, 29696
    s_add_u32 s60, s59, 593920
    buffer_load_dwordx4 v3, s[44:47], s60 offen lds
    s_add_u32 m0, s61, 30720
    s_add_u32 s60, s59, 614400
    buffer_load_dwordx4 v3, s[44:47], s60 offen lds
    s_add_u32 m0, s61, 31744
    s_add_u32 s60, s59, 634880
    buffer_load_dwordx4 v3, s[44:47], s60 offen lds
    s_waitcnt vmcnt(0)
    ds_read_b64_tr_b16 a[0:1], v6 offset:0
    ds_read_b64_tr_b16 a[2:3], v6 offset:256
    ds_read_b64_tr_b16 a[4:5], v6 offset:1024
    ds_read_b64_tr_b16 a[6:7], v6 offset:1280
    ds_read_b64_tr_b16 a[8:9], v6 offset:2048
    ds_read_b64_tr_b16 a[10:11], v6 offset:2304
    ds_read_b64_tr_b16 a[12:13], v6 offset:3072
    ds_read_b64_tr_b16 a[14:15], v6 offset:3328
    ds_read_b64_tr_b16 a[16:17], v6 offset:4096
    ds_read_b64_tr_b16 a[18:19], v6 offset:4352
    ds_read_b64_tr_b16 a[20:21], v6 offset:5120
    ds_read_b64_tr_b16 a[22:23], v6 offset:5376
    ds_read_b64_tr_b16 a[24:25], v6 offset:6144
    ds_read_b64_tr_b16 a[26:27], v6 offset:6400
    ds_read_b64_tr_b16 a[28:29], v6 offset:7168
    ds_read_b64_tr_b16 a[30:31], v6 offset:7424
    ds_read_b64_tr_b16 a[32:33], v6 offset:8192
    ds_read_b64_tr_b16 a[34:35], v6 offset:8448
    ds_read_b64_tr_b16 a[36:37], v6 offset:9216
    ds_read_b64_tr_b16 a[38:39], v6 offset:9472
    ds_read_b64_tr_b16 a[40:41], v6 offset:10240
    ds_read_b64_tr_b16 a[42:43], v6 offset:10496
    ds_read_b64_tr_b16 a[44:45], v6 offset:11264
    ds_read_b64_tr_b16 a[46:47], v6 offset:11520
    ds_read_b64_tr_b16 a[48:49], v6 offset:12288
    ds_read_b64_tr_b16 a[50:51], v6 offset:12544
    ds_read_b64_tr_b16 a[52:53], v6 offset:13312
    ds_read_b64_tr_b16 a[54:55], v6 offset:13568
    ds_read_b64_tr_b16 a[56:57], v6 offset:14336
    ds_read_b64_tr_b16 a[58:59], v6 offset:14592
    ds_read_b64_tr_b16 a[60:61], v6 offset:15360
    ds_read_b64_tr_b16 a[62:63], v6 offset:15616
    s_waitcnt lgkmcnt(0)
    ds_read_b64_tr_b16 a[64:65], v6 offset:16384
    ds_read_b64_tr_b16 a[66:67], v6 offset:16640
    ds_read_b64_tr_b16 a[68:69], v6 offset:17408
    ds_read_b64_tr_b16 a[70:71], v6 offset:17664
    ds_read_b64_tr_b16 a[72:73], v6 offset:18432
    ds_read_b64_tr_b16 a[74:75], v6 offset:18688
    ds_read_b64_tr_b16 a[76:77], v6 offset:19456
    ds_read_b64_tr_b16 a[78:79], v6 offset:19712
    ds_read_b64_tr_b16 a[80:81], v6 offset:20480
    ds_read_b64_tr_b16 a[82:83], v6 offset:20736
    ds_read_b64_tr_b16 a[84:85], v6 offset:21504
    ds_read_b64_tr_b16 a[86:87], v6 offset:21760
    ds_read_b64_tr_b16 a[88:89], v6 offset:22528
    ds_read_b64_tr_b16 a[90:91], v6 offset:22784
    ds_read_b64_tr_b16 a[92:93], v6 offset:23552
    ds_read_b64_tr_b16 a[94:95], v6 offset:23808
    ds_read_b64_tr_b16 a[96:97], v6 offset:24576
    ds_read_b64_tr_b16 a[98:99], v6 offset:24832
    ds_read_b64_tr_b16 a[100:101], v6 offset:25600
    ds_read_b64_tr_b16 a[102:103], v6 offset:25856
    ds_read_b64_tr_b16 a[104:105], v6 offset:26624
    ds_read_b64_tr_b16 a[106:107], v6 offset:26880
    ds_read_b64_tr_b16 a[108:109], v6 offset:27648
    ds_read_b64_tr_b16 a[110:111], v6 offset:27904
    ds_read_b64_tr_b16 a[112:113], v6 offset:28672
    ds_read_b64_tr_b16 a[114:115], v6 offset:28928
    ds_read_b64_tr_b16 a[116:117], v6 offset:29696
    ds_read_b64_tr_b16 a[118:119], v6 offset:29952
    ds_read_b64_tr_b16 a[120:121], v6 offset:30720
    ds_read_b64_tr_b16 a[122:123], v6 offset:30976
    ds_read_b64_tr_b16 a[124:125], v6 offset:31744
    ds_read_b64_tr_b16 a[126:127], v6 offset:32000
    s_waitcnt lgkmcnt(0)
    s_add_u32 m0, s61, 0
    s_add_u32 s60, s59, 655360
    buffer_load_dwordx4 v3, s[44:47], s60 offen lds
    s_add_u32 m0, s61, 1024
    s_add_u32 s60, s59, 675840
    buffer_load_dwordx4 v3, s[44:47], s60 offen lds
    s_add_u32 m0, s61, 2048
    s_add_u32 s60, s59, 696320
    buffer_load_dwordx4 v3, s[44:47], s60 offen lds
    s_add_u32 m0, s61, 3072
    s_add_u32 s60, s59, 716800
    buffer_load_dwordx4 v3, s[44:47], s60 offen lds
    s_add_u32 m0, s61, 4096
    s_add_u32 s60, s59, 737280
    buffer_load_dwordx4 v3, s[44:47], s60 offen lds
    s_add_u32 m0, s61, 5120
    s_add_u32 s60, s59, 757760
    buffer_load_dwordx4 v3, s[44:47], s60 offen lds
    s_add_u32 m0, s61, 6144
    s_add_u32 s60, s59, 778240
    buffer_load_dwordx4 v3, s[44:47], s60 offen lds
    s_add_u32 m0, s61, 7168
    s_add_u32 s60, s59, 798720
    buffer_load_dwordx4 v3, s[44:47], s60 offen lds
    s_add_u32 m0, s61, 8192
    s_add_u32 s60, s59, 819200
    buffer_load_dwordx4 v3, s[44:47], s60 offen lds
    s_add_u32 m0, s61, 9216
    s_add_u32 s60, s59, 839680
    buffer_load_dwordx4 v3, s[44:47], s60 offen lds
    s_add_u32 m0, s61, 10240
    s_add_u32 s60, s59, 860160
    buffer_load_dwordx4 v3, s[44:47], s60 offen lds
    s_add_u32 m0, s61, 11264
    s_add_u32 s60, s59, 880640
    buffer_load_dwordx4 v3, s[44:47], s60 offen lds
    s_add_u32 m0, s61, 12288
    s_add_u32 s60, s59, 901120
    buffer_load_dwordx4 v3, s[44:47], s60 offen lds
    s_add_u32 m0, s61, 13312
    s_add_u32 s60, s59, 921600
    buffer_load_dwordx4 v3, s[44:47], s60 offen lds
    s_add_u32 m0, s61, 14336
    s_add_u32 s60, s59, 942080
    buffer_load_dwordx4 v3, s[44:47], s60 offen lds
    s_add_u32 m0, s61, 15360
    s_add_u32 s60, s59, 962560
    buffer_load_dwordx4 v3, s[44:47], s60 offen lds
    s_add_u32 m0, s61, 16384
    s_add_u32 s60, s59, 983040
    buffer_load_dwordx4 v3, s[44:47], s60 offen lds
    s_add_u32 m0, s61, 17408
    s_add_u32 s60, s59, 1003520
    buffer_load_dwordx4 v3, s[44:47], s60 offen lds
    s_add_u32 m0, s61, 18432
    s_add_u32 s60, s59, 1024000
    buffer_load_dwordx4 v3, s[44:47], s60 offen lds
    s_add_u32 m0, s61, 19456
    s_add_u32 s60, s59, 1044480
    buffer_load_dwordx4 v3, s[44:47], s60 offen lds
    s_add_u32 m0, s61, 20480
    s_add_u32 s60, s59, 1064960
    buffer_load_dwordx4 v3, s[44:47], s60 offen lds
    s_add_u32 m0, s61, 21504
    s_add_u32 s60, s59, 1085440
    buffer_load_dwordx4 v3, s[44:47], s60 offen lds
    s_add_u32 m0, s61, 22528
    s_add_u32 s60, s59, 1105920
    buffer_load_dwordx4 v3, s[44:47], s60 offen lds
    s_add_u32 m0, s61, 23552
    s_add_u32 s60, s59, 1126400
    buffer_load_dwordx4 v3, s[44:47], s60 offen lds
    s_add_u32 m0, s61, 24576
    s_add_u32 s60, s59, 1146880
    buffer_load_dwordx4 v3, s[44:47], s60 offen lds
    s_add_u32 m0, s61, 25600
    s_add_u32 s60, s59, 1167360
    buffer_load_dwordx4 v3, s[44:47], s60 offen lds
    s_add_u32 m0, s61, 26624
    s_add_u32 s60, s59, 1187840
    buffer_load_dwordx4 v3, s[44:47], s60 offen lds
    s_add_u32 m0, s61, 27648
    s_add_u32 s60, s59, 1208320
    buffer_load_dwordx4 v3, s[44:47], s60 offen lds
    s_add_u32 m0, s61, 28672
    s_add_u32 s60, s59, 1228800
    buffer_load_dwordx4 v3, s[44:47], s60 offen lds
    s_add_u32 m0, s61, 29696
    s_add_u32 s60, s59, 1249280
    buffer_load_dwordx4 v3, s[44:47], s60 offen lds
    s_add_u32 m0, s61, 30720
    s_add_u32 s60, s59, 1269760
    buffer_load_dwordx4 v3, s[44:47], s60 offen lds
    s_add_u32 m0, s61, 31744
    s_add_u32 s60, s59, 1290240
    buffer_load_dwordx4 v3, s[44:47], s60 offen lds
    s_waitcnt vmcnt(0)
    ds_read_b64_tr_b16 a[128:129], v6 offset:0
    ds_read_b64_tr_b16 a[130:131], v6 offset:256
    ds_read_b64_tr_b16 a[132:133], v6 offset:1024
    ds_read_b64_tr_b16 a[134:135], v6 offset:1280
    ds_read_b64_tr_b16 a[136:137], v6 offset:2048
    ds_read_b64_tr_b16 a[138:139], v6 offset:2304
    ds_read_b64_tr_b16 a[140:141], v6 offset:3072
    ds_read_b64_tr_b16 a[142:143], v6 offset:3328
    ds_read_b64_tr_b16 a[144:145], v6 offset:4096
    ds_read_b64_tr_b16 a[146:147], v6 offset:4352
    ds_read_b64_tr_b16 a[148:149], v6 offset:5120
    ds_read_b64_tr_b16 a[150:151], v6 offset:5376
    ds_read_b64_tr_b16 a[152:153], v6 offset:6144
    ds_read_b64_tr_b16 a[154:155], v6 offset:6400
    ds_read_b64_tr_b16 a[156:157], v6 offset:7168
    ds_read_b64_tr_b16 a[158:159], v6 offset:7424
    ds_read_b64_tr_b16 a[160:161], v6 offset:8192
    ds_read_b64_tr_b16 a[162:163], v6 offset:8448
    ds_read_b64_tr_b16 a[164:165], v6 offset:9216
    ds_read_b64_tr_b16 a[166:167], v6 offset:9472
    ds_read_b64_tr_b16 a[168:169], v6 offset:10240
    ds_read_b64_tr_b16 a[170:171], v6 offset:10496
    ds_read_b64_tr_b16 a[172:173], v6 offset:11264
    ds_read_b64_tr_b16 a[174:175], v6 offset:11520
    ds_read_b64_tr_b16 a[176:177], v6 offset:12288
    ds_read_b64_tr_b16 a[178:179], v6 offset:12544
    ds_read_b64_tr_b16 a[180:181], v6 offset:13312
    ds_read_b64_tr_b16 a[182:183], v6 offset:13568
    ds_read_b64_tr_b16 a[184:185], v6 offset:14336
    ds_read_b64_tr_b16 a[186:187], v6 offset:14592
    ds_read_b64_tr_b16 a[188:189], v6 offset:15360
    ds_read_b64_tr_b16 a[190:191], v6 offset:15616
    s_waitcnt lgkmcnt(0)
    ds_read_b64_tr_b16 a[192:193], v6 offset:16384
    ds_read_b64_tr_b16 a[194:195], v6 offset:16640
    ds_read_b64_tr_b16 a[196:197], v6 offset:17408
    ds_read_b64_tr_b16 a[198:199], v6 offset:17664
    ds_read_b64_tr_b16 a[200:201], v6 offset:18432
    ds_read_b64_tr_b16 a[202:203], v6 offset:18688
    ds_read_b64_tr_b16 a[204:205], v6 offset:19456
    ds_read_b64_tr_b16 a[206:207], v6 offset:19712
    ds_read_b64_tr_b16 a[208:209], v6 offset:20480
    ds_read_b64_tr_b16 a[210:211], v6 offset:20736
    ds_read_b64_tr_b16 a[212:213], v6 offset:21504
    ds_read_b64_tr_b16 a[214:215], v6 offset:21760
    ds_read_b64_tr_b16 a[216:217], v6 offset:22528
    ds_read_b64_tr_b16 a[218:219], v6 offset:22784
    ds_read_b64_tr_b16 a[220:221], v6 offset:23552
    ds_read_b64_tr_b16 a[222:223], v6 offset:23808
    ds_read_b64_tr_b16 a[224:225], v6 offset:24576
    ds_read_b64_tr_b16 a[226:227], v6 offset:24832
    ds_read_b64_tr_b16 a[228:229], v6 offset:25600
    ds_read_b64_tr_b16 a[230:231], v6 offset:25856
    ds_read_b64_tr_b16 a[232:233], v6 offset:26624
    ds_read_b64_tr_b16 a[234:235], v6 offset:26880
    ds_read_b64_tr_b16 a[236:237], v6 offset:27648
    ds_read_b64_tr_b16 a[238:239], v6 offset:27904
    ds_read_b64_tr_b16 a[240:241], v6 offset:28672
    ds_read_b64_tr_b16 a[242:243], v6 offset:28928
    ds_read_b64_tr_b16 a[244:245], v6 offset:29696
    ds_read_b64_tr_b16 a[246:247], v6 offset:29952
    ds_read_b64_tr_b16 a[248:249], v6 offset:30720
    ds_read_b64_tr_b16 a[250:251], v6 offset:30976
    ds_read_b64_tr_b16 a[252:253], v6 offset:31744
    ds_read_b64_tr_b16 a[254:255], v6 offset:32000
    s_waitcnt lgkmcnt(0)
    v_and_b32 v8, 31, v1
    v_xor_b32 v8, v8, v5
    v_lshlrev_b32 v8, 4, v8
    v_lshl_add_u32 v8, v5, 13, v8
    v_xor_b32 v16, 0, v8
    v_xor_b32 v17, 32, v8
    v_xor_b32 v18, 64, v8
    v_xor_b32 v19, 96, v8
    v_xor_b32 v20, 128, v8
    v_xor_b32 v21, 160, v8
    v_xor_b32 v22, 192, v8
    v_xor_b32 v23, 224, v8
    v_and_b32 v9, 31, v1
    v_and_b32 v10, 15, v1
    v_xor_b32 v10, v10, v5
    v_lshlrev_b32 v10, 4, v10
    v_lshl_add_u32 v10, v9, 9, v10
    v_add_u32 v10, s61, v10
    v_lshlrev_b32 v11, 4, v1
    s_lshl_b32 s59, s56, 12
    s_add_u32 s59, s59, 131072
    v_add_u32 v12, s59, v11
    s_lshl_b32 s59, s56, 10
    s_add_u32 s59, s59, 131072
    v_add_u32 v13, s59, v11
    v_mul_u32_u24 v14, 2560, v9
    v_lshl_add_u32 v14, v5, 3, v14
    s_lshl_b32 s59, s57, 6
    s_lshl_b32 s60, s56, 4
    s_add_u32 s59, s59, s60
    s_add_u32 s59, s59, 1280
    v_add_u32 v14, s59, v14
.os_79:
    s_lshl_b32 s73, s58, 2
    s_add_u32 s73, s73, 0x5a0c000
    s_mov_b32 s74, 7
    s_waitcnt vmcnt(0)
    s_cmp_lg_u32 s56, 0
    s_cbranch_scc1 .wo_81
    v_mov_b32 v28, s73
    s_mov_b32 s75, 0
.wl_80:
    global_load_dword v29, v28, s[40:41] sc1
    s_waitcnt vmcnt(0)
    v_readfirstlane_b32 s76, v29
    s_nop 0
    s_cmp_ge_i32 s76, s74
    s_cbranch_scc1 .wo_81
    s_sleep 12
    s_add_u32 s75, s75, 1
    s_cmp_lt_u32 s75, 3000000
    s_cbranch_scc1 .wl_80
    s_branch .abort_1
.wo_81:
    s_barrier
    s_lshl_b32 s59, s58, 18
    s_lshl_b32 s60, s56, 11
    s_add_u32 s59, s59, s60
    s_add_u32 s59, s59, 0x3000000
    s_add_u32 m0, s61, 0
    s_add_u32 s60, s59, 0
    buffer_load_dwordx4 v16, s[52:55], s60 offen sc1 lds
    s_add_u32 m0, s61, 1024
    s_add_u32 s60, s59, 16384
    buffer_load_dwordx4 v17, s[52:55], s60 offen sc1 lds
    s_add_u32 m0, s61, 2048
    s_add_u32 s60, s59, 32768
    buffer_load_dwordx4 v18, s[52:55], s60 offen sc1 lds
    s_add_u32 m0, s61, 3072
    s_add_u32 s60, s59, 49152
    buffer_load_dwordx4 v19, s[52:55], s60 offen sc1 lds
    s_add_u32 m0, s61, 4096
    s_add_u32 s60, s59, 65536
    buffer_load_dwordx4 v20, s[52:55], s60 offen sc1 lds
    s_add_u32 m0, s61, 5120
    s_add_u32 s60, s59, 81920
    buffer_load_dwordx4 v21, s[52:55], s60 offen sc1 lds
    s_add_u32 m0, s61, 6144
    s_add_u32 s60, s59, 98304
    buffer_load_dwordx4 v22, s[52:55], s60 offen sc1 lds
    s_add_u32 m0, s61, 7168
    s_add_u32 s60, s59, 114688
    buffer_load_dwordx4 v23, s[52:55], s60 offen sc1 lds
    s_add_u32 m0, s61, 8192
    s_add_u32 s60, s59, 131072
    buffer_load_dwordx4 v16, s[52:55], s60 offen sc1 lds
    s_add_u32 m0, s61, 9216
    s_add_u32 s60, s59, 147456
    buffer_load_dwordx4 v17, s[52:55], s60 offen sc1 lds
    s_add_u32 m0, s61, 10240
    s_add_u32 s60, s59, 163840
    buffer_load_dwordx4 v18, s[52:55], s60 offen sc1 lds
    s_add_u32 m0, s61, 11264
    s_add_u32 s60, s59, 180224
    buffer_load_dwordx4 v19, s[52:55], s60 offen sc1 lds
    s_add_u32 m0, s61, 12288
    s_add_u32 s60, s59, 196608
    buffer_load_dwordx4 v20, s[52:55], s60 offen sc1 lds
    s_add_u32 m0, s61, 13312
    s_add_u32 s60, s59, 212992
    buffer_load_dwordx4 v21, s[52:55], s60 offen sc1 lds
    s_add_u32 m0, s61, 14336
    s_add_u32 s60, s59, 229376
    buffer_load_dwordx4 v22, s[52:55], s60 offen sc1 lds
    s_add_u32 m0, s61, 15360
    s_add_u32 s60, s59, 245760
    buffer_load_dwordx4 v23, s[52:55], s60 offen sc1 lds
    s_add_u32 m0, s61, 16384
    s_add_u32 s60, s59, 512
    buffer_load_dwordx4 v16, s[52:55], s60 offen sc1 lds
    s_add_u32 m0, s61, 17408
    s_add_u32 s60, s59, 16896
    buffer_load_dwordx4 v17, s[52:55], s60 offen sc1 lds
    s_add_u32 m0, s61, 18432
    s_add_u32 s60, s59, 33280
    buffer_load_dwordx4 v18, s[52:55], s60 offen sc1 lds
    s_add_u32 m0, s61, 19456
    s_add_u32 s60, s59, 49664
    buffer_load_dwordx4 v19, s[52:55], s60 offen sc1 lds
    s_add_u32 m0, s61, 20480
    s_add_u32 s60, s59, 66048
    buffer_load_dwordx4 v20, s[52:55], s60 offen sc1 lds
    s_add_u32 m0, s61, 21504
    s_add_u32 s60, s59, 82432
    buffer_load_dwordx4 v21, s[52:55], s60 offen sc1 lds
    s_add_u32 m0, s61, 22528
    s_add_u32 s60, s59, 98816
    buffer_load_dwordx4 v22, s[52:55], s60 offen sc1 lds
    s_add_u32 m0, s61, 23552
    s_add_u32 s60, s59, 115200
    buffer_load_dwordx4 v23, s[52:55], s60 offen sc1 lds
    s_add_u32 m0, s61, 24576
    s_add_u32 s60, s59, 131584
    buffer_load_dwordx4 v16, s[52:55], s60 offen sc1 lds
    s_add_u32 m0, s61, 25600
    s_add_u32 s60, s59, 147968
    buffer_load_dwordx4 v17, s[52:55], s60 offen sc1 lds
    s_add_u32 m0, s61, 26624
    s_add_u32 s60, s59, 164352
    buffer_load_dwordx4 v18, s[52:55], s60 offen sc1 lds
    s_add_u32 m0, s61, 27648
    s_add_u32 s60, s59, 180736
    buffer_load_dwordx4 v19, s[52:55], s60 offen sc1 lds
    s_add_u32 m0, s61, 28672
    s_add_u32 s60, s59, 197120
    buffer_load_dwordx4 v20, s[52:55], s60 offen sc1 lds
    s_add_u32 m0, s61, 29696
    s_add_u32 s60, s59, 213504
    buffer_load_dwordx4 v21, s[52:55], s60 offen sc1 lds
    s_add_u32 m0, s61, 30720
    s_add_u32 s60, s59, 229888
    buffer_load_dwordx4 v22, s[52:55], s60 offen sc1 lds
    s_add_u32 m0, s61, 31744
    s_add_u32 s60, s59, 246272
    buffer_load_dwordx4 v23, s[52:55], s60 offen sc1 lds
    s_waitcnt vmcnt(16)
    v_xor_b32 v24, 0, v10
    ds_read_b128 v[64:67], v24 offset:0
    v_xor_b32 v25, 32, v10
    ds_read_b128 v[68:71], v25 offset:0
    v_xor_b32 v26, 64, v10
    ds_read_b128 v[72:75], v26 offset:0
    v_xor_b32 v27, 96, v10
    ds_read_b128 v[76:79], v27 offset:0
    v_xor_b32 v24, 128, v10
    ds_read_b128 v[80:83], v24 offset:0
    v_xor_b32 v25, 160, v10
    ds_read_b128 v[84:87], v25 offset:0
    v_xor_b32 v26, 192, v10
    ds_read_b128 v[88:91], v26 offset:0
    v_xor_b32 v27, 224, v10
    ds_read_b128 v[92:95], v27 offset:0
    v_xor_b32 v24, 256, v10
    ds_read_b128 v[96:99], v24 offset:0
    v_xor_b32 v25, 288, v10
    ds_read_b128 v[100:103], v25 offset:0
    v_xor_b32 v26, 320, v10
    ds_read_b128 v[104:107], v26 offset:0
    v_xor_b32 v27, 352, v10
    ds_read_b128 v[108:111], v27 offset:0
    v_xor_b32 v24, 384, v10
    ds_read_b128 v[112:115], v24 offset:0
    v_xor_b32 v25, 416, v10
    ds_read_b128 v[116:119], v25 offset:0
    v_xor_b32 v26, 448, v10
    ds_read_b128 v[120:123], v26 offset:0
    v_xor_b32 v27, 480, v10
    ds_read_b128 v[124:127], v27 offset:0
    s_waitcnt lgkmcnt(0)
    v_mfma_f32_32x32x16_bf16 v[32:47], a[0:3], v[64:67], 0
    s_add_u32 m0, s61, 0
    s_add_u32 s60, s59, 1024
    buffer_load_dwordx4 v16, s[52:55], s60 offen sc1 lds
    v_mfma_f32_32x32x16_bf16 v[32:47], a[4:7], v[68:71], v[32:47]
    s_add_u32 m0, s61, 1024
    s_add_u32 s60, s59, 17408
    buffer_load_dwordx4 v17, s[52:55], s60 offen sc1 lds
    v_mfma_f32_32x32x16_bf16 v[32:47], a[8:11], v[72:75], v[32:47]
    s_add_u32 m0, s61, 2048
    s_add_u32 s60, s59, 33792
    buffer_load_dwordx4 v18, s[52:55], s60 offen sc1 lds
    v_mfma_f32_32x32x16_bf16 v[32:47], a[12:15], v[76:79], v[32:47]
    s_add_u32 m0, s61, 3072
    s_add_u32 s60, s59, 50176
    buffer_load_dwordx4 v19, s[52:55], s60 offen sc1 lds
    v_mfma_f32_32x32x16_bf16 v[32:47], a[16:19], v[80:83], v[32:47]
    s_add_u32 m0, s61, 4096
    s_add_u32 s60, s59, 66560
    buffer_load_dwordx4 v20, s[52:55], s60 offen sc1 lds
    v_mfma_f32_32x32x16_bf16 v[32:47], a[20:23], v[84:87], v[32:47]
    s_add_u32 m0, s61, 5120
    s_add_u32 s60, s59, 82944
    buffer_load_dwordx4 v21, s[52:55], s60 offen sc1 lds
    v_mfma_f32_32x32x16_bf16 v[32:47], a[24:27], v[88:91], v[32:47]
    s_add_u32 m0, s61, 6144
    s_add_u32 s60, s59, 99328
    buffer_load_dwordx4 v22, s[52:55], s60 offen sc1 lds
    v_mfma_f32_32x32x16_bf16 v[32:47], a[28:31], v[92:95], v[32:47]
    s_add_u32 m0, s61, 7168
    s_add_u32 s60, s59, 115712
    buffer_load_dwordx4 v23, s[52:55], s60 offen sc1 lds
    v_mfma_f32_32x32x16_bf16 v[32:47], a[32:35], v[96:99], v[32:47]
    s_add_u32 m0, s61, 8192
    s_add_u32 s60, s59, 132096
    buffer_load_dwordx4 v16, s[52:55], s60 offen sc1 lds
    v_mfma_f32_32x32x16_bf16 v[32:47], a[36:39], v[100:103], v[32:47]
    s_add_u32 m0, s61, 9216
    s_add_u32 s60, s59, 148480
    buffer_load_dwordx4 v17, s[52:55], s60 offen sc1 lds
    v_mfma_f32_32x32x16_bf16 v[32:47], a[40:43], v[104:107], v[32:47]
    s_add_u32 m0, s61, 10240
    s_add_u32 s60, s59, 164864
    buffer_load_dwordx4 v18, s[52:55], s60 offen sc1 lds
    v_mfma_f32_32x32x16_bf16 v[32:47], a[44:47], v[108:111], v[32:47]
    s_add_u32 m0, s61, 11264
    s_add_u32 s60, s59, 181248
    buffer_load_dwordx4 v19, s[52:55], s60 offen sc1 lds
    v_mfma_f32_32x32x16_bf16 v[32:47], a[48:51], v[112:115], v[32:47]
    s_add_u32 m0, s61, 12288
    s_add_u32 s60, s59, 197632
    buffer_load_dwordx4 v20, s[52:55], s60 offen sc1 lds
    v_mfma_f32_32x32x16_bf16 v[32:47], a[52:55], v[116:119], v[32:47]
    s_add_u32 m0, s61, 13312
    s_add_u32 s60, s59, 214016
    buffer_load_dwordx4 v21, s[52:55], s60 offen sc1 lds
    v_mfma_f32_32x32x16_bf16 v[32:47], a[56:59], v[120:123], v[32:47]
    s_add_u32 m0, s61, 14336
    s_add_u32 s60, s59, 230400
    buffer_load_dwordx4 v22, s[52:55], s60 offen sc1 lds
    v_mfma_f32_32x32x16_bf16 v[32:47], a[60:63], v[124:127], v[32:47]
    s_add_u32 m0, s61, 15360
    s_add_u32 s60, s59, 246784
    buffer_load_dwordx4 v23, s[52:55], s60 offen sc1 lds
    s_waitcnt vmcnt(16)
    v_xor_b32 v24, 0, v10
    ds_read_b128 v[64:67], v24 offset:16384
    v_xor_b32 v25, 32, v10
    ds_read_b128 v[68:71], v25 offset:16384
    v_xor_b32 v26, 64, v10
    ds_read_b128 v[72:75], v26 offset:16384
    v_xor_b32 v27, 96, v10
    ds_read_b128 v[76:79], v27 offset:16384
    v_xor_b32 v24, 128, v10
    ds_read_b128 v[80:83], v24 offset:16384
    v_xor_b32 v25, 160, v10
    ds_read_b128 v[84:87], v25 offset:16384
    v_xor_b32 v26, 192, v10
    ds_read_b128 v[88:91], v26 offset:16384
    v_xor_b32 v27, 224, v10
    ds_read_b128 v[92:95], v27 offset:16384
    v_xor_b32 v24, 256, v10
    ds_read_b128 v[96:99], v24 offset:16384
    v_xor_b32 v25, 288, v10
    ds_read_b128 v[100:103], v25 offset:16384
    v_xor_b32 v26, 320, v10
    ds_read_b128 v[104:107], v26 offset:16384
    v_xor_b32 v27, 352, v10
    ds_read_b128 v[108:111], v27 offset:16384
    v_xor_b32 v24, 384, v10
    ds_read_b128 v[112:115], v24 offset:16384
    v_xor_b32 v25, 416, v10
    ds_read_b128 v[116:119], v25 offset:16384
    v_xor_b32 v26, 448, v10
    ds_read_b128 v[120:123], v26 offset:16384
    v_xor_b32 v27, 480, v10
    ds_read_b128 v[124:127], v27 offset:16384
    s_waitcnt lgkmcnt(0)
    v_mfma_f32_32x32x16_bf16 v[32:47], a[64:67], v[64:67], v[32:47]
    s_add_u32 m0, s61, 16384
    s_add_u32 s60, s59, 1536
    buffer_load_dwordx4 v16, s[52:55], s60 offen sc1 lds
    v_mfma_f32_32x32x16_bf16 v[32:47], a[68:71], v[68:71], v[32:47]
    s_add_u32 m0, s61, 17408
    s_add_u32 s60, s59, 17920
    buffer_load_dwordx4 v17, s[52:55], s60 offen sc1 lds
    v_mfma_f32_32x32x16_bf16 v[32:47], a[72:75], v[72:75], v[32:47]
    s_add_u32 m0, s61, 18432
    s_add_u32 s60, s59, 34304
    buffer_load_dwordx4 v18, s[52:55], s60 offen sc1 lds
    v_mfma_f32_32x32x16_bf16 v[32:47], a[76:79], v[76:79], v[32:47]
    s_add_u32 m0, s61, 19456
    s_add_u32 s60, s59, 50688
    buffer_load_dwordx4 v19, s[52:55], s60 offen sc1 lds
    v_mfma_f32_32x32x16_bf16 v[32:47], a[80:83], v[80:83], v[32:47]
    s_add_u32 m0, s61, 20480
    s_add_u32 s60, s59, 67072
    buffer_load_dwordx4 v20, s[52:55], s60 offen sc1 lds
    v_mfma_f32_32x32x16_bf16 v[32:47], a[84:87], v[84:87], v[32:47]
    s_add_u32 m0, s61, 21504
    s_add_u32 s60, s59, 83456
    buffer_load_dwordx4 v21, s[52:55], s60 offen sc1 lds
    v_mfma_f32_32x32x16_bf16 v[32:47], a[88:91], v[88:91], v[32:47]
    s_add_u32 m0, s61, 22528
    s_add_u32 s60, s59, 99840
    buffer_load_dwordx4 v22, s[52:55], s60 offen sc1 lds
    v_mfma_f32_32x32x16_bf16 v[32:47], a[92:95], v[92:95], v[32:47]
    s_add_u32 m0, s61, 23552
    s_add_u32 s60, s59, 116224
    buffer_load_dwordx4 v23, s[52:55], s60 offen sc1 lds
    v_mfma_f32_32x32x16_bf16 v[32:47], a[96:99], v[96:99], v[32:47]
    s_add_u32 m0, s61, 24576
    s_add_u32 s60, s59, 132608
    buffer_load_dwordx4 v16, s[52:55], s60 offen sc1 lds
    v_mfma_f32_32x32x16_bf16 v[32:47], a[100:103], v[100:103], v[32:47]
    s_add_u32 m0, s61, 25600
    s_add_u32 s60, s59, 148992
    buffer_load_dwordx4 v17, s[52:55], s60 offen sc1 lds
    v_mfma_f32_32x32x16_bf16 v[32:47], a[104:107], v[104:107], v[32:47]
    s_add_u32 m0, s61, 26624
    s_add_u32 s60, s59, 165376
    buffer_load_dwordx4 v18, s[52:55], s60 offen sc1 lds
    v_mfma_f32_32x32x16_bf16 v[32:47], a[108:111], v[108:111], v[32:47]
    s_add_u32 m0, s61, 27648
    s_add_u32 s60, s59, 181760
    buffer_load_dwordx4 v19, s[52:55], s60 offen sc1 lds
    v_mfma_f32_32x32x16_bf16 v[32:47], a[112:115], v[112:115], v[32:47]
    s_add_u32 m0, s61, 28672
    s_add_u32 s60, s59, 198144
    buffer_load_dwordx4 v20, s[52:55], s60 offen sc1 lds
    v_mfma_f32_32x32x16_bf16 v[32:47], a[116:119], v[116:119], v[32:47]
    s_add_u32 m0, s61, 29696
    s_add_u32 s60, s59, 214528
    buffer_load_dwordx4 v21, s[52:55], s60 offen sc1 lds
    v_mfma_f32_32x32x16_bf16 v[32:47], a[120:123], v[120:123], v[32:47]
    s_add_u32 m0, s61, 30720
    s_add_u32 s60, s59, 230912
    buffer_load_dwordx4 v22, s[52:55], s60 offen sc1 lds
    v_mfma_f32_32x32x16_bf16 v[32:47], a[124:127], v[124:127], v[32:47]
    s_add_u32 m0, s61, 31744
    s_add_u32 s60, s59, 247296
    buffer_load_dwordx4 v23, s[52:55], s60 offen sc1 lds
    s_waitcnt vmcnt(16)
    v_xor_b32 v24, 0, v10
    ds_read_b128 v[64:67], v24 offset:0
    v_xor_b32 v25, 32, v10
    ds_read_b128 v[68:71], v25 offset:0
    v_xor_b32 v26, 64, v10
    ds_read_b128 v[72:75], v26 offset:0
    v_xor_b32 v27, 96, v10
    ds_read_b128 v[76:79], v27 offset:0
    v_xor_b32 v24, 128, v10
    ds_read_b128 v[80:83], v24 offset:0
    v_xor_b32 v25, 160, v10
    ds_read_b128 v[84:87], v25 offset:0
    v_xor_b32 v26, 192, v10
    ds_read_b128 v[88:91], v26 offset:0
    v_xor_b32 v27, 224, v10
    ds_read_b128 v[92:95], v27 offset:0
    v_xor_b32 v24, 256, v10
    ds_read_b128 v[96:99], v24 offset:0
    v_xor_b32 v25, 288, v10
    ds_read_b128 v[100:103], v25 offset:0
    v_xor_b32 v26, 320, v10
    ds_read_b128 v[104:107], v26 offset:0
    v_xor_b32 v27, 352, v10
    ds_read_b128 v[108:111], v27 offset:0
    v_xor_b32 v24, 384, v10
    ds_read_b128 v[112:115], v24 offset:0
    v_xor_b32 v25, 416, v10
    ds_read_b128 v[116:119], v25 offset:0
    v_xor_b32 v26, 448, v10
    ds_read_b128 v[120:123], v26 offset:0
    v_xor_b32 v27, 480, v10
    ds_read_b128 v[124:127], v27 offset:0
    s_waitcnt lgkmcnt(0)
    v_mfma_f32_32x32x16_bf16 v[32:47], a[128:131], v[64:67], v[32:47]
    v_mfma_f32_32x32x16_bf16 v[32:47], a[132:135], v[68:71], v[32:47]
    v_mfma_f32_32x32x16_bf16 v[32:47], a[136:139], v[72:75], v[32:47]
    v_mfma_f32_32x32x16_bf16 v[32:47], a[140:143], v[76:79], v[32:47]
    v_mfma_f32_32x32x16_bf16 v[32:47], a[144:147], v[80:83], v[32:47]
    v_mfma_f32_32x32x16_bf16 v[32:47], a[148:151], v[84:87], v[32:47]
    v_mfma_f32_32x32x16_bf16 v[32:47], a[152:155], v[88:91], v[32:47]
    v_mfma_f32_32x32x16_bf16 v[32:47], a[156:159], v[92:95], v[32:47]
    v_mfma_f32_32x32x16_bf16 v[32:47], a[160:163], v[96:99], v[32:47]
    v_mfma_f32_32x32x16_bf16 v[32:47], a[164:167], v[100:103], v[32:47]
    v_mfma_f32_32x32x16_bf16 v[32:47], a[168:171], v[104:107], v[32:47]
    v_mfma_f32_32x32x16_bf16 v[32:47], a[172:175], v[108:111], v[32:47]
    v_mfma_f32_32x32x16_bf16 v[32:47], a[176:179], v[112:115], v[32:47]
    v_mfma_f32_32x32x16_bf16 v[32:47], a[180:183], v[116:119], v[32:47]
    v_mfma_f32_32x32x16_bf16 v[32:47], a[184:187], v[120:123], v[32:47]
    v_mfma_f32_32x32x16_bf16 v[32:47], a[188:191], v[124:127], v[32:47]
    s_waitcnt vmcnt(0)
    v_xor_b32 v24, 0, v10
    ds_read_b128 v[64:67], v24 offset:16384
    v_xor_b32 v25, 32, v10
    ds_read_b128 v[68:71], v25 offset:16384
    v_xor_b32 v26, 64, v10
    ds_read_b128 v[72:75], v26 offset:16384
    v_xor_b32 v27, 96, v10
    ds_read_b128 v[76:79], v27 offset:16384
    v_xor_b32 v24, 128, v10
    ds_read_b128 v[80:83], v24 offset:16384
    v_xor_b32 v25, 160, v10
    ds_read_b128 v[84:87], v25 offset:16384
    v_xor_b32 v26, 192, v10
    ds_read_b128 v[88:91], v26 offset:16384
    v_xor_b32 v27, 224, v10
    ds_read_b128 v[92:95], v27 offset:16384
    v_xor_b32 v24, 256, v10
    ds_read_b128 v[96:99], v24 offset:16384
    v_xor_b32 v25, 288, v10
    ds_read_b128 v[100:103], v25 offset:16384
    v_xor_b32 v26, 320, v10
    ds_read_b128 v[104:107], v26 offset:16384
    v_xor_b32 v27, 352, v10
    ds_read_b128 v[108:111], v27 offset:16384
    v_xor_b32 v24, 384, v10
    ds_read_b128 v[112:115], v24 offset:16384
    v_xor_b32 v25, 416, v10
    ds_read_b128 v[116:119], v25 offset:16384
    v_xor_b32 v26, 448, v10
    ds_read_b128 v[120:123], v26 offset:16384
    v_xor_b32 v27, 480, v10
    ds_read_b128 v[124:127], v27 offset:16384
    s_waitcnt lgkmcnt(0)
    v_mfma_f32_32x32x16_bf16 v[32:47], a[192:195], v[64:67], v[32:47]
    v_mfma_f32_32x32x16_bf16 v[32:47], a[196:199], v[68:71], v[32:47]
    v_mfma_f32_32x32x16_bf16 v[32:47], a[200:203], v[72:75], v[32:47]
    v_mfma_f32_32x32x16_bf16 v[32:47], a[204:207], v[76:79], v[32:47]
    v_mfma_f32_32x32x16_bf16 v[32:47], a[208:211], v[80:83], v[32:47]
    v_mfma_f32_32x32x16_bf16 v[32:47], a[212:215], v[84:87], v[32:47]
    v_mfma_f32_32x32x16_bf16 v[32:47], a[216:219], v[88:91], v[32:47]
    v_mfma_f32_32x32x16_bf16 v[32:47], a[220:223], v[92:95], v[32:47]
    v_mfma_f32_32x32x16_bf16 v[32:47], a[224:227], v[96:99], v[32:47]
    v_mfma_f32_32x32x16_bf16 v[32:47], a[228:231], v[100:103], v[32:47]
    v_mfma_f32_32x32x16_bf16 v[32:47], a[232:235], v[104:107], v[32:47]
    v_mfma_f32_32x32x16_bf16 v[32:47], a[236:239], v[108:111], v[32:47]
    v_mfma_f32_32x32x16_bf16 v[32:47], a[240:243], v[112:115], v[32:47]
    v_mfma_f32_32x32x16_bf16 v[32:47], a[244:247], v[116:119], v[32:47]
    v_mfma_f32_32x32x16_bf16 v[32:47], a[248:251], v[120:123], v[32:47]
    v_mfma_f32_32x32x16_bf16 v[32:47], a[252:255], v[124:127], v[32:47]
    s_nop 11
    ds_write_b128 v12, v[32:35] offset:0
    ds_write_b128 v12, v[36:39] offset:1024
    ds_write_b128 v12, v[40:43] offset:2048
    ds_write_b128 v12, v[44:47] offset:3072
    s_waitcnt lgkmcnt(0)
    s_barrier
    ds_read_b128 v[64:67], v13 offset:0
    ds_read_b128 v[68:71], v13 offset:4096
    ds_read_b128 v[72:75], v13 offset:8192
    ds_read_b128 v[76:79], v13 offset:12288
    s_waitcnt lgkmcnt(0)
    s_barrier
    v_add_f32 v64, v64, v68
    v_add_f32 v72, v72, v76
    v_add_f32 v65, v65, v69
    v_add_f32 v73, v73, v77
    v_add_f32 v66, v66, v70
    v_add_f32 v74, v74, v78
    v_add_f32 v67, v67, v71
    v_add_f32 v75, v75, v79
    v_add_f32 v64, v64, v72
    v_add_f32 v65, v65, v73
    v_add_f32 v66, v66, v74
    v_add_f32 v67, v67, v75
    v_cvt_pk_bf16_f32 v64, v64, v65
    v_cvt_pk_bf16_f32 v65, v66, v67
    s_mul_i32 s59, s58, 81920
    buffer_store_dwordx2 v[64:65], v14, s[48:51], s59 offen
    s_add_u32 s58, s58, 3
    s_cmp_lt_u32 s58, 64
    s_cbranch_scc1 .os_79
    s_branch .done_2
.hrole_4:
    s_mov_b32 s99, -1
    s_mov_b32 s90, 0
    s_mov_b32 s91, 0
    s_mov_b32 s92, 0
    s_mov_b32 s93, 0
    s_mov_b32 s94, 0
    s_mov_b32 s95, 0
    s_mov_b32 s96, 0
    s_mov_b32 s97, 0
    v_and_b32 v1, 63, v0
    v_lshrrev_b32 v2, 6, v0
    s_nop 0
    v_readfirstlane_b32 s53, v2
    v_and_b32 v2, 8, v1
    v_cmp_ne_u32 s[60:61], 0, v2
    v_cmp_gt_u32 s[62:63], 32, v1
    v_cmp_gt_u32 s[64:65], 40, v1
    v_cmp_eq_u32 s[66:67], 0, v2
    s_cmp_eq_u32 s53, 1
    s_cselect_b64 s[88:89], -1, 0
    s_mov_b32 s44, s40
    s_and_b32 s45, s41, 0xffff
    s_mov_b32 s46, 0xfe00000
    s_mov_b32 s47, 0x00020000
    s_mov_b32 s54, 63
    s_mul_i32 s55, s53, 24576
    s_add_u32 s55, s55, 51200
    v_lshlrev_b32 v17, 4, v1
    v_add_u32 v17, s55, v17
    s_mov_b32 s72, s26
    s_and_b32 s73, s27, 0xffff
    s_mov_b32 s74, 0x500000
    s_mov_b32 s75, 0x00020000
    s_mov_b32 s76, s28
    s_and_b32 s77, s29, 0xffff
    s_mov_b32 s78, 0x500000
    s_mov_b32 s79, 0x00020000
    s_mov_b32 s80, s32
    s_and_b32 s81, s33, 0xffff
    s_mov_b32 s82, 0x500000
    s_mov_b32 s83, 0x00020000
    v_lshrrev_b32 v20, 4, v1
    s_lshl_b32 s55, s53, 4
    v_add_u32 v20, s55, v20
    v_and_b32 v22, 15, v1
    v_lshlrev_b32 v22, 4, v22
    v_mul_u32_u24 v21, 1280, v20
    v_add_u32 v21, v21, v22
    v_lshl_add_u32 v20, v20, 13, v22
    v_lshrrev_b32 v22, 5, v1
    v_lshlrev_b32 v22, 3, v22
    v_bfe_u32 v24, v1, 4, 1
    v_lshl_add_u32 v22, v24, 2, v22
    v_bfe_u32 v24, v1, 2, 1
    v_add_u32 v22, v24, v22
    v_lshlrev_b32 v22, 8, v22
    v_bfe_u32 v24, v1, 3, 1
    v_lshl_add_u32 v22, v24, 5, v22
    v_and_b32 v24, 3, v1
    v_lshl_add_u32 v22, v24, 3, v22
    s_lshl_b32 s55, s53, 6
    v_add_u32 v22, s55, v22
    v_lshrrev_b32 v23, 5, v1
    v_lshlrev_b32 v23, 2, v23
    v_bfe_u32 v24, v1, 4, 1
    v_lshl_add_u32 v23, v24, 4, v23
    v_bfe_u32 v24, v1, 2, 1
    v_add_u32 v23, v24, v23
    v_lshlrev_b32 v23, 8, v23
    v_bfe_u32 v24, v1, 3, 1
    v_lshl_add_u32 v23, v24, 5, v23
    v_and_b32 v24, 3, v1
    v_lshl_add_u32 v23, v24, 3, v23
    s_lshl_b32 s70, s52, 8
    s_mul_i32 s71, s52, 163840
    s_lshl_b32 s98, s53, 12
    s_add_u32 m0, s98, 0
    s_add_u32 s56, s70, 0
    buffer_load_dwordx4 v20, s[72:75], s56 offen lds
    s_add_u32 m0, s98, 1024
    s_add_u32 s56, s70, 32768
    buffer_load_dwordx4 v20, s[72:75], s56 offen lds
    s_add_u32 m0, s98, 2048
    s_add_u32 s56, s70, 65536
    buffer_load_dwordx4 v20, s[72:75], s56 offen lds
    s_add_u32 m0, s98, 3072
    s_add_u32 s56, s70, 98304
    buffer_load_dwordx4 v20, s[72:75], s56 offen lds
    s_add_u32 m0, s98, 16384
    s_add_u32 s56, s70, 524288
    buffer_load_dwordx4 v20, s[72:75], s56 offen lds
    s_add_u32 m0, s98, 17408
    s_add_u32 s56, s70, 557056
    buffer_load_dwordx4 v20, s[72:75], s56 offen lds
    s_add_u32 m0, s98, 18432
    s_add_u32 s56, s70, 589824
    buffer_load_dwordx4 v20, s[72:75], s56 offen lds
    s_add_u32 m0, s98, 19456
    s_add_u32 s56, s70, 622592
    buffer_load_dwordx4 v20, s[72:75], s56 offen lds
    s_add_u32 m0, s98, 32768
    s_add_u32 s56, s70, 1048576
    buffer_load_dwordx4 v20, s[72:75], s56 offen lds
    s_add_u32 m0, s98, 33792
    s_add_u32 s56, s70, 1081344
    buffer_load_dwordx4 v20, s[72:75], s56 offen lds
    s_add_u32 m0, s98, 34816
    s_add_u32 s56, s70, 1114112
    buffer_load_dwordx4 v20, s[72:75], s56 offen lds
    s_add_u32 m0, s98, 35840
    s_add_u32 s56, s70, 1146880
    buffer_load_dwordx4 v20, s[72:75], s56 offen lds
    s_add_u32 m0, s98, 49152
    s_add_u32 s56, s70, 1572864
    buffer_load_dwordx4 v20, s[72:75], s56 offen lds
    s_add_u32 m0, s98, 50176
    s_add_u32 s56, s70, 1605632
    buffer_load_dwordx4 v20, s[72:75], s56 offen lds
    s_add_u32 m0, s98, 51200
    s_add_u32 s56, s70, 1638400
    buffer_load_dwordx4 v20, s[72:75], s56 offen lds
    s_add_u32 m0, s98, 52224
    s_add_u32 s56, s70, 1671168
    buffer_load_dwordx4 v20, s[72:75], s56 offen lds
    s_add_u32 m0, s98, 65536
    s_add_u32 s56, s70, 2097152
    buffer_load_dwordx4 v20, s[72:75], s56 offen lds
    s_add_u32 m0, s98, 66560
    s_add_u32 s56, s70, 2129920
    buffer_load_dwordx4 v20, s[72:75], s56 offen lds
    s_add_u32 m0, s98, 67584
    s_add_u32 s56, s70, 2162688
    buffer_load_dwordx4 v20, s[72:75], s56 offen lds
    s_add_u32 m0, s98, 68608
    s_add_u32 s56, s70, 2195456
    buffer_load_dwordx4 v20, s[72:75], s56 offen lds
    s_add_u32 m0, s98, 81920
    s_add_u32 s56, s70, 2621440
    buffer_load_dwordx4 v20, s[72:75], s56 offen lds
    s_add_u32 m0, s98, 82944
    s_add_u32 s56, s70, 2654208
    buffer_load_dwordx4 v20, s[72:75], s56 offen lds
    s_add_u32 m0, s98, 83968
    s_add_u32 s56, s70, 2686976
    buffer_load_dwordx4 v20, s[72:75], s56 offen lds
    s_add_u32 m0, s98, 84992
    s_add_u32 s56, s70, 2719744
    buffer_load_dwordx4 v20, s[72:75], s56 offen lds
    s_add_u32 m0, s98, 98304
    s_add_u32 s56, s70, 3145728
    buffer_load_dwordx4 v20, s[72:75], s56 offen lds
    s_add_u32 m0, s98, 99328
    s_add_u32 s56, s70, 3178496
    buffer_load_dwordx4 v20, s[72:75], s56 offen lds
    s_add_u32 m0, s98, 100352
    s_add_u32 s56, s70, 3211264
    buffer_load_dwordx4 v20, s[72:75], s56 offen lds
    s_add_u32 m0, s98, 101376
    s_add_u32 s56, s70, 3244032
    buffer_load_dwordx4 v20, s[72:75], s56 offen lds
    s_add_u32 m0, s98, 114688
    s_add_u32 s56, s70, 3670016
    buffer_load_dwordx4 v20, s[72:75], s56 offen lds
    s_add_u32 m0, s98, 115712
    s_add_u32 s56, s70, 3702784
    buffer_load_dwordx4 v20, s[72:75], s56 offen lds
    s_add_u32 m0, s98, 116736
    s_add_u32 s56, s70, 3735552
    buffer_load_dwordx4 v20, s[72:75], s56 offen lds
    s_add_u32 m0, s98, 117760
    s_add_u32 s56, s70, 3768320
    buffer_load_dwordx4 v20, s[72:75], s56 offen lds
    s_add_u32 m0, s98, 131072
    s_add_u32 s56, s70, 4194304
    buffer_load_dwordx4 v20, s[72:75], s56 offen lds
    s_add_u32 m0, s98, 132096
    s_add_u32 s56, s70, 4227072
    buffer_load_dwordx4 v20, s[72:75], s56 offen lds
    s_add_u32 m0, s98, 133120
    s_add_u32 s56, s70, 4259840
    buffer_load_dwordx4 v20, s[72:75], s56 offen lds
    s_add_u32 m0, s98, 134144
    s_add_u32 s56, s70, 4292608
    buffer_load_dwordx4 v20, s[72:75], s56 offen lds
    s_waitcnt vmcnt(32) lgkmcnt(0)
    s_barrier
    v_add_u32 v24, 0, v22
    ds_read_b64_tr_b16 a[0:1], v24 offset:0
    ds_read_b64_tr_b16 a[2:3], v24 offset:512
    ds_read_b64_tr_b16 a[4:5], v24 offset:4096
    ds_read_b64_tr_b16 a[6:7], v24 offset:4608
    ds_read_b64_tr_b16 a[8:9], v24 offset:8192
    ds_read_b64_tr_b16 a[10:11], v24 offset:8704
    ds_read_b64_tr_b16 a[12:13], v24 offset:12288
    ds_read_b64_tr_b16 a[14:15], v24 offset:12800
    s_waitcnt vmcnt(28) lgkmcnt(0)
    s_barrier
    s_add_u32 m0, s98, 0
    s_add_u32 s56, s70, 4718592
    buffer_load_dwordx4 v20, s[72:75], s56 offen lds
    s_add_u32 m0, s98, 1024
    s_add_u32 s56, s70, 4751360
    buffer_load_dwordx4 v20, s[72:75], s56 offen lds
    s_add_u32 m0, s98, 2048
    s_add_u32 s56, s70, 4784128
    buffer_load_dwordx4 v20, s[72:75], s56 offen lds
    s_add_u32 m0, s98, 3072
    s_add_u32 s56, s70, 4816896
    buffer_load_dwordx4 v20, s[72:75], s56 offen lds
    v_add_u32 v24, 16384, v22
    ds_read_b64_tr_b16 a[16:17], v24 offset:0
    ds_read_b64_tr_b16 a[18:19], v24 offset:512
    ds_read_b64_tr_b16 a[20:21], v24 offset:4096
    ds_read_b64_tr_b16 a[22:23], v24 offset:4608
    ds_read_b64_tr_b16 a[24:25], v24 offset:8192
    ds_read_b64_tr_b16 a[26:27], v24 offset:8704
    ds_read_b64_tr_b16 a[28:29], v24 offset:12288
    ds_read_b64_tr_b16 a[30:31], v24 offset:12800
    s_waitcnt vmcnt(28) lgkmcnt(0)
    s_barrier
    s_add_u32 m0, s98, 16384
    s_add_u32 s56, s70, 0
    buffer_load_dwordx4 v20, s[76:79], s56 offen lds
    s_add_u32 m0, s98, 17408
    s_add_u32 s56, s70, 32768
    buffer_load_dwordx4 v20, s[76:79], s56 offen lds
    s_add_u32 m0, s98, 18432
    s_add_u32 s56, s70, 65536
    buffer_load_dwordx4 v20, s[76:79], s56 offen lds
    s_add_u32 m0, s98, 19456
    s_add_u32 s56, s70, 98304
    buffer_load_dwordx4 v20, s[76:79], s56 offen lds
    v_add_u32 v24, 32768, v22
    ds_read_b64_tr_b16 a[32:33], v24 offset:0
    ds_read_b64_tr_b16 a[34:35], v24 offset:512
    ds_read_b64_tr_b16 a[36:37], v24 offset:4096
    ds_read_b64_tr_b16 a[38:39], v24 offset:4608
    ds_read_b64_tr_b16 a[40:41], v24 offset:8192
    ds_read_b64_tr_b16 a[42:43], v24 offset:8704
    ds_read_b64_tr_b16 a[44:45], v24 offset:12288
    ds_read_b64_tr_b16 a[46:47], v24 offset:12800
    s_waitcnt vmcnt(28) lgkmcnt(0)
    s_barrier
    s_add_u32 m0, s98, 32768
    s_add_u32 s56, s70, 524288
    buffer_load_dwordx4 v20, s[76:79], s56 offen lds
    s_add_u32 m0, s98, 33792
    s_add_u32 s56, s70, 557056
    buffer_load_dwordx4 v20, s[76:79], s56 offen lds
    s_add_u32 m0, s98, 34816
    s_add_u32 s56, s70, 589824
    buffer_load_dwordx4 v20, s[76:79], s56 offen lds
    s_add_u32 m0, s98, 35840
    s_add_u32 s56, s70, 622592
    buffer_load_dwordx4 v20, s[76:79], s56 offen lds
    v_add_u32 v24, 49152, v22
    ds_read_b64_tr_b16 a[48:49], v24 offset:0
    ds_read_b64_tr_b16 a[50:51], v24 offset:512
    ds_read_b64_tr_b16 a[52:53], v24 offset:4096
    ds_read_b64_tr_b16 a[54:55], v24 offset:4608
    ds_read_b64_tr_b16 a[56:57], v24 offset:8192
    ds_read_b64_tr_b16 a[58:59], v24 offset:8704
    ds_read_b64_tr_b16 a[60:61], v24 offset:12288
    ds_read_b64_tr_b16 a[62:63], v24 offset:12800
    s_waitcnt vmcnt(28) lgkmcnt(0)
    s_barrier
    s_add_u32 m0, s98, 49152
    s_add_u32 s56, s70, 1048576
    buffer_load_dwordx4 v20, s[76:79], s56 offen lds
    s_add_u32 m0, s98, 50176
    s_add_u32 s56, s70, 1081344
    buffer_load_dwordx4 v20, s[76:79], s56 offen lds
    s_add_u32 m0, s98, 51200
    s_add_u32 s56, s70, 1114112
    buffer_load_dwordx4 v20, s[76:79], s56 offen lds
    s_add_u32 m0, s98, 52224
    s_add_u32 s56, s70, 1146880
    buffer_load_dwordx4 v20, s[76:79], s56 offen lds
    v_add_u32 v24, 65536, v22
    ds_read_b64_tr_b16 a[64:65], v24 offset:0
    ds_read_b64_tr_b16 a[66:67], v24 offset:512
    ds_read_b64_tr_b16 a[68:69], v24 offset:4096
    ds_read_b64_tr_b16 a[70:71], v24 offset:4608
    ds_read_b64_tr_b16 a[72:73], v24 offset:8192
    ds_read_b64_tr_b16 a[74:75], v24 offset:8704
    ds_read_b64_tr_b16 a[76:77], v24 offset:12288
    ds_read_b64_tr_b16 a[78:79], v24 offset:12800
    s_waitcnt vmcnt(28) lgkmcnt(0)
    s_barrier
    s_add_u32 m0, s98, 65536
    s_add_u32 s56, s70, 1572864
    buffer_load_dwordx4 v20, s[76:79], s56 offen lds
    s_add_u32 m0, s98, 66560
    s_add_u32 s56, s70, 1605632
    buffer_load_dwordx4 v20, s[76:79], s56 offen lds
    s_add_u32 m0, s98, 67584
    s_add_u32 s56, s70, 1638400
    buffer_load_dwordx4 v20, s[76:79], s56 offen lds
    s_add_u32 m0, s98, 68608
    s_add_u32 s56, s70, 1671168
    buffer_load_dwordx4 v20, s[76:79], s56 offen lds
    v_add_u32 v24, 81920, v22
    ds_read_b64_tr_b16 a[80:81], v24 offset:0
    ds_read_b64_tr_b16 a[82:83], v24 offset:512
    ds_read_b64_tr_b16 a[84:85], v24 offset:4096
    ds_read_b64_tr_b16 a[86:87], v24 offset:4608
    ds_read_b64_tr_b16 a[88:89], v24 offset:8192
    ds_read_b64_tr_b16 a[90:91], v24 offset:8704
    ds_read_b64_tr_b16 a[92:93], v24 offset:12288
    ds_read_b64_tr_b16 a[94:95], v24 offset:12800
    s_waitcnt vmcnt(28) lgkmcnt(0)
    s_barrier
    s_add_u32 m0, s98, 81920
    s_add_u32 s56, s70, 2097152
    buffer_load_dwordx4 v20, s[76:79], s56 offen lds
    s_add_u32 m0, s98, 82944
    s_add_u32 s56, s70, 2129920
    buffer_load_dwordx4 v20, s[76:79], s56 offen lds
    s_add_u32 m0, s98, 83968
    s_add_u32 s56, s70, 2162688
    buffer_load_dwordx4 v20, s[76:79], s56 offen lds
    s_add_u32 m0, s98, 84992
    s_add_u32 s56, s70, 2195456
    buffer_load_dwordx4 v20, s[76:79], s56 offen lds
    v_add_u32 v24, 98304, v22
    ds_read_b64_tr_b16 a[96:97], v24 offset:0
    ds_read_b64_tr_b16 a[98:99], v24 offset:512
    ds_read_b64_tr_b16 a[100:101], v24 offset:4096
    ds_read_b64_tr_b16 a[102:103], v24 offset:4608
    ds_read_b64_tr_b16 a[104:105], v24 offset:8192
    ds_read_b64_tr_b16 a[106:107], v24 offset:8704
    ds_read_b64_tr_b16 a[108:109], v24 offset:12288
    ds_read_b64_tr_b16 a[110:111], v24 offset:12800
    s_waitcnt vmcnt(28) lgkmcnt(0)
    s_barrier
    s_add_u32 m0, s98, 98304
    s_add_u32 s56, s70, 2621440
    buffer_load_dwordx4 v20, s[76:79], s56 offen lds
    s_add_u32 m0, s98, 99328
    s_add_u32 s56, s70, 2654208
    buffer_load_dwordx4 v20, s[76:79], s56 offen lds
    s_add_u32 m0, s98, 100352
    s_add_u32 s56, s70, 2686976
    buffer_load_dwordx4 v20, s[76:79], s56 offen lds
    s_add_u32 m0, s98, 101376
    s_add_u32 s56, s70, 2719744
    buffer_load_dwordx4 v20, s[76:79], s56 offen lds
    v_add_u32 v24, 114688, v22
    ds_read_b64_tr_b16 a[112:113], v24 offset:0
    ds_read_b64_tr_b16 a[114:115], v24 offset:512
    ds_read_b64_tr_b16 a[116:117], v24 offset:4096
    ds_read_b64_tr_b16 a[118:119], v24 offset:4608
    ds_read_b64_tr_b16 a[120:121], v24 offset:8192
    ds_read_b64_tr_b16 a[122:123], v24 offset:8704
    ds_read_b64_tr_b16 a[124:125], v24 offset:12288
    ds_read_b64_tr_b16 a[126:127], v24 offset:12800
    s_waitcnt vmcnt(28) lgkmcnt(0)
    s_barrier
    s_add_u32 m0, s98, 114688
    s_add_u32 s56, s70, 3145728
    buffer_load_dwordx4 v20, s[76:79], s56 offen lds
    s_add_u32 m0, s98, 115712
    s_add_u32 s56, s70, 3178496
    buffer_load_dwordx4 v20, s[76:79], s56 offen lds
    s_add_u32 m0, s98, 116736
    s_add_u32 s56, s70, 3211264
    buffer_load_dwordx4 v20, s[76:79], s56 offen lds
    s_add_u32 m0, s98, 117760
    s_add_u32 s56, s70, 3244032
    buffer_load_dwordx4 v20, s[76:79], s56 offen lds
    v_add_u32 v24, 131072, v22
    ds_read_b64_tr_b16 a[128:129], v24 offset:0
    ds_read_b64_tr_b16 a[130:131], v24 offset:512
    ds_read_b64_tr_b16 a[132:133], v24 offset:4096
    ds_read_b64_tr_b16 a[134:135], v24 offset:4608
    ds_read_b64_tr_b16 a[136:137], v24 offset:8192
    ds_read_b64_tr_b16 a[138:139], v24 offset:8704
    ds_read_b64_tr_b16 a[140:141], v24 offset:12288
    ds_read_b64_tr_b16 a[142:143], v24 offset:12800
    s_waitcnt vmcnt(28) lgkmcnt(0)
    s_barrier
    s_add_u32 m0, s98, 131072
    s_add_u32 s56, s70, 3670016
    buffer_load_dwordx4 v20, s[76:79], s56 offen lds
    s_add_u32 m0, s98, 132096
    s_add_u32 s56, s70, 3702784
    buffer_load_dwordx4 v20, s[76:79], s56 offen lds
    s_add_u32 m0, s98, 133120
    s_add_u32 s56, s70, 3735552
    buffer_load_dwordx4 v20, s[76:79], s56 offen lds
    s_add_u32 m0, s98, 134144
    s_add_u32 s56, s70, 3768320
    buffer_load_dwordx4 v20, s[76:79], s56 offen lds
    v_add_u32 v24, 0, v22
    ds_read_b64_tr_b16 a[144:145], v24 offset:0
    ds_read_b64_tr_b16 a[146:147], v24 offset:512
    ds_read_b64_tr_b16 a[148:149], v24 offset:4096
    ds_read_b64_tr_b16 a[150:151], v24 offset:4608
    ds_read_b64_tr_b16 a[152:153], v24 offset:8192
    ds_read_b64_tr_b16 a[154:155], v24 offset:8704
    ds_read_b64_tr_b16 a[156:157], v24 offset:12288
    ds_read_b64_tr_b16 a[158:159], v24 offset:12800
    s_waitcnt vmcnt(28) lgkmcnt(0)
    s_barrier
    s_add_u32 m0, s98, 0
    s_add_u32 s56, s70, 4194304
    buffer_load_dwordx4 v20, s[76:79], s56 offen lds
    s_add_u32 m0, s98, 1024
    s_add_u32 s56, s70, 4227072
    buffer_load_dwordx4 v20, s[76:79], s56 offen lds
    s_add_u32 m0, s98, 2048
    s_add_u32 s56, s70, 4259840
    buffer_load_dwordx4 v20, s[76:79], s56 offen lds
    s_add_u32 m0, s98, 3072
    s_add_u32 s56, s70, 4292608
    buffer_load_dwordx4 v20, s[76:79], s56 offen lds
    v_add_u32 v24, 16384, v22
    ds_read_b64_tr_b16 a[160:161], v24 offset:0
    ds_read_b64_tr_b16 a[162:163], v24 offset:512
    ds_read_b64_tr_b16 a[164:165], v24 offset:4096
    ds_read_b64_tr_b16 a[166:167], v24 offset:4608
    ds_read_b64_tr_b16 a[168:169], v24 offset:8192
    ds_read_b64_tr_b16 a[170:171], v24 offset:8704
    ds_read_b64_tr_b16 a[172:173], v24 offset:12288
    ds_read_b64_tr_b16 a[174:175], v24 offset:12800
    s_waitcnt vmcnt(28) lgkmcnt(0)
    s_barrier
    s_add_u32 m0, s98, 16384
    s_add_u32 s56, s70, 4718592
    buffer_load_dwordx4 v20, s[76:79], s56 offen lds
    s_add_u32 m0, s98, 17408
    s_add_u32 s56, s70, 4751360
    buffer_load_dwordx4 v20, s[76:79], s56 offen lds
    s_add_u32 m0, s98, 18432
    s_add_u32 s56, s70, 4784128
    buffer_load_dwordx4 v20, s[76:79], s56 offen lds
    s_add_u32 m0, s98, 19456
    s_add_u32 s56, s70, 4816896
    buffer_load_dwordx4 v20, s[76:79], s56 offen lds
    v_add_u32 v24, 32768, v22
    ds_read_b64_tr_b16 a[176:177], v24 offset:0
    ds_read_b64_tr_b16 a[178:179], v24 offset:512
    ds_read_b64_tr_b16 a[180:181], v24 offset:4096
    ds_read_b64_tr_b16 a[182:183], v24 offset:4608
    ds_read_b64_tr_b16 a[184:185], v24 offset:8192
    ds_read_b64_tr_b16 a[186:187], v24 offset:8704
    ds_read_b64_tr_b16 a[188:189], v24 offset:12288
    ds_read_b64_tr_b16 a[190:191], v24 offset:12800
    s_waitcnt vmcnt(28) lgkmcnt(0)
    s_barrier
    s_add_u32 m0, s98, 32768
    s_add_u32 s56, s71, 0
    buffer_load_dwordx4 v21, s[80:83], s56 offen lds
    s_add_u32 m0, s98, 33792
    s_add_u32 s56, s71, 5120
    buffer_load_dwordx4 v21, s[80:83], s56 offen lds
    s_add_u32 m0, s98, 34816
    s_add_u32 s56, s71, 10240
    buffer_load_dwordx4 v21, s[80:83], s56 offen lds
    s_add_u32 m0, s98, 35840
    s_add_u32 s56, s71, 15360
    buffer_load_dwordx4 v21, s[80:83], s56 offen lds
    v_add_u32 v24, 49152, v22
    ds_read_b64_tr_b16 a[192:193], v24 offset:0
    ds_read_b64_tr_b16 a[194:195], v24 offset:512
    ds_read_b64_tr_b16 a[196:197], v24 offset:4096
    ds_read_b64_tr_b16 a[198:199], v24 offset:4608
    ds_read_b64_tr_b16 a[200:201], v24 offset:8192
    ds_read_b64_tr_b16 a[202:203], v24 offset:8704
    ds_read_b64_tr_b16 a[204:205], v24 offset:12288
    ds_read_b64_tr_b16 a[206:207], v24 offset:12800
    s_waitcnt vmcnt(28) lgkmcnt(0)
    s_barrier
    s_add_u32 m0, s98, 49152
    s_add_u32 s56, s71, 81920
    buffer_load_dwordx4 v21, s[80:83], s56 offen lds
    s_add_u32 m0, s98, 50176
    s_add_u32 s56, s71, 87040
    buffer_load_dwordx4 v21, s[80:83], s56 offen lds
    s_add_u32 m0, s98, 51200
    s_add_u32 s56, s71, 92160
    buffer_load_dwordx4 v21, s[80:83], s56 offen lds
    s_add_u32 m0, s98, 52224
    s_add_u32 s56, s71, 97280
    buffer_load_dwordx4 v21, s[80:83], s56 offen lds
    v_add_u32 v24, 65536, v22
    ds_read_b64_tr_b16 a[208:209], v24 offset:0
    ds_read_b64_tr_b16 a[210:211], v24 offset:512
    ds_read_b64_tr_b16 a[212:213], v24 offset:4096
    ds_read_b64_tr_b16 a[214:215], v24 offset:4608
    ds_read_b64_tr_b16 a[216:217], v24 offset:8192
    ds_read_b64_tr_b16 a[218:219], v24 offset:8704
    ds_read_b64_tr_b16 a[220:221], v24 offset:12288
    ds_read_b64_tr_b16 a[222:223], v24 offset:12800
    s_waitcnt vmcnt(28) lgkmcnt(0)
    s_barrier
    s_add_u32 m0, s98, 65536
    s_add_u32 s56, s71, 256
    buffer_load_dwordx4 v21, s[80:83], s56 offen lds
    s_add_u32 m0, s98, 66560
    s_add_u32 s56, s71, 5376
    buffer_load_dwordx4 v21, s[80:83], s56 offen lds
    s_add_u32 m0, s98, 67584
    s_add_u32 s56, s71, 10496
    buffer_load_dwordx4 v21, s[80:83], s56 offen lds
    s_add_u32 m0, s98, 68608
    s_add_u32 s56, s71, 15616
    buffer_load_dwordx4 v21, s[80:83], s56 offen lds
    v_add_u32 v24, 81920, v22
    ds_read_b64_tr_b16 a[224:225], v24 offset:0
    ds_read_b64_tr_b16 a[226:227], v24 offset:512
    ds_read_b64_tr_b16 a[228:229], v24 offset:4096
    ds_read_b64_tr_b16 a[230:231], v24 offset:4608
    ds_read_b64_tr_b16 a[232:233], v24 offset:8192
    ds_read_b64_tr_b16 a[234:235], v24 offset:8704
    ds_read_b64_tr_b16 a[236:237], v24 offset:12288
    ds_read_b64_tr_b16 a[238:239], v24 offset:12800
    s_waitcnt vmcnt(28) lgkmcnt(0)
    s_barrier
    s_add_u32 m0, s98, 81920
    s_add_u32 s56, s71, 82176
    buffer_load_dwordx4 v21, s[80:83], s56 offen lds
    s_add_u32 m0, s98, 82944
    s_add_u32 s56, s71, 87296
    buffer_load_dwordx4 v21, s[80:83], s56 offen lds
    s_add_u32 m0, s98, 83968
    s_add_u32 s56, s71, 92416
    buffer_load_dwordx4 v21, s[80:83], s56 offen lds
    s_add_u32 m0, s98, 84992
    s_add_u32 s56, s71, 97536
    buffer_load_dwordx4 v21, s[80:83], s56 offen lds
    v_add_u32 v24, 98304, v22
    ds_read_b64_tr_b16 a[240:241], v24 offset:0
    ds_read_b64_tr_b16 a[242:243], v24 offset:512
    ds_read_b64_tr_b16 a[244:245], v24 offset:4096
    ds_read_b64_tr_b16 a[246:247], v24 offset:4608
    ds_read_b64_tr_b16 a[248:249], v24 offset:8192
    ds_read_b64_tr_b16 a[250:251], v24 offset:8704
    ds_read_b64_tr_b16 a[252:253], v24 offset:12288
    ds_read_b64_tr_b16 a[254:255], v24 offset:12800
    s_waitcnt vmcnt(28) lgkmcnt(0)
    s_barrier
    s_add_u32 m0, s98, 98304
    s_add_u32 s56, s71, 512
    buffer_load_dwordx4 v21, s[80:83], s56 offen lds
    s_add_u32 m0, s98, 99328
    s_add_u32 s56, s71, 5632
    buffer_load_dwordx4 v21, s[80:83], s56 offen lds
    s_add_u32 m0, s98, 100352
    s_add_u32 s56, s71, 10752
    buffer_load_dwordx4 v21, s[80:83], s56 offen lds
    s_add_u32 m0, s98, 101376
    s_add_u32 s56, s71, 15872
    buffer_load_dwordx4 v21, s[80:83], s56 offen lds
    v_add_u32 v24, 114688, v22
    ds_read_b64_tr_b16 v[192:193], v24 offset:0
    ds_read_b64_tr_b16 v[194:195], v24 offset:512
    ds_read_b64_tr_b16 v[196:197], v24 offset:4096
    ds_read_b64_tr_b16 v[198:199], v24 offset:4608
    ds_read_b64_tr_b16 v[200:201], v24 offset:8192
    ds_read_b64_tr_b16 v[202:203], v24 offset:8704
    ds_read_b64_tr_b16 v[204:205], v24 offset:12288
    ds_read_b64_tr_b16 v[206:207], v24 offset:12800
    s_waitcnt vmcnt(28) lgkmcnt(0)
    s_barrier
    s_add_u32 m0, s98, 114688
    s_add_u32 s56, s71, 82432
    buffer_load_dwordx4 v21, s[80:83], s56 offen lds
    s_add_u32 m0, s98, 115712
    s_add_u32 s56, s71, 87552
    buffer_load_dwordx4 v21, s[80:83], s56 offen lds
    s_add_u32 m0, s98, 116736
    s_add_u32 s56, s71, 92672
    buffer_load_dwordx4 v21, s[80:83], s56 offen lds
    s_add_u32 m0, s98, 117760
    s_add_u32 s56, s71, 97792
    buffer_load_dwordx4 v21, s[80:83], s56 offen lds
    v_add_u32 v24, 131072, v22
    ds_read_b64_tr_b16 v[208:209], v24 offset:0
    ds_read_b64_tr_b16 v[210:211], v24 offset:512
    ds_read_b64_tr_b16 v[212:213], v24 offset:4096
    ds_read_b64_tr_b16 v[214:215], v24 offset:4608
    ds_read_b64_tr_b16 v[216:217], v24 offset:8192
    ds_read_b64_tr_b16 v[218:219], v24 offset:8704
    ds_read_b64_tr_b16 v[220:221], v24 offset:12288
    ds_read_b64_tr_b16 v[222:223], v24 offset:12800
    s_waitcnt vmcnt(28) lgkmcnt(0)
    s_barrier
    s_add_u32 m0, s98, 131072
    s_add_u32 s56, s71, 768
    buffer_load_dwordx4 v21, s[80:83], s56 offen lds
    s_add_u32 m0, s98, 132096
    s_add_u32 s56, s71, 5888
    buffer_load_dwordx4 v21, s[80:83], s56 offen lds
    s_add_u32 m0, s98, 133120
    s_add_u32 s56, s71, 11008
    buffer_load_dwordx4 v21, s[80:83], s56 offen lds
    s_add_u32 m0, s98, 134144
    s_add_u32 s56, s71, 16128
    buffer_load_dwordx4 v21, s[80:83], s56 offen lds
    v_add_u32 v24, 0, v22
    ds_read_b64_tr_b16 v[224:225], v24 offset:0
    ds_read_b64_tr_b16 v[226:227], v24 offset:512
    ds_read_b64_tr_b16 v[228:229], v24 offset:4096
    ds_read_b64_tr_b16 v[230:231], v24 offset:4608
    ds_read_b64_tr_b16 v[232:233], v24 offset:8192
    ds_read_b64_tr_b16 v[234:235], v24 offset:8704
    ds_read_b64_tr_b16 v[236:237], v24 offset:12288
    ds_read_b64_tr_b16 v[238:239], v24 offset:12800
    s_waitcnt vmcnt(28) lgkmcnt(0)
    s_barrier
    s_add_u32 m0, s98, 0
    s_add_u32 s56, s71, 82688
    buffer_load_dwordx4 v21, s[80:83], s56 offen lds
    s_add_u32 m0, s98, 1024
    s_add_u32 s56, s71, 87808
    buffer_load_dwordx4 v21, s[80:83], s56 offen lds
    s_add_u32 m0, s98, 2048
    s_add_u32 s56, s71, 92928
    buffer_load_dwordx4 v21, s[80:83], s56 offen lds
    s_add_u32 m0, s98, 3072
    s_add_u32 s56, s71, 98048
    buffer_load_dwordx4 v21, s[80:83], s56 offen lds
    v_add_u32 v24, 16384, v22
    ds_read_b64_tr_b16 v[240:241], v24 offset:0
    ds_read_b64_tr_b16 v[242:243], v24 offset:512
    ds_read_b64_tr_b16 v[244:245], v24 offset:4096
    ds_read_b64_tr_b16 v[246:247], v24 offset:4608
    ds_read_b64_tr_b16 v[248:249], v24 offset:8192
    ds_read_b64_tr_b16 v[250:251], v24 offset:8704
    ds_read_b64_tr_b16 v[252:253], v24 offset:12288
    ds_read_b64_tr_b16 v[254:255], v24 offset:12800
    s_waitcnt vmcnt(28) lgkmcnt(0)
    s_barrier
    s_add_u32 m0, s98, 16384
    s_add_u32 s56, s71, 1024
    buffer_load_dwordx4 v21, s[80:83], s56 offen lds
    s_add_u32 m0, s98, 17408
    s_add_u32 s56, s71, 6144
    buffer_load_dwordx4 v21, s[80:83], s56 offen lds
    s_add_u32 m0, s98, 18432
    s_add_u32 s56, s71, 11264
    buffer_load_dwordx4 v21, s[80:83], s56 offen lds
    s_add_u32 m0, s98, 19456
    s_add_u32 s56, s71, 16384
    buffer_load_dwordx4 v21, s[80:83], s56 offen lds
    v_add_u32 v25, 32768, v23
    s_cmp_lg_u32 s53, 0
    s_cbranch_scc1 .won_84
    ds_read_b64_tr_b16 v[128:129], v25 offset:0
    ds_read_b64_tr_b16 v[130:131], v25 offset:512
    ds_read_b64_tr_b16 v[132:133], v25 offset:2048
    ds_read_b64_tr_b16 v[134:135], v25 offset:2560
    ds_read_b64_tr_b16 v[136:137], v25 offset:8192
    ds_read_b64_tr_b16 v[138:139], v25 offset:8704
    ds_read_b64_tr_b16 v[140:141], v25 offset:10240
    ds_read_b64_tr_b16 v[142:143], v25 offset:10752
    ds_read_b64_tr_b16 v[160:161], v25 offset:64
    ds_read_b64_tr_b16 v[162:163], v25 offset:576
    ds_read_b64_tr_b16 v[164:165], v25 offset:2112
    ds_read_b64_tr_b16 v[166:167], v25 offset:2624
    ds_read_b64_tr_b16 v[168:169], v25 offset:8256
    ds_read_b64_tr_b16 v[170:171], v25 offset:8768
    ds_read_b64_tr_b16 v[172:173], v25 offset:10304
    ds_read_b64_tr_b16 v[174:175], v25 offset:10816
    ds_read_b64_tr_b16 v[32:33], v25 offset:128
    ds_read_b64_tr_b16 v[34:35], v25 offset:640
    ds_read_b64_tr_b16 v[36:37], v25 offset:2176
    ds_read_b64_tr_b16 v[38:39], v25 offset:2688
    ds_read_b64_tr_b16 v[40:41], v25 offset:8320
    ds_read_b64_tr_b16 v[42:43], v25 offset:8832
    ds_read_b64_tr_b16 v[44:45], v25 offset:10368
    ds_read_b64_tr_b16 v[46:47], v25 offset:10880
    ds_read_b64_tr_b16 v[64:65], v25 offset:192
    ds_read_b64_tr_b16 v[66:67], v25 offset:704
    ds_read_b64_tr_b16 v[68:69], v25 offset:2240
    ds_read_b64_tr_b16 v[70:71], v25 offset:2752
    ds_read_b64_tr_b16 v[72:73], v25 offset:8384
    ds_read_b64_tr_b16 v[74:75], v25 offset:8896
    ds_read_b64_tr_b16 v[76:77], v25 offset:10432
    ds_read_b64_tr_b16 v[78:79], v25 offset:10944
    s_branch .wo_83
.won_84:
.wo_83:
    s_waitcnt vmcnt(28) lgkmcnt(0)
    s_barrier
    s_add_u32 m0, s98, 32768
    s_add_u32 s56, s71, 82944
    buffer_load_dwordx4 v21, s[80:83], s56 offen lds
    s_add_u32 m0, s98, 33792
    s_add_u32 s56, s71, 88064
    buffer_load_dwordx4 v21, s[80:83], s56 offen lds
    s_add_u32 m0, s98, 34816
    s_add_u32 s56, s71, 93184
    buffer_load_dwordx4 v21, s[80:83], s56 offen lds
    s_add_u32 m0, s98, 35840
    s_add_u32 s56, s71, 98304
    buffer_load_dwordx4 v21, s[80:83], s56 offen lds
    v_add_u32 v25, 49152, v23
    s_cmp_lg_u32 s53, 0
    s_cbranch_scc1 .won_86
    ds_read_b64_tr_b16 v[144:145], v25 offset:0
    ds_read_b64_tr_b16 v[146:147], v25 offset:512
    ds_read_b64_tr_b16 v[148:149], v25 offset:2048
    ds_read_b64_tr_b16 v[150:151], v25 offset:2560
    ds_read_b64_tr_b16 v[152:153], v25 offset:8192
    ds_read_b64_tr_b16 v[154:155], v25 offset:8704
    ds_read_b64_tr_b16 v[156:157], v25 offset:10240
    ds_read_b64_tr_b16 v[158:159], v25 offset:10752
    ds_read_b64_tr_b16 v[176:177], v25 offset:64
    ds_read_b64_tr_b16 v[178:179], v25 offset:576
    ds_read_b64_tr_b16 v[180:181], v25 offset:2112
    ds_read_b64_tr_b16 v[182:183], v25 offset:2624
    ds_read_b64_tr_b16 v[184:185], v25 offset:8256
    ds_read_b64_tr_b16 v[186:187], v25 offset:8768
    ds_read_b64_tr_b16 v[188:189], v25 offset:10304
    ds_read_b64_tr_b16 v[190:191], v25 offset:10816
    ds_read_b64_tr_b16 v[48:49], v25 offset:128
    ds_read_b64_tr_b16 v[50:51], v25 offset:640
    ds_read_b64_tr_b16 v[52:53], v25 offset:2176
    ds_read_b64_tr_b16 v[54:55], v25 offset:2688
    ds_read_b64_tr_b16 v[56:57], v25 offset:8320
    ds_read_b64_tr_b16 v[58:59], v25 offset:8832
    ds_read_b64_tr_b16 v[60:61], v25 offset:10368
    ds_read_b64_tr_b16 v[62:63], v25 offset:10880
    ds_read_b64_tr_b16 v[80:81], v25 offset:192
    ds_read_b64_tr_b16 v[82:83], v25 offset:704
    ds_read_b64_tr_b16 v[84:85], v25 offset:2240
    ds_read_b64_tr_b16 v[86:87], v25 offset:2752
    ds_read_b64_tr_b16 v[88:89], v25 offset:8384
    ds_read_b64_tr_b16 v[90:91], v25 offset:8896
    ds_read_b64_tr_b16 v[92:93], v25 offset:10432
    ds_read_b64_tr_b16 v[94:95], v25 offset:10944
    s_branch .wo_85
.won_86:
.wo_85:
    s_waitcnt vmcnt(28) lgkmcnt(0)
    s_barrier
    v_add_u32 v25, 65536, v23
    s_cmp_lg_u32 s53, 0
    s_cbranch_scc1 .won_88
    ds_read_b64_tr_b16 v[96:97], v25 offset:0
    ds_read_b64_tr_b16 v[98:99], v25 offset:512
    ds_read_b64_tr_b16 v[100:101], v25 offset:2048
    ds_read_b64_tr_b16 v[102:103], v25 offset:2560
    ds_read_b64_tr_b16 v[104:105], v25 offset:8192
    ds_read_b64_tr_b16 v[106:107], v25 offset:8704
    ds_read_b64_tr_b16 v[108:109], v25 offset:10240
    ds_read_b64_tr_b16 v[110:111], v25 offset:10752
    s_branch .wo_87
.won_88:
    s_cmp_lg_u32 s53, 1
    s_cbranch_scc1 .won_89
    ds_read_b64_tr_b16 v[128:129], v25 offset:64
    ds_read_b64_tr_b16 v[130:131], v25 offset:576
    ds_read_b64_tr_b16 v[132:133], v25 offset:2112
    ds_read_b64_tr_b16 v[134:135], v25 offset:2624
    ds_read_b64_tr_b16 v[136:137], v25 offset:8256
    ds_read_b64_tr_b16 v[138:139], v25 offset:8768
    ds_read_b64_tr_b16 v[140:141], v25 offset:10304
    ds_read_b64_tr_b16 v[142:143], v25 offset:10816
    ds_read_b64_tr_b16 v[160:161], v25 offset:128
    ds_read_b64_tr_b16 v[162:163], v25 offset:640
    ds_read_b64_tr_b16 v[164:165], v25 offset:2176
    ds_read_b64_tr_b16 v[166:167], v25 offset:2688
    ds_read_b64_tr_b16 v[168:169], v25 offset:8320
    ds_read_b64_tr_b16 v[170:171], v25 offset:8832
    ds_read_b64_tr_b16 v[172:173], v25 offset:10368
    ds_read_b64_tr_b16 v[174:175], v25 offset:10880
    ds_read_b64_tr_b16 v[32:33], v25 offset:192
    ds_read_b64_tr_b16 v[34:35], v25 offset:704
    ds_read_b64_tr_b16 v[36:37], v25 offset:2240
    ds_read_b64_tr_b16 v[38:39], v25 offset:2752
    ds_read_b64_tr_b16 v[40:41], v25 offset:8384
    ds_read_b64_tr_b16 v[42:43], v25 offset:8896
    ds_read_b64_tr_b16 v[44:45], v25 offset:10432
    ds_read_b64_tr_b16 v[46:47], v25 offset:10944
    s_branch .wo_87
.won_89:
.wo_87:
    s_waitcnt vmcnt(24) lgkmcnt(0)
    s_barrier
    v_add_u32 v25, 81920, v23
    s_cmp_lg_u32 s53, 0
    s_cbranch_scc1 .won_91
    ds_read_b64_tr_b16 v[112:113], v25 offset:0
    ds_read_b64_tr_b16 v[114:115], v25 offset:512
    ds_read_b64_tr_b16 v[116:117], v25 offset:2048
    ds_read_b64_tr_b16 v[118:119], v25 offset:2560
    ds_read_b64_tr_b16 v[120:121], v25 offset:8192
    ds_read_b64_tr_b16 v[122:123], v25 offset:8704
    ds_read_b64_tr_b16 v[124:125], v25 offset:10240
    ds_read_b64_tr_b16 v[126:127], v25 offset:10752
    s_branch .wo_90
.won_91:
    s_cmp_lg_u32 s53, 1
    s_cbranch_scc1 .won_92
    ds_read_b64_tr_b16 v[144:145], v25 offset:64
    ds_read_b64_tr_b16 v[146:147], v25 offset:576
    ds_read_b64_tr_b16 v[148:149], v25 offset:2112
    ds_read_b64_tr_b16 v[150:151], v25 offset:2624
    ds_read_b64_tr_b16 v[152:153], v25 offset:8256
    ds_read_b64_tr_b16 v[154:155], v25 offset:8768
    ds_read_b64_tr_b16 v[156:157], v25 offset:10304
    ds_read_b64_tr_b16 v[158:159], v25 offset:10816
    ds_read_b64_tr_b16 v[176:177], v25 offset:128
    ds_read_b64_tr_b16 v[178:179], v25 offset:640
    ds_read_b64_tr_b16 v[180:181], v25 offset:2176
    ds_read_b64_tr_b16 v[182:183], v25 offset:2688
    ds_read_b64_tr_b16 v[184:185], v25 offset:8320
    ds_read_b64_tr_b16 v[186:187], v25 offset:8832
    ds_read_b64_tr_b16 v[188:189], v25 offset:10368
    ds_read_b64_tr_b16 v[190:191], v25 offset:10880
    ds_read_b64_tr_b16 v[48:49], v25 offset:192
    ds_read_b64_tr_b16 v[50:51], v25 offset:704
    ds_read_b64_tr_b16 v[52:53], v25 offset:2240
    ds_read_b64_tr_b16 v[54:55], v25 offset:2752
    ds_read_b64_tr_b16 v[56:57], v25 offset:8384
    ds_read_b64_tr_b16 v[58:59], v25 offset:8896
    ds_read_b64_tr_b16 v[60:61], v25 offset:10432
    ds_read_b64_tr_b16 v[62:63], v25 offset:10944
    s_branch .wo_90
.won_92:
.wo_90:
    s_waitcnt vmcnt(20) lgkmcnt(0)
    s_barrier
    v_add_u32 v25, 98304, v23
    s_cmp_lg_u32 s53, 1
    s_cbranch_scc1 .won_94
    ds_read_b64_tr_b16 v[64:65], v25 offset:0
    ds_read_b64_tr_b16 v[66:67], v25 offset:512
    ds_read_b64_tr_b16 v[68:69], v25 offset:2048
    ds_read_b64_tr_b16 v[70:71], v25 offset:2560
    ds_read_b64_tr_b16 v[72:73], v25 offset:8192
    ds_read_b64_tr_b16 v[74:75], v25 offset:8704
    ds_read_b64_tr_b16 v[76:77], v25 offset:10240
    ds_read_b64_tr_b16 v[78:79], v25 offset:10752
    ds_read_b64_tr_b16 v[96:97], v25 offset:64
    ds_read_b64_tr_b16 v[98:99], v25 offset:576
    ds_read_b64_tr_b16 v[100:101], v25 offset:2112
    ds_read_b64_tr_b16 v[102:103], v25 offset:2624
    ds_read_b64_tr_b16 v[104:105], v25 offset:8256
    ds_read_b64_tr_b16 v[106:107], v25 offset:8768
    ds_read_b64_tr_b16 v[108:109], v25 offset:10304
    ds_read_b64_tr_b16 v[110:111], v25 offset:10816
    s_branch .wo_93
.won_94:
    s_cmp_lg_u32 s53, 2
    s_cbranch_scc1 .won_95
    ds_read_b64_tr_b16 v[128:129], v25 offset:128
    ds_read_b64_tr_b16 v[130:131], v25 offset:640
    ds_read_b64_tr_b16 v[132:133], v25 offset:2176
    ds_read_b64_tr_b16 v[134:135], v25 offset:2688
    ds_read_b64_tr_b16 v[136:137], v25 offset:8320
    ds_read_b64_tr_b16 v[138:139], v25 offset:8832
    ds_read_b64_tr_b16 v[140:141], v25 offset:10368
    ds_read_b64_tr_b16 v[142:143], v25 offset:10880
    ds_read_b64_tr_b16 v[160:161], v25 offset:192
    ds_read_b64_tr_b16 v[162:163], v25 offset:704
    ds_read_b64_tr_b16 v[164:165], v25 offset:2240
    ds_read_b64_tr_b16 v[166:167], v25 offset:2752
    ds_read_b64_tr_b16 v[168:169], v25 offset:8384
    ds_read_b64_tr_b16 v[170:171], v25 offset:8896
    ds_read_b64_tr_b16 v[172:173], v25 offset:10432
    ds_read_b64_tr_b16 v[174:175], v25 offset:10944
    s_branch .wo_93
.won_95:
.wo_93:
    s_waitcnt vmcnt(16) lgkmcnt(0)
    s_barrier
    v_add_u32 v25, 114688, v23
    s_cmp_lg_u32 s53, 1
    s_cbranch_scc1 .won_97
    ds_read_b64_tr_b16 v[80:81], v25 offset:0
    ds_read_b64_tr_b16 v[82:83], v25 offset:512
    ds_read_b64_tr_b16 v[84:85], v25 offset:2048
    ds_read_b64_tr_b16 v[86:87], v25 offset:2560
    ds_read_b64_tr_b16 v[88:89], v25 offset:8192
    ds_read_b64_tr_b16 v[90:91], v25 offset:8704
    ds_read_b64_tr_b16 v[92:93], v25 offset:10240
    ds_read_b64_tr_b16 v[94:95], v25 offset:10752
    ds_read_b64_tr_b16 v[112:113], v25 offset:64
    ds_read_b64_tr_b16 v[114:115], v25 offset:576
    ds_read_b64_tr_b16 v[116:117], v25 offset:2112
    ds_read_b64_tr_b16 v[118:119], v25 offset:2624
    ds_read_b64_tr_b16 v[120:121], v25 offset:8256
    ds_read_b64_tr_b16 v[122:123], v25 offset:8768
    ds_read_b64_tr_b16 v[124:125], v25 offset:10304
    ds_read_b64_tr_b16 v[126:127], v25 offset:10816
    s_branch .wo_96
.won_97:
    s_cmp_lg_u32 s53, 2
    s_cbranch_scc1 .won_98
    ds_read_b64_tr_b16 v[144:145], v25 offset:128
    ds_read_b64_tr_b16 v[146:147], v25 offset:640
    ds_read_b64_tr_b16 v[148:149], v25 offset:2176
    ds_read_b64_tr_b16 v[150:151], v25 offset:2688
    ds_read_b64_tr_b16 v[152:153], v25 offset:8320
    ds_read_b64_tr_b16 v[154:155], v25 offset:8832
    ds_read_b64_tr_b16 v[156:157], v25 offset:10368
    ds_read_b64_tr_b16 v[158:159], v25 offset:10880
    ds_read_b64_tr_b16 v[176:177], v25 offset:192
    ds_read_b64_tr_b16 v[178:179], v25 offset:704
    ds_read_b64_tr_b16 v[180:181], v25 offset:2240
    ds_read_b64_tr_b16 v[182:183], v25 offset:2752
    ds_read_b64_tr_b16 v[184:185], v25 offset:8384
    ds_read_b64_tr_b16 v[186:187], v25 offset:8896
    ds_read_b64_tr_b16 v[188:189], v25 offset:10432
    ds_read_b64_tr_b16 v[190:191], v25 offset:10944
    s_branch .wo_96
.won_98:
.wo_96:
    s_waitcnt vmcnt(12) lgkmcnt(0)
    s_barrier
    v_add_u32 v25, 131072, v23
    s_cmp_lg_u32 s53, 2
    s_cbranch_scc1 .won_100
    ds_read_b64_tr_b16 v[32:33], v25 offset:0
    ds_read_b64_tr_b16 v[34:35], v25 offset:512
    ds_read_b64_tr_b16 v[36:37], v25 offset:2048
    ds_read_b64_tr_b16 v[38:39], v25 offset:2560
    ds_read_b64_tr_b16 v[40:41], v25 offset:8192
    ds_read_b64_tr_b16 v[42:43], v25 offset:8704
    ds_read_b64_tr_b16 v[44:45], v25 offset:10240
    ds_read_b64_tr_b16 v[46:47], v25 offset:10752
    ds_read_b64_tr_b16 v[64:65], v25 offset:64
    ds_read_b64_tr_b16 v[66:67], v25 offset:576
    ds_read_b64_tr_b16 v[68:69], v25 offset:2112
    ds_read_b64_tr_b16 v[70:71], v25 offset:2624
    ds_read_b64_tr_b16 v[72:73], v25 offset:8256
    ds_read_b64_tr_b16 v[74:75], v25 offset:8768
    ds_read_b64_tr_b16 v[76:77], v25 offset:10304
    ds_read_b64_tr_b16 v[78:79], v25 offset:10816
    ds_read_b64_tr_b16 v[96:97], v25 offset:128
    ds_read_b64_tr_b16 v[98:99], v25 offset:640
    ds_read_b64_tr_b16 v[100:101], v25 offset:2176
    ds_read_b64_tr_b16 v[102:103], v25 offset:2688
    ds_read_b64_tr_b16 v[104:105], v25 offset:8320
    ds_read_b64_tr_b16 v[106:107], v25 offset:8832
    ds_read_b64_tr_b16 v[108:109], v25 offset:10368
    ds_read_b64_tr_b16 v[110:111], v25 offset:10880
    s_branch .wo_99
.won_100:
    s_cmp_lg_u32 s53, 3
    s_cbranch_scc1 .won_101
    ds_read_b64_tr_b16 v[128:129], v25 offset:192
    ds_read_b64_tr_b16 v[130:131], v25 offset:704
    ds_read_b64_tr_b16 v[132:133], v25 offset:2240
    ds_read_b64_tr_b16 v[134:135], v25 offset:2752
    ds_read_b64_tr_b16 v[136:137], v25 offset:8384
    ds_read_b64_tr_b16 v[138:139], v25 offset:8896
    ds_read_b64_tr_b16 v[140:141], v25 offset:10432
    ds_read_b64_tr_b16 v[142:143], v25 offset:10944
    s_branch .wo_99
.won_101:
.wo_99:
    s_waitcnt vmcnt(8) lgkmcnt(0)
    s_barrier
    v_add_u32 v25, 0, v23
    s_cmp_lg_u32 s53, 2
    s_cbranch_scc1 .won_103
    ds_read_b64_tr_b16 v[48:49], v25 offset:0
    ds_read_b64_tr_b16 v[50:51], v25 offset:512
    ds_read_b64_tr_b16 v[52:53], v25 offset:2048
    ds_read_b64_tr_b16 v[54:55], v25 offset:2560
    ds_read_b64_tr_b16 v[56:57], v25 offset:8192
    ds_read_b64_tr_b16 v[58:59], v25 offset:8704
    ds_read_b64_tr_b16 v[60:61], v25 offset:10240
    ds_read_b64_tr_b16 v[62:63], v25 offset:10752
    ds_read_b64_tr_b16 v[80:81], v25 offset:64
    ds_read_b64_tr_b16 v[82:83], v25 offset:576
    ds_read_b64_tr_b16 v[84:85], v25 offset:2112
    ds_read_b64_tr_b16 v[86:87], v25 offset:2624
    ds_read_b64_tr_b16 v[88:89], v25 offset:8256
    ds_read_b64_tr_b16 v[90:91], v25 offset:8768
    ds_read_b64_tr_b16 v[92:93], v25 offset:10304
    ds_read_b64_tr_b16 v[94:95], v25 offset:10816
    ds_read_b64_tr_b16 v[112:113], v25 offset:128
    ds_read_b64_tr_b16 v[114:115], v25 offset:640
    ds_read_b64_tr_b16 v[116:117], v25 offset:2176
    ds_read_b64_tr_b16 v[118:119], v25 offset:2688
    ds_read_b64_tr_b16 v[120:121], v25 offset:8320
    ds_read_b64_tr_b16 v[122:123], v25 offset:8832
    ds_read_b64_tr_b16 v[124:125], v25 offset:10368
    ds_read_b64_tr_b16 v[126:127], v25 offset:10880
    s_branch .wo_102
.won_103:
    s_cmp_lg_u32 s53, 3
    s_cbranch_scc1 .won_104
    ds_read_b64_tr_b16 v[144:145], v25 offset:192
    ds_read_b64_tr_b16 v[146:147], v25 offset:704
    ds_read_b64_tr_b16 v[148:149], v25 offset:2240
    ds_read_b64_tr_b16 v[150:151], v25 offset:2752
    ds_read_b64_tr_b16 v[152:153], v25 offset:8384
    ds_read_b64_tr_b16 v[154:155], v25 offset:8896
    ds_read_b64_tr_b16 v[156:157], v25 offset:10432
    ds_read_b64_tr_b16 v[158:159], v25 offset:10944
    s_branch .wo_102
.won_104:
.wo_102:
    s_waitcnt vmcnt(4) lgkmcnt(0)
    s_barrier
    v_add_u32 v25, 16384, v23
    s_cmp_lg_u32 s53, 3
    s_cbranch_scc1 .won_106
    ds_read_b64_tr_b16 v[160:161], v25 offset:0
    ds_read_b64_tr_b16 v[162:163], v25 offset:512
    ds_read_b64_tr_b16 v[164:165], v25 offset:2048
    ds_read_b64_tr_b16 v[166:167], v25 offset:2560
    ds_read_b64_tr_b16 v[168:169], v25 offset:8192
    ds_read_b64_tr_b16 v[170:171], v25 offset:8704
    ds_read_b64_tr_b16 v[172:173], v25 offset:10240
    ds_read_b64_tr_b16 v[174:175], v25 offset:10752
    ds_read_b64_tr_b16 v[32:33], v25 offset:64
    ds_read_b64_tr_b16 v[34:35], v25 offset:576
    ds_read_b64_tr_b16 v[36:37], v25 offset:2112
    ds_read_b64_tr_b16 v[38:39], v25 offset:2624
    ds_read_b64_tr_b16 v[40:41], v25 offset:8256
    ds_read_b64_tr_b16 v[42:43], v25 offset:8768
    ds_read_b64_tr_b16 v[44:45], v25 offset:10304
    ds_read_b64_tr_b16 v[46:47], v25 offset:10816
    ds_read_b64_tr_b16 v[64:65], v25 offset:128
    ds_read_b64_tr_b16 v[66:67], v25 offset:640
    ds_read_b64_tr_b16 v[68:69], v25 offset:2176
    ds_read_b64_tr_b16 v[70:71], v25 offset:2688
    ds_read_b64_tr_b16 v[72:73], v25 offset:8320
    ds_read_b64_tr_b16 v[74:75], v25 offset:8832
    ds_read_b64_tr_b16 v[76:77], v25 offset:10368
    ds_read_b64_tr_b16 v[78:79], v25 offset:10880
    ds_read_b64_tr_b16 v[96:97], v25 offset:192
    ds_read_b64_tr_b16 v[98:99], v25 offset:704
    ds_read_b64_tr_b16 v[100:101], v25 offset:2240
    ds_read_b64_tr_b16 v[102:103], v25 offset:2752
    ds_read_b64_tr_b16 v[104:105], v25 offset:8384
    ds_read_b64_tr_b16 v[106:107], v25 offset:8896
    ds_read_b64_tr_b16 v[108:109], v25 offset:10432
    ds_read_b64_tr_b16 v[110:111], v25 offset:10944
    s_branch .wo_105
.won_106:
.wo_105:
    s_waitcnt vmcnt(0) lgkmcnt(0)
    s_barrier
    v_add_u32 v25, 32768, v23
    s_cmp_lg_u32 s53, 3
    s_cbranch_scc1 .won_108
    ds_read_b64_tr_b16 v[176:177], v25 offset:0
    ds_read_b64_tr_b16 v[178:179], v25 offset:512
    ds_read_b64_tr_b16 v[180:181], v25 offset:2048
    ds_read_b64_tr_b16 v[182:183], v25 offset:2560
    ds_read_b64_tr_b16 v[184:185], v25 offset:8192
    ds_read_b64_tr_b16 v[186:187], v25 offset:8704
    ds_read_b64_tr_b16 v[188:189], v25 offset:10240
    ds_read_b64_tr_b16 v[190:191], v25 offset:10752
    ds_read_b64_tr_b16 v[48:49], v25 offset:64
    ds_read_b64_tr_b16 v[50:51], v25 offset:576
    ds_read_b64_tr_b16 v[52:53], v25 offset:2112
    ds_read_b64_tr_b16 v[54:55], v25 offset:2624
    ds_read_b64_tr_b16 v[56:57], v25 offset:8256
    ds_read_b64_tr_b16 v[58:59], v25 offset:8768
    ds_read_b64_tr_b16 v[60:61], v25 offset:10304
    ds_read_b64_tr_b16 v[62:63], v25 offset:10816
    ds_read_b64_tr_b16 v[80:81], v25 offset:128
    ds_read_b64_tr_b16 v[82:83], v25 offset:640
    ds_read_b64_tr_b16 v[84:85], v25 offset:2176
    ds_read_b64_tr_b16 v[86:87], v25 offset:2688
    ds_read_b64_tr_b16 v[88:89], v25 offset:8320
    ds_read_b64_tr_b16 v[90:91], v25 offset:8832
    ds_read_b64_tr_b16 v[92:93], v25 offset:10368
    ds_read_b64_tr_b16 v[94:95], v25 offset:10880
    ds_read_b64_tr_b16 v[112:113], v25 offset:192
    ds_read_b64_tr_b16 v[114:115], v25 offset:704
    ds_read_b64_tr_b16 v[116:117], v25 offset:2240
    ds_read_b64_tr_b16 v[118:119], v25 offset:2752
    ds_read_b64_tr_b16 v[120:121], v25 offset:8384
    ds_read_b64_tr_b16 v[122:123], v25 offset:8896
    ds_read_b64_tr_b16 v[124:125], v25 offset:10432
    ds_read_b64_tr_b16 v[126:127], v25 offset:10944
    s_branch .wo_107
.won_108:
.wo_107:
    s_waitcnt lgkmcnt(0)
    s_barrier
    ds_write_b128 v17, v[32:35] offset:0
    ds_write_b128 v17, v[36:39] offset:1024
    ds_write_b128 v17, v[40:43] offset:2048
    ds_write_b128 v17, v[44:47] offset:3072
    ds_write_b128 v17, v[48:51] offset:4096
    ds_write_b128 v17, v[52:55] offset:5120
    ds_write_b128 v17, v[56:59] offset:6144
    ds_write_b128 v17, v[60:63] offset:7168
    ds_write_b128 v17, v[64:67] offset:8192
    ds_write_b128 v17, v[68:71] offset:9216
    ds_write_b128 v17, v[72:75] offset:10240
    ds_write_b128 v17, v[76:79] offset:11264
    ds_write_b128 v17, v[80:83] offset:12288
    ds_write_b128 v17, v[84:87] offset:13312
    ds_write_b128 v17, v[88:91] offset:14336
    ds_write_b128 v17, v[92:95] offset:15360
    ds_write_b128 v17, v[96:99] offset:16384
    ds_write_b128 v17, v[100:103] offset:17408
    ds_write_b128 v17, v[104:107] offset:18432
    ds_write_b128 v17, v[108:111] offset:19456
    ds_write_b128 v17, v[112:115] offset:20480
    ds_write_b128 v17, v[116:119] offset:21504
    ds_write_b128 v17, v[120:123] offset:22528
    ds_write_b128 v17, v[124:127] offset:23552
    s_waitcnt lgkmcnt(0)
    v_mbcnt_lo_u32_b32 v2, -1, 0
    v_min_u32 v2, 31, v2
    v_lshlrev_b32 v2, 2, v2
    s_mov_b32 s57, 0
.sw_109:
    global_load_dword v3, v2, s[38:39] sc1
    s_waitcnt vmcnt(0)
    v_readlane_b32 s55, v3, 29
    v_readlane_b32 s56, v3, 0
    v_readlane_b32 s70, v3, 8
    v_readlane_b32 s71, v3, 2
    s_cmp_ge_u32 s55, 34
    s_cselect_b32 s55, 1, 0
    v_readlane_b32 s85, v3, 4
    s_nop 0
    s_cmp_lg_u32 s85, 0
    s_cselect_b32 s55, s55, 0
    s_cmp_ge_u32 s56, 32
    s_cselect_b32 s55, s55, 0
    s_cmp_ge_u32 s70, 64
    s_cselect_b32 s55, s55, 0
    s_cmp_eq_u32 s55, 1
    s_cbranch_scc1 .swo_110
    s_sleep 4
    s_add_u32 s57, s57, 1
    s_cmp_lt_u32 s57, 3000000
    s_cbranch_scc1 .sw_109
    s_branch .abort_1
.swo_110:
    s_and_b32 s85, s85, 3
    s_sub_u32 s85, s85, 1
    s_lshl_b32 s85, s85, 13
    s_cmp_eq_u32 s71, 0
    s_cselect_b32 s58, 1, 0
    s_mov_b32 s99, 7
    v_and_b32 v1, 63, v0
    v_mov_b32 v3, 0x4444
    v_mov_b32 v2, 0xeeee
    v_cndmask_b32 v3, v3, v2, s[60:61]
    v_lshlrev_b32 v4, 4, v1
    v_lshrrev_b32 v2, 5, v1
    v_lshlrev_b32 v2, 4, v2
    v_and_b32 v36, 15, v1
    v_add_u32 v2, v2, v36
    s_lshl_b32 s55, s53, 5
    v_add_u32 v2, s55, v2
    v_lshlrev_b32 v2, 4, v2
    v_bfe_u32 v36, v1, 4, 1
    v_lshl_add_u32 v2, v36, 3, v2
    v_add_u32 v5, 10240, v2
    v_lshrrev_b32 v2, 4, v1
    v_lshlrev_b32 v2, 3, v2
    v_bfe_u32 v36, v1, 2, 2
    v_add_u32 v2, v2, v36
    v_lshlrev_b32 v2, 4, v2
    v_and_b32 v36, 1, v1
    v_lshl_add_u32 v2, v36, 3, v2
    v_add_u32 v6, 10240, v2
    v_and_b32 v2, 15, v1
    v_lshrrev_b32 v36, 4, v1
    v_xor_b32 v36, v36, v2
    v_lshlrev_b32 v36, 4, v36
    v_lshl_add_u32 v7, v2, 8, v36
    v_add_u32 v7, 18432, v7
    v_lshrrev_b32 v2, 4, v1
    v_lshlrev_b32 v2, 2, v2
    v_bfe_u32 v36, v1, 2, 2
    v_add_u32 v2, v2, v36
    v_and_b32 v36, 7, v2
    v_lshlrev_b32 v36, 5, v36
    v_lshl_add_u32 v2, v2, 8, v36
    v_and_b32 v36, 3, v1
    v_lshl_add_u32 v8, v36, 3, v2
    v_add_u32 v8, 34816, v8
    v_lshrrev_b32 v2, 5, v1
    v_lshlrev_b32 v2, 4, v2
    v_and_b32 v36, 15, v1
    v_add_u32 v2, v2, v36
    v_lshlrev_b32 v2, 4, v2
    v_bfe_u32 v36, v1, 4, 1
    v_lshl_add_u32 v9, v36, 3, v2
    s_lshl_b32 s87, s53, 5
    s_add_u32 s87, s87, s52
    v_and_b32 v2, 7, v1
    v_lshlrev_b32 v2, 4, v2
    v_lshrrev_b32 v36, 4, v1
    v_lshl_add_u32 v2, v36, 7, v2
    v_bfe_u32 v36, v1, 3, 1
    v_lshl_add_u32 v2, v36, 11, v2
    s_lshl_b32 s55, s87, 12
    s_add_u32 s55, s55, 0x5ac0000
    v_add_u32 v10, s55, v2
    v_and_b32 v2, 7, v1
    v_lshlrev_b32 v2, 4, v2
    v_bfe_u32 v36, v1, 4, 1
    v_lshl_add_u32 v2, v36, 3, v2
    v_lshrrev_b32 v36, 5, v1
    v_lshl_add_u32 v2, v36, 2, v2
    s_lshl_b32 s55, s87, 7
    v_add_u32 v12, s55, v2
    s_lshl_b32 s55, s53, 7
    s_add_u32 s55, s55, 14336
    v_add_u32 v18, s55, v2
    s_cmp_lg_u32 s53, 3
    s_cbranch_scc1 .w3s_111
    v_lshlrev_b32 v2, 3, v1
    v_add_u32 v18, 14336, v2
    v_lshrrev_b32 v36, 4, v1
    v_lshlrev_b32 v36, 12, v36
    v_and_b32 v2, 127, v2
    v_add_u32 v2, v2, v36
    s_lshl_b32 s55, s52, 7
    v_add_u32 v12, s55, v2
    v_mov_b32 v36, -1
    v_mov_b32 v37, -1
    ds_write_b64 v18, v[36:37]
    ds_write_b64 v18, v[36:37] offset:1024
    s_waitcnt lgkmcnt(0)
.w3s_111:
    s_cmp_lt_u32 s52, 16
    s_cselect_b32 s55, 48, 32
    v_cmp_gt_u32 s[68:69], s55, v1
    v_and_b32 v2, 7, v1
    v_lshlrev_b32 v2, 4, v2
    s_lshr_b32 s55, s87, 6
    s_lshl_b32 s55, s55, 14
    s_and_b32 s56, s87, 63
    s_lshl_b32 s56, s56, 7
    s_add_u32 s55, s55, s56
    s_add_u32 s55, s55, s85
    v_add_u32 v18, s55, v2
    v_and_b32 v2, 15, v1
    v_and_b32 v36, 1, v2
    v_lshlrev_b32 v36, 4, v36
    v_mov_b32 v37, 0x3f80
    v_lshlrev_b32 v36, v36, v37
    v_lshrrev_b32 v2, 1, v2
    v_cmp_eq_u32 vcc, 0, v2
    s_nop 1
    v_cndmask_b32 v24, 0, v36, vcc
    v_cmp_eq_u32 vcc, 1, v2
    s_nop 1
    v_cndmask_b32 v25, 0, v36, vcc
    v_cmp_eq_u32 vcc, 2, v2
    s_nop 1
    v_cndmask_b32 v26, 0, v36, vcc
    v_cmp_eq_u32 vcc, 3, v2
    s_nop 1
    v_cndmask_b32 v27, 0, v36, vcc
    v_and_b32 v2, 15, v1
    v_lshlrev_b32 v2, 8, v2
    v_lshrrev_b32 v36, 4, v1
    v_lshl_add_u32 v2, v36, 4, v2
    s_lshl_b32 s55, s52, 11
    s_add_u32 s55, s55, 0x4000000
    v_add_u32 v13, s55, v2
    v_lshrrev_b32 v2, 4, v1
    v_and_b32 v36, 15, v1
    v_xor_b32 v37, v36, v2
    v_lshlrev_b32 v37, 4, v37
    v_lshl_add_u32 v14, v2, 13, v37
    v_lshlrev_b32 v37, 1, v2
    v_xor_b32 v37, v36, v37
    v_lshlrev_b32 v37, 4, v37
    v_lshl_add_u32 v15, v2, 13, v37
    v_lshrrev_b32 v2, 5, v1
    v_lshlrev_b32 v2, 1, v2
    v_bfe_u32 v36, v1, 3, 1
    v_add_u32 v2, v2, v36
    s_mul_i32 s55, s53, 20
    v_add_u32 v2, s55, v2
    v_lshlrev_b32 v2, 12, v2
    v_and_b32 v36, 7, v1
    v_lshl_add_u32 v2, v36, 4, v2
    v_bfe_u32 v36, v1, 4, 1
    v_lshl_add_u32 v2, v36, 3, v2
    s_lshl_b32 s55, s52, 7
    s_add_u32 s55, s55, 0x5ac0000
    v_add_u32 v19, s55, v2
    v_add_u32 v20, 16384, v19
    v_add_u32 v21, 32768, v19
    v_add_u32 v22, 49152, v19
    v_add_u32 v23, 65536, v19
    v_and_b32 v2, 7, v1
    v_lshlrev_b32 v2, 4, v2
    v_lshrrev_b32 v36, 4, v1
    v_lshl_add_u32 v11, v36, 7, v2
    s_lshl_b32 s55, s53, 9
    s_add_u32 s55, s55, 16384
    v_add_u32 v2, s55, v11
    s_lshl_b32 s55, s53, 6
    v_xor_b32 v8, s55, v8
    s_lshl_b32 s55, s53, 9
    v_add_u32 v9, s55, v9
    s_lshr_b32 s55, s52, 2
    s_lshl_b32 s55, s55, 14
    s_and_b32 s56, s52, 3
    s_lshl_b32 s56, s56, 11
    s_add_u32 s55, s55, s56
    s_add_u32 s55, s55, s85
    v_add_u32 v9, s55, v9
    s_lshl_b32 s55, s53, 1
    s_and_b32 s56, s55, 3
    s_lshl_b32 s56, s56, 6
    v_xor_b32 v14, s56, v14
    s_lshl_b32 s56, s55, 15
    s_lshl_b32 s70, s52, 8
    s_add_u32 s56, s56, s70
    v_add_u32 v14, s56, v14
    v_add_u32 v15, s56, v15
    v_xor_b32 v0, 64, v14
    v_add_u32 v0, 0x8000, v0
    v_xor_b32 v1, 128, v15
    v_add_u32 v1, 0x8000, v1
    s_lshl_b32 s98, s53, 11
    s_mov_b32 s54, 0
    s_cmp_lt_i32 s99, s54
    s_cbranch_scc0 .kvok_112
    v_mbcnt_lo_u32_b32 v36, -1, 0
    v_min_u32 v36, 7, v36
    v_lshlrev_b32 v36, 2, v36
    s_mov_b32 s57, 0
.kvl_113:
    global_load_dword v37, v36, s[38:39] offset:32 sc1
    s_waitcnt vmcnt(0)
    v_cmp_eq_u32 vcc, 0, v36
    v_lshrrev_b32 v38, 1, v37
    s_nop 0
    v_cndmask_b32 v37, v37, v38, vcc
    v_cmp_le_u32 vcc, 32, v37
    s_nop 0
    s_and_b32 s56, vcc_lo, 0xff
    s_ff0_i32_b32 s56, s56
    s_lshl_b32 s99, s56, 3
    s_sub_u32 s99, s99, 1
    s_cmp_lt_i32 s99, s54
    s_cbranch_scc0 .kvok_112
    s_sleep 4
    s_add_u32 s57, s57, 1
    s_cmp_lt_u32 s57, 3000000
    s_cbranch_scc1 .kvl_113
    s_branch .abort_1
.kvok_112:
    s_mov_b32 s55, 2
    s_cmp_lt_i32 s99, s55
    s_cbranch_scc0 .kvok_114
    v_mbcnt_lo_u32_b32 v36, -1, 0
    v_min_u32 v36, 7, v36
    v_lshlrev_b32 v36, 2, v36
    s_mov_b32 s57, 0
.kvl_115:
    global_load_dword v37, v36, s[38:39] offset:32 sc1
    s_waitcnt vmcnt(0)
    v_cmp_eq_u32 vcc, 0, v36
    v_lshrrev_b32 v38, 1, v37
    s_nop 0
    v_cndmask_b32 v37, v37, v38, vcc
    v_cmp_le_u32 vcc, 32, v37
    s_nop 0
    s_and_b32 s56, vcc_lo, 0xff
    s_ff0_i32_b32 s56, s56
    s_lshl_b32 s99, s56, 3
    s_sub_u32 s99, s99, 1
    s_cmp_lt_i32 s99, s55
    s_cbranch_scc0 .kvok_114
    s_sleep 4
    s_add_u32 s57, s57, 1
    s_cmp_lt_u32 s57, 3000000
    s_cbranch_scc1 .kvl_115
    s_branch .abort_1
.kvok_114:
    s_mov_b32 s59, 0
    s_lshl_b32 s70, s59, 18
    s_add_u32 s71, s70, 0x2000000
    s_add_u32 s70, s70, 0x1000000
    s_lshl_b32 s56, s59, 13
    s_add_u32 s56, s56, s98
    s_add_u32 m0, s56, 18432
    s_nop 0
    buffer_load_dwordx4 v14, s[44:47], s70 offen sc1 lds
    s_add_u32 m0, s56, 19456
    s_nop 0
    buffer_load_dwordx4 v0, s[44:47], s70 offen sc1 lds
    s_add_u32 m0, s56, 34816
    s_nop 0
    buffer_load_dwordx4 v15, s[44:47], s71 offen sc1 lds
    s_add_u32 m0, s56, 35840
    s_nop 0
    buffer_load_dwordx4 v1, s[44:47], s71 offen sc1 lds
    s_mov_b32 s59, 1
    s_lshl_b32 s70, s59, 18
    s_add_u32 s71, s70, 0x2000000
    s_add_u32 s70, s70, 0x1000000
    s_lshl_b32 s56, s59, 13
    s_add_u32 s56, s56, s98
    s_add_u32 m0, s56, 18432
    s_nop 0
    buffer_load_dwordx4 v14, s[44:47], s70 offen sc1 lds
    s_add_u32 m0, s56, 19456
    s_nop 0
    buffer_load_dwordx4 v0, s[44:47], s70 offen sc1 lds
    s_add_u32 m0, s56, 34816
    s_nop 0
    buffer_load_dwordx4 v15, s[44:47], s71 offen sc1 lds
    s_add_u32 m0, s56, 35840
    s_nop 0
    buffer_load_dwordx4 v1, s[44:47], s71 offen sc1 lds
    s_cmp_ge_u32 s87, 80
    s_cbranch_scc1 .f0_116
    s_mov_b64 exec, 0xff
    s_mov_b32 s55, 0x5a00000
    buffer_load_dwordx4 v[28:31], v12, s[44:47], s55 offen sc1
    s_waitcnt vmcnt(0)
    s_mov_b32 s55, 0x5aa0000
    buffer_store_dwordx4 v[28:31], v18, s[44:47], s55 offen sc1
    s_mov_b64 exec, -1
.f0_116:
    s_waitcnt vmcnt(0)
    s_barrier
    s_cmp_eq_u32 s58, 0
    s_cbranch_scc1 .hslow_117
.hstep_119:
    s_cmp_eq_u32 s54, 63
    s_cbranch_scc1 .hfin_118
    s_and_b32 s59, s54, 1
    s_lshl_b32 s55, s59, 13
    v_add_u32 v36, s55, v7
    v_xor_b32 v37, 0, v36
    ds_read_b128 v[80:83], v37
    ds_read_b128 v[96:99], v37 offset:4096
    v_xor_b32 v37, 64, v36
    ds_read_b128 v[84:87], v37
    ds_read_b128 v[100:103], v37 offset:4096
    v_xor_b32 v37, 128, v36
    ds_read_b128 v[88:91], v37
    ds_read_b128 v[104:107], v37 offset:4096
    v_xor_b32 v37, 192, v36
    ds_read_b128 v[92:95], v37
    ds_read_b128 v[108:111], v37 offset:4096
    v_add_u32 v36, s55, v8
    v_xor_b32 v37, 32, v36
    ds_read_b64_tr_b16 v[112:113], v36
    ds_read_b64_tr_b16 v[114:115], v36 offset:4096
    ds_read_b64_tr_b16 v[116:117], v37
    ds_read_b64_tr_b16 v[118:119], v37 offset:4096
    v_mov_b32 v64, 0
    v_mov_b32 v65, 0
    v_mov_b32 v66, 0
    v_mov_b32 v67, 0
    v_mov_b32 v68, 0
    v_mov_b32 v69, 0
    v_mov_b32 v70, 0
    v_mov_b32 v71, 0
    s_cmp_ge_u32 s53, 3
    s_cbranch_scc1 .nomp_120
    s_mul_i32 s56, s53, 7
    s_lshr_b32 s56, s56, 1
    s_lshl_b32 s56, s56, 10
    s_and_b32 s55, s54, 3
    s_mul_i32 s55, s55, 10240
    s_add_u32 s55, s55, s56
    s_add_u32 s55, s55, 0x5a00000
    s_mov_b32 s57, 0
    s_cmp_eq_u32 s53, 1
    s_cbranch_scc1 .m4_121
    buffer_load_dwordx4 v[72:75], v4, s[44:47], s55 offen offset:0 sc1
    buffer_load_dwordx4 v[76:79], v4, s[44:47], s55 offen offset:1024 sc1
    buffer_load_dwordx4 v[120:123], v4, s[44:47], s55 offen offset:2048 sc1
    s_waitcnt vmcnt(0)
    v_max3_u32 v36, v72, v73, v74
    v_max3_u32 v37, v75, v76, v77
    v_max3_u32 v36, v36, v78, v79
    v_max3_u32 v37, v37, v120, v121
    v_max3_u32 v36, v36, v122, v123
    v_max_u32 v36, v36, v37
    v_cmp_eq_u32 vcc, -1, v36
    s_nop 0
    s_cbranch_vccz .ok_123
    s_mov_b64 exec, vcc
    buffer_load_dwordx4 v[72:75], v4, s[44:47], s55 offen offset:0 sc1
    buffer_load_dwordx4 v[76:79], v4, s[44:47], s55 offen offset:1024 sc1
    buffer_load_dwordx4 v[120:123], v4, s[44:47], s55 offen offset:2048 sc1
.mp_124:
    buffer_load_dwordx4 v[72:75], v4, s[44:47], s55 offen offset:0 sc1
    buffer_load_dwordx4 v[76:79], v4, s[44:47], s55 offen offset:1024 sc1
    buffer_load_dwordx4 v[120:123], v4, s[44:47], s55 offen offset:2048 sc1
    s_mov_b64 exec, -1
    s_waitcnt vmcnt(3)
    v_max3_u32 v36, v72, v73, v74
    v_max3_u32 v37, v75, v76, v77
    v_max3_u32 v36, v36, v78, v79
    v_max3_u32 v37, v37, v120, v121
    v_max3_u32 v36, v36, v122, v123
    v_max_u32 v36, v36, v37
    v_cmp_eq_u32 vcc, -1, v36
    s_nop 0
    s_cbranch_vccz .ok_123
    s_mov_b64 exec, vcc
    s_add_u32 s57, s57, 1
    s_cmp_lt_u32 s57, 3000000
    s_cbranch_scc1 .mp_124
    s_branch .abort_1
.ok_123:
    v_add_u32 v37, s56, v4
    ds_write_b128 v37, v[72:75] offset:0
    ds_write_b128 v37, v[76:79] offset:1024
    ds_write_b128 v37, v[120:123] offset:2048
    s_branch .mj_122
.m4_121:
    buffer_load_dwordx4 v[72:75], v4, s[44:47], s55 offen offset:0 sc1
    buffer_load_dwordx4 v[76:79], v4, s[44:47], s55 offen offset:1024 sc1
    buffer_load_dwordx4 v[120:123], v4, s[44:47], s55 offen offset:2048 sc1
    buffer_load_dwordx4 v[124:127], v4, s[44:47], s55 offen offset:3072 sc1
    s_waitcnt vmcnt(0)
    v_max3_u32 v36, v72, v73, v74
    v_max3_u32 v37, v75, v76, v77
    v_max3_u32 v36, v36, v78, v79
    v_max3_u32 v37, v37, v120, v121
    v_max3_u32 v36, v36, v122, v123
    v_max3_u32 v37, v37, v124, v125
    v_max3_u32 v36, v36, v126, v127
    v_max_u32 v36, v36, v37
    v_cmp_eq_u32 vcc, -1, v36
    s_nop 0
    s_cbranch_vccz .ok_125
    s_mov_b64 exec, vcc
    buffer_load_dwordx4 v[72:75], v4, s[44:47], s55 offen offset:0 sc1
    buffer_load_dwordx4 v[76:79], v4, s[44:47], s55 offen offset:1024 sc1
    buffer_load_dwordx4 v[120:123], v4, s[44:47], s55 offen offset:2048 sc1
    buffer_load_dwordx4 v[124:127], v4, s[44:47], s55 offen offset:3072 sc1
.mp_126:
    buffer_load_dwordx4 v[72:75], v4, s[44:47], s55 offen offset:0 sc1
    buffer_load_dwordx4 v[76:79], v4, s[44:47], s55 offen offset:1024 sc1
    buffer_load_dwordx4 v[120:123], v4, s[44:47], s55 offen offset:2048 sc1
    buffer_load_dwordx4 v[124:127], v4, s[44:47], s55 offen offset:3072 sc1
    s_mov_b64 exec, -1
    s_waitcnt vmcnt(4)
    v_max3_u32 v36, v72, v73, v74
    v_max3_u32 v37, v75, v76, v77
    v_max3_u32 v36, v36, v78, v79
    v_max3_u32 v37, v37, v120, v121
    v_max3_u32 v36, v36, v122, v123
    v_max3_u32 v37, v37, v124, v125
    v_max3_u32 v36, v36, v126, v127
    v_max_u32 v36, v36, v37
    v_cmp_eq_u32 vcc, -1, v36
    s_nop 0
    s_cbranch_vccz .ok_125
    s_mov_b64 exec, vcc
    s_add_u32 s57, s57, 1
    s_cmp_lt_u32 s57, 3000000
    s_cbranch_scc1 .mp_126
    s_branch .abort_1
.ok_125:
    v_add_u32 v37, s56, v4
    ds_write_b128 v37, v[72:75] offset:0
    ds_write_b128 v37, v[76:79] offset:1024
    ds_write_b128 v37, v[120:123] offset:2048
    ds_write_b128 v37, v[124:127] offset:3072
.mj_122:
    s_waitcnt lgkmcnt(0)
.nomp_120:
    s_cmp_ge_u32 s87, 80
    s_cbranch_scc1 .lf_127
    s_cmp_eq_u32 s54, 0
    s_cbranch_scc1 .lf_127
    s_and_b32 s70, s54, 3
    s_mul_i32 s70, s70, 32768
    s_add_u32 s70, s70, 0x5aa0000
    s_add_u32 s71, s54, 2
    s_and_b32 s71, s71, 3
    s_mul_i32 s71, s71, 32768
    s_add_u32 s71, s71, 0x5aa0000
    v_mov_b32 v32, -1
    v_mov_b32 v33, -1
    v_mov_b32 v34, -1
    v_mov_b32 v35, -1
    s_mov_b64 exec, 0xff
    buffer_store_dwordx4 v[32:35], v18, s[44:47], s71 offen sc1
    s_mov_b64 exec, -1
.lf_127:
    s_waitcnt lgkmcnt(0)
    s_barrier
    ds_read_b128 v[40:43], v11 offset:0
    ds_read_b128 v[44:47], v11 offset:512
    ds_read_b128 v[48:51], v11 offset:1024
    ds_read_b128 v[52:55], v11 offset:1536
    s_add_u32 s55, s54, 2
    s_min_u32 s55, s55, 63
    s_lshl_b32 s70, s55, 18
    s_add_u32 s71, s70, 0x2000000
    s_add_u32 s70, s70, 0x1000000
    s_lshl_b32 s56, s59, 13
    s_add_u32 s56, s56, s98
    s_waitcnt lgkmcnt(3)
    v_smfmac_f32_16x16x64_bf16 v[68:71], v[40:43], a[0:7], v3
    ds_read_b128 v[40:43], v11 offset:2048
    s_waitcnt lgkmcnt(3)
    v_smfmac_f32_16x16x64_bf16 v[68:71], v[44:47], a[8:15], v3
    ds_read_b128 v[44:47], v11 offset:2560
    s_waitcnt lgkmcnt(3)
    v_smfmac_f32_16x16x64_bf16 v[68:71], v[48:51], a[16:23], v3
    ds_read_b128 v[48:51], v11 offset:3072
    s_waitcnt lgkmcnt(3)
    v_smfmac_f32_16x16x64_bf16 v[68:71], v[52:55], a[24:31], v3
    ds_read_b128 v[52:55], v11 offset:3584
    s_add_u32 m0, s56, 18432
    s_nop 0
    buffer_load_dwordx4 v14, s[44:47], s70 offen sc1 lds
    s_waitcnt lgkmcnt(3)
    v_smfmac_f32_16x16x64_bf16 v[68:71], v[40:43], a[32:39], v3
    ds_read_b128 v[40:43], v11 offset:4096
    s_waitcnt lgkmcnt(3)
    v_smfmac_f32_16x16x64_bf16 v[68:71], v[44:47], a[40:47], v3
    ds_read_b128 v[44:47], v11 offset:4608
    s_waitcnt lgkmcnt(3)
    v_smfmac_f32_16x16x64_bf16 v[68:71], v[48:51], a[48:55], v3
    ds_read_b128 v[48:51], v11 offset:5120
    s_waitcnt lgkmcnt(3)
    v_smfmac_f32_16x16x64_bf16 v[68:71], v[52:55], a[56:63], v3
    ds_read_b128 v[52:55], v11 offset:5632
    s_waitcnt lgkmcnt(3)
    v_smfmac_f32_16x16x64_bf16 v[68:71], v[40:43], a[64:71], v3
    ds_read_b128 v[40:43], v11 offset:6144
    s_add_u32 m0, s56, 19456
    s_nop 0
    buffer_load_dwordx4 v0, s[44:47], s70 offen sc1 lds
    s_waitcnt lgkmcnt(3)
    v_smfmac_f32_16x16x64_bf16 v[68:71], v[44:47], a[72:79], v3
    ds_read_b128 v[44:47], v11 offset:6656
    s_waitcnt lgkmcnt(3)
    v_smfmac_f32_16x16x64_bf16 v[68:71], v[48:51], a[80:87], v3
    ds_read_b128 v[48:51], v11 offset:7168
    s_waitcnt lgkmcnt(3)
    v_smfmac_f32_16x16x64_bf16 v[68:71], v[52:55], a[88:95], v3
    ds_read_b128 v[52:55], v11 offset:7680
    s_waitcnt lgkmcnt(3)
    v_smfmac_f32_16x16x64_bf16 v[68:71], v[40:43], a[96:103], v3
    ds_read_b128 v[40:43], v11 offset:8192
    s_waitcnt lgkmcnt(3)
    v_smfmac_f32_16x16x64_bf16 v[68:71], v[44:47], a[104:111], v3
    ds_read_b128 v[44:47], v11 offset:8704
    s_add_u32 m0, s56, 34816
    s_nop 0
    buffer_load_dwordx4 v15, s[44:47], s71 offen sc1 lds
    s_waitcnt lgkmcnt(3)
    v_smfmac_f32_16x16x64_bf16 v[68:71], v[48:51], a[112:119], v3
    ds_read_b128 v[48:51], v11 offset:9216
    s_waitcnt lgkmcnt(3)
    v_smfmac_f32_16x16x64_bf16 v[68:71], v[52:55], a[120:127], v3
    ds_read_b128 v[52:55], v11 offset:9728
    s_waitcnt lgkmcnt(3)
    v_smfmac_f32_16x16x64_bf16 v[68:71], v[40:43], a[128:135], v3
    ds_read_b128 v[40:43], v11 offset:0
    s_waitcnt lgkmcnt(3)
    v_smfmac_f32_16x16x64_bf16 v[68:71], v[44:47], a[136:143], v3
    ds_read_b128 v[44:47], v11 offset:512
    s_waitcnt lgkmcnt(3)
    v_smfmac_f32_16x16x64_bf16 v[68:71], v[48:51], a[144:151], v3
    ds_read_b128 v[48:51], v11 offset:1024
    s_add_u32 m0, s56, 35840
    s_nop 0
    buffer_load_dwordx4 v1, s[44:47], s71 offen sc1 lds
    s_waitcnt lgkmcnt(3)
    v_smfmac_f32_16x16x64_bf16 v[68:71], v[52:55], a[152:159], v3
    ds_read_b128 v[52:55], v11 offset:1536
    s_waitcnt lgkmcnt(3)
    v_smfmac_f32_16x16x64_bf16 v[64:67], v[40:43], a[160:167], v3
    ds_read_b128 v[40:43], v11 offset:2048
    s_waitcnt lgkmcnt(3)
    v_smfmac_f32_16x16x64_bf16 v[64:67], v[44:47], a[168:175], v3
    ds_read_b128 v[44:47], v11 offset:2560
    s_waitcnt lgkmcnt(3)
    v_smfmac_f32_16x16x64_bf16 v[64:67], v[48:51], a[176:183], v3
    ds_read_b128 v[48:51], v11 offset:3072
    v_cvt_pk_bf16_f32 v68, v68, v69
    v_cvt_pk_bf16_f32 v69, v70, v71
    ds_write_b64 v5, v[68:69]
    s_waitcnt lgkmcnt(4)
    v_smfmac_f32_16x16x64_bf16 v[64:67], v[52:55], a[184:191], v3
    ds_read_b128 v[52:55], v11 offset:3584
    s_waitcnt lgkmcnt(4)
    v_smfmac_f32_16x16x64_bf16 v[64:67], v[40:43], a[192:199], v3
    ds_read_b128 v[40:43], v11 offset:4096
    s_waitcnt lgkmcnt(4)
    v_smfmac_f32_16x16x64_bf16 v[64:67], v[44:47], a[200:207], v3
    ds_read_b128 v[44:47], v11 offset:4608
    s_waitcnt lgkmcnt(3)
    s_barrier
    s_waitcnt vmcnt(4)
    ds_read_b64_tr_b16 v[56:57], v6 offset:0
    ds_read_b64_tr_b16 v[58:59], v6 offset:64
    ds_read_b64_tr_b16 v[60:61], v6 offset:512
    ds_read_b64_tr_b16 v[62:63], v6 offset:576
    ds_read_b64_tr_b16 v[120:121], v6 offset:1024
    ds_read_b64_tr_b16 v[122:123], v6 offset:1088
    ds_read_b64_tr_b16 v[124:125], v6 offset:1536
    ds_read_b64_tr_b16 v[126:127], v6 offset:1600
    s_waitcnt lgkmcnt(12)
    v_smfmac_f32_16x16x64_bf16 v[64:67], v[48:51], a[208:215], v3
    ds_read_b128 v[48:51], v11 offset:5120
    s_waitcnt lgkmcnt(11)
    v_smfmac_f32_16x16x64_bf16 v[64:67], v[52:55], a[216:223], v3
    ds_read_b128 v[52:55], v11 offset:5632
    s_waitcnt lgkmcnt(11)
    v_smfmac_f32_16x16x64_bf16 v[64:67], v[40:43], a[224:231], v3
    ds_read_b128 v[40:43], v11 offset:6144
    s_waitcnt lgkmcnt(11)
    v_smfmac_f32_16x16x64_bf16 v[64:67], v[44:47], a[232:239], v3
    ds_read_b128 v[44:47], v11 offset:6656
    s_waitcnt lgkmcnt(10)
    v_mfma_f32_16x16x32_bf16 v[72:75], v[80:83], v[56:59], 0
    v_mfma_f32_16x16x32_bf16 v[76:79], v[96:99], v[56:59], 0
    s_waitcnt lgkmcnt(8)
    v_mfma_f32_16x16x32_bf16 v[72:75], v[84:87], v[60:63], v[72:75]
    v_mfma_f32_16x16x32_bf16 v[76:79], v[100:103], v[60:63], v[76:79]
    s_waitcnt lgkmcnt(6)
    v_mfma_f32_16x16x32_bf16 v[72:75], v[88:91], v[120:123], v[72:75]
    v_mfma_f32_16x16x32_bf16 v[76:79], v[104:107], v[120:123], v[76:79]
    s_waitcnt lgkmcnt(4)
    v_mfma_f32_16x16x32_bf16 v[72:75], v[92:95], v[124:127], v[72:75]
    v_mfma_f32_16x16x32_bf16 v[76:79], v[108:111], v[124:127], v[76:79]
    s_waitcnt lgkmcnt(3)
    v_smfmac_f32_16x16x64_bf16 v[64:67], v[48:51], a[240:247], v3
    ds_read_b128 v[48:51], v11 offset:7168
    s_waitcnt lgkmcnt(3)
    v_smfmac_f32_16x16x64_bf16 v[64:67], v[52:55], a[248:255], v3
    ds_read_b128 v[52:55], v11 offset:7680
    v_mov_b32 v80, 0
    v_mov_b32 v81, 0
    v_mov_b32 v82, 0
    v_mov_b32 v83, 0
    v_max3_f32 v36, v72, v73, v74
    v_max3_f32 v37, v75, v76, v77
    v_max3_f32 v36, v36, v78, v79
    v_max_f32 v36, v36, v37
    s_waitcnt lgkmcnt(3)
    v_smfmac_f32_16x16x64_bf16 v[64:67], v[40:43], v[192:199], v3
    ds_read_b128 v[40:43], v11 offset:8192
    v_mov_b32 v37, v36
    v_mov_b32 v84, 0
    v_mov_b32 v85, 0
    v_permlane32_swap_b32 v36, v37
    s_waitcnt lgkmcnt(3)
    v_smfmac_f32_16x16x64_bf16 v[64:67], v[44:47], v[200:207], v3
    ds_read_b128 v[44:47], v11 offset:8704
    v_max_f32 v36, v36, v37
    v_mov_b32 v37, v36
    v_mov_b32 v86, 0
    v_mov_b32 v87, 0
    s_waitcnt lgkmcnt(3)
    v_smfmac_f32_16x16x64_bf16 v[64:67], v[48:51], v[208:215], v3
    ds_read_b128 v[48:51], v11 offset:9216
    v_permlane16_swap_b32 v36, v37
    s_mov_b32 s55, 0x3e0293ee
    v_max_f32 v36, v36, v37
    v_mul_f32 v36, s55, v36
    s_waitcnt lgkmcnt(3)
    v_smfmac_f32_16x16x64_bf16 v[64:67], v[52:55], v[216:223], v3
    ds_read_b128 v[52:55], v11 offset:9728
    v_fma_f32 v72, v72, s55, -v36
    v_fma_f32 v73, v73, s55, -v36
    v_fma_f32 v74, v74, s55, -v36
    v_fma_f32 v75, v75, s55, -v36
    s_waitcnt lgkmcnt(3)
    v_smfmac_f32_16x16x64_bf16 v[64:67], v[40:43], v[224:231], v3
    v_fma_f32 v76, v76, s55, -v36
    v_fma_f32 v77, v77, s55, -v36
    v_fma_f32 v78, v78, s55, -v36
    v_fma_f32 v79, v79, s55, -v36
    s_waitcnt lgkmcnt(2)
    v_smfmac_f32_16x16x64_bf16 v[64:67], v[44:47], v[232:239], v3
    v_exp_f32 v72, v72
    v_exp_f32 v73, v73
    v_exp_f32 v74, v74
    v_exp_f32 v75, v75
    s_waitcnt lgkmcnt(1)
    v_smfmac_f32_16x16x64_bf16 v[64:67], v[48:51], v[240:247], v3
    v_exp_f32 v76, v76
    v_exp_f32 v77, v77
    v_exp_f32 v78, v78
    v_exp_f32 v79, v79
    s_waitcnt lgkmcnt(0)
    v_smfmac_f32_16x16x64_bf16 v[64:67], v[52:55], v[248:255], v3
    v_cvt_pk_bf16_f32 v28, v72, v73
    v_cvt_pk_bf16_f32 v29, v74, v75
    v_cvt_pk_bf16_f32 v30, v76, v77
    v_cvt_pk_bf16_f32 v31, v78, v79
    s_nop 1
    v_mfma_f32_16x16x32_bf16 v[104:107], v[112:115], v[28:31], 0
    v_mfma_f32_16x16x32_bf16 v[108:111], v[116:119], v[28:31], 0
    v_cvt_pk_bf16_f32 v64, v64, v65
    v_cvt_pk_bf16_f32 v65, v66, v67
    ds_write_b64 v5, v[64:65] offset:2048
    s_and_b32 s70, s54, 3
    s_lshl_b32 s70, s70, 17
    s_add_u32 s70, s70, 0x5a20000
    buffer_load_dwordx2 v[38:39], v9, s[44:47], s70 offen sc1
    v_add_f32 v72, v72, v73
    v_add_f32 v74, v74, v75
    v_add_f32 v76, v76, v77
    v_add_f32 v78, v78, v79
    s_waitcnt lgkmcnt(0)
    s_barrier
    ds_read_b64_tr_b16 v[40:41], v6 offset:2048
    ds_read_b64_tr_b16 v[42:43], v6 offset:2112
    ds_read_b64_tr_b16 v[44:45], v6 offset:2560
    ds_read_b64_tr_b16 v[46:47], v6 offset:2624
    ds_read_b64_tr_b16 v[48:49], v6 offset:3072
    ds_read_b64_tr_b16 v[50:51], v6 offset:3136
    ds_read_b64_tr_b16 v[52:53], v6 offset:3584
    ds_read_b64_tr_b16 v[54:55], v6 offset:3648
    v_add_f32 v72, v72, v74
    v_add_f32 v76, v76, v78
    v_add_f32 v13, v72, v76
    v_mov_b32 v88, 0
    v_mov_b32 v89, 0
    v_mov_b32 v90, 0
    v_mov_b32 v91, 0
    v_mov_b32 v92, 0
    v_mov_b32 v93, 0
    v_mov_b32 v94, 0
    v_mov_b32 v95, 0
    v_mov_b32 v96, 0
    v_mov_b32 v97, 0
    v_mov_b32 v98, 0
    v_mov_b32 v99, 0
    buffer_load_dwordx2 v[38:39], v9, s[44:47], s70 offen sc1
    s_waitcnt lgkmcnt(6)
    v_mfma_f32_16x16x32_bf16 v[64:67], v[40:43], v[56:59], 0
    s_waitcnt lgkmcnt(4)
    v_mfma_f32_16x16x32_bf16 v[64:67], v[44:47], v[60:63], v[64:67]
    s_waitcnt lgkmcnt(2)
    v_mfma_f32_16x16x32_bf16 v[64:67], v[48:51], v[120:123], v[64:67]
    s_waitcnt lgkmcnt(0)
    v_mfma_f32_16x16x32_bf16 v[64:67], v[52:55], v[124:127], v[64:67]
    ds_read_b128 v[40:43], v17 offset:0
    ds_read_b128 v[44:47], v17 offset:1024
    ds_read_b128 v[48:51], v17 offset:2048
    ds_read_b128 v[52:55], v17 offset:3072
    ds_read_b128 v[112:115], v17 offset:4096
    ds_read_b128 v[116:119], v17 offset:5120
    buffer_load_dwordx2 v[38:39], v9, s[44:47], s70 offen sc1
    v_mov_b32 v16, 0x42800000
    v_fma_f32 v64, v64, s55, -v36
    v_fma_f32 v65, v65, s55, -v36
    v_fma_f32 v66, v66, s55, -v36
    v_fma_f32 v67, v67, s55, -v36
    v_max3_f32 v37, v64, v65, v66
    v_max_f32 v37, v37, v67
    v_cmp_nle_f32 vcc, v37, v16
    s_nop 0
    s_cbranch_vccz .safe_128
    v_mov_b32 v16, v37
    s_nop 1
    v_permlane16_swap_b32 v37, v16
    v_max_f32 v37, v37, v16
    v_max_f32 v37, 0, v37
    v_sub_f32 v64, v64, v37
    v_sub_f32 v65, v65, v37
    v_sub_f32 v66, v66, v37
    v_sub_f32 v67, v67, v37
    v_sub_f32 v16, 0, v37
    v_exp_f32 v16, v16
    s_nop 0
    v_mul_f32 v104, v104, v16
    v_mul_f32 v105, v105, v16
    v_mul_f32 v106, v106, v16
    v_mul_f32 v107, v107, v16
    v_mul_f32 v108, v108, v16
    v_mul_f32 v109, v109, v16
    v_mul_f32 v110, v110, v16
    v_mul_f32 v111, v111, v16
    v_mul_f32 v13, v13, v16
.safe_128:
    v_exp_f32 v64, v64
    v_exp_f32 v65, v65
    v_exp_f32 v66, v66
    v_exp_f32 v67, v67
    buffer_load_dwordx2 v[38:39], v9, s[44:47], s70 offen sc1
    v_cvt_pk_bf16_f32 v37, v64, v65
    v_cvt_pk_bf16_f32 v16, v66, v67
    v_cndmask_b32 v32, 0, v37, s[62:63]
    v_cndmask_b32 v33, 0, v16, s[62:63]
    v_cndmask_b32 v34, v37, 0, s[62:63]
    v_cndmask_b32 v35, v16, 0, s[62:63]
    v_add_f32 v64, v64, v65
    v_add_f32 v66, v66, v67
    v_add_f32 v36, v64, v66
    v_cndmask_b32 v36, 0, v36, s[62:63]
    v_add_f32 v36, v36, v13
    v_mov_b32 v16, v36
    s_nop 1
    v_permlane32_swap_b32 v36, v16
    v_add_f32 v36, v36, v16
    v_mov_b32 v16, v36
    s_nop 1
    v_permlane16_swap_b32 v36, v16
    v_add_f32 v36, v36, v16
    v_rcp_f32 v16, v36
    s_mov_b32 s57, 0
.vp_129:
    s_waitcnt vmcnt(3)
    v_max_u32 v37, v38, v39
    v_cmp_eq_u32 vcc, -1, v37
    s_nop 0
    s_cbranch_vccz .okv_130
    buffer_load_dwordx2 v[38:39], v9, s[44:47], s70 offen sc1
    s_add_u32 s57, s57, 1
    s_cmp_lt_u32 s57, 3000000
    s_cbranch_scc1 .vp_129
    s_branch .abort_1
.okv_130:
    v_mfma_f32_16x16x16_bf16 v[104:107], v[38:39], v[32:33], v[104:107]
    v_mfma_f32_16x16x16_bf16 v[108:111], v[38:39], v[34:35], v[108:111]
    v_mov_b32 v37, s59
    s_nop 5
    v_mul_f32 v104, v104, v16
    v_mul_f32 v105, v105, v16
    v_mul_f32 v106, v106, v16
    v_mul_f32 v107, v107, v16
    v_mul_f32 v108, v108, v16
    v_mul_f32 v109, v109, v16
    v_mul_f32 v110, v110, v16
    v_mul_f32 v111, v111, v16
    v_cvt_pk_bf16_f32 v104, v104, v105
    v_cvt_pk_bf16_f32 v105, v106, v107
    v_cvt_pk_bf16_f32 v106, v108, v109
    v_cvt_pk_bf16_f32 v107, v110, v111
    s_mov_b64 exec, s[66:67]
    ds_write_b128 v2, v[104:107]
    s_mov_b64 exec, -1
    s_waitcnt lgkmcnt(0)
    s_barrier
    ds_read_b128 v[64:67], v11 offset:16384
    ds_read_b128 v[68:71], v11 offset:16896
    ds_read_b128 v[72:75], v11 offset:17408
    ds_read_b128 v[76:79], v11 offset:17920
    s_waitcnt lgkmcnt(3)
    v_smfmac_f32_16x16x64_bf16 v[80:83], v[64:67], v[128:135], v3
    v_smfmac_f32_16x16x64_bf16 v[84:87], v[64:67], v[160:167], v3
    s_waitcnt lgkmcnt(2)
    v_smfmac_f32_16x16x64_bf16 v[80:83], v[68:71], v[136:143], v3
    v_smfmac_f32_16x16x64_bf16 v[84:87], v[68:71], v[168:175], v3
    s_waitcnt lgkmcnt(1)
    v_smfmac_f32_16x16x64_bf16 v[80:83], v[72:75], v[144:151], v3
    v_smfmac_f32_16x16x64_bf16 v[84:87], v[72:75], v[176:183], v3
    s_waitcnt lgkmcnt(0)
    v_smfmac_f32_16x16x64_bf16 v[80:83], v[76:79], v[152:159], v3
    v_smfmac_f32_16x16x64_bf16 v[84:87], v[76:79], v[184:191], v3
    s_waitcnt lgkmcnt(9)
    v_smfmac_f32_16x16x64_bf16 v[88:91], v[64:67], v[40:47], v3
    ds_read_b128 v[40:43], v17 offset:6144
    ds_read_b128 v[44:47], v17 offset:7168
    s_waitcnt lgkmcnt(9)
    v_smfmac_f32_16x16x64_bf16 v[88:91], v[68:71], v[48:55], v3
    ds_read_b128 v[48:51], v17 offset:8192
    ds_read_b128 v[52:55], v17 offset:9216
    s_waitcnt lgkmcnt(9)
    v_smfmac_f32_16x16x64_bf16 v[88:91], v[72:75], v[112:119], v3
    ds_read_b128 v[112:115], v17 offset:10240
    ds_read_b128 v[116:119], v17 offset:11264
    s_waitcnt lgkmcnt(4)
    v_smfmac_f32_16x16x64_bf16 v[88:91], v[76:79], v[40:47], v3
    ds_read_b128 v[40:43], v17 offset:12288
    ds_read_b128 v[44:47], v17 offset:13312
    s_waitcnt lgkmcnt(4)
    v_smfmac_f32_16x16x64_bf16 v[92:95], v[64:67], v[48:55], v3
    ds_read_b128 v[48:51], v17 offset:14336
    ds_read_b128 v[52:55], v17 offset:15360
    v_cvt_pk_bf16_f32 v80, v80, v81
    v_cvt_pk_bf16_f32 v81, v82, v83
    v_bfi_b32 v80, 1, v37, v80
    s_waitcnt lgkmcnt(4)
    v_smfmac_f32_16x16x64_bf16 v[92:95], v[68:71], v[112:119], v3
    ds_read_b128 v[112:115], v17 offset:16384
    ds_read_b128 v[116:119], v17 offset:17408
    v_bfi_b32 v81, 1, v37, v81
    buffer_store_dwordx2 v[80:81], v19, s[44:47], 0 offen
    v_cvt_pk_bf16_f32 v84, v84, v85
    s_waitcnt lgkmcnt(4)
    v_smfmac_f32_16x16x64_bf16 v[92:95], v[72:75], v[40:47], v3
    ds_read_b128 v[40:43], v17 offset:18432
    ds_read_b128 v[44:47], v17 offset:19456
    v_cvt_pk_bf16_f32 v85, v86, v87
    v_bfi_b32 v84, 1, v37, v84
    v_bfi_b32 v85, 1, v37, v85
    s_waitcnt lgkmcnt(4)
    v_smfmac_f32_16x16x64_bf16 v[92:95], v[76:79], v[48:55], v3
    ds_read_b128 v[48:51], v17 offset:20480
    ds_read_b128 v[52:55], v17 offset:21504
    buffer_store_dwordx2 v[84:85], v20, s[44:47], 0 offen
    s_waitcnt lgkmcnt(4)
    v_smfmac_f32_16x16x64_bf16 v[96:99], v[64:67], v[112:119], v3
    ds_read_b128 v[112:115], v17 offset:22528
    ds_read_b128 v[116:119], v17 offset:23552
    s_waitcnt lgkmcnt(4)
    v_smfmac_f32_16x16x64_bf16 v[96:99], v[68:71], v[40:47], v3
    v_cvt_pk_bf16_f32 v88, v88, v89
    v_cvt_pk_bf16_f32 v89, v90, v91
    v_bfi_b32 v88, 1, v37, v88
    s_waitcnt lgkmcnt(2)
    v_smfmac_f32_16x16x64_bf16 v[96:99], v[72:75], v[48:55], v3
    v_bfi_b32 v89, 1, v37, v89
    buffer_store_dwordx2 v[88:89], v21, s[44:47], 0 offen
    s_waitcnt lgkmcnt(0)
    v_smfmac_f32_16x16x64_bf16 v[96:99], v[76:79], v[112:119], v3
    v_cvt_pk_bf16_f32 v92, v92, v93
    v_cvt_pk_bf16_f32 v93, v94, v95
    v_bfi_b32 v92, 1, v37, v92
    v_bfi_b32 v93, 1, v37, v93
    buffer_store_dwordx2 v[92:93], v22, s[44:47], 0 offen
    s_nop 2
    v_cvt_pk_bf16_f32 v96, v96, v97
    v_cvt_pk_bf16_f32 v97, v98, v99
    v_bfi_b32 v96, 1, v37, v96
    v_bfi_b32 v97, 1, v37, v97
    buffer_store_dwordx2 v[96:97], v23, s[44:47], 0 offen
    s_cmp_eq_u32 s53, 3
    s_cbranch_scc1 .gw3_131
    s_cmp_ge_u32 s87, 80
    s_cbranch_scc1 .idle_133
    s_mov_b32 s57, 0
    s_add_u32 s55, s54, 1
    s_and_b32 s55, s55, 3
    s_mul_i32 s55, s55, 10240
    s_add_u32 s55, s55, 0x5a00000
    buffer_load_dwordx4 v[40:43], v10, s[44:47], 0 offen offset:0 sc1
    buffer_load_dwordx4 v[44:47], v10, s[44:47], 0 offen offset:512 sc1
    buffer_load_dwordx4 v[48:51], v10, s[44:47], 0 offen offset:1024 sc1
    buffer_load_dwordx4 v[52:55], v10, s[44:47], 0 offen offset:1536 sc1
    s_cmp_eq_u32 s59, 1
    s_waitcnt vmcnt(0)
    s_cbranch_scc1 .go_135
    v_or3_b32 v16, v40, v41, v42
    v_or3_b32 v36, v43, v44, v45
    v_or3_b32 v16, v16, v46, v47
    v_or3_b32 v36, v36, v48, v49
    v_or3_b32 v16, v16, v50, v51
    v_or3_b32 v36, v36, v52, v53
    v_or3_b32 v16, v16, v54, v55
    s_branch .gj_136
.go_135:
    v_bitop3_b32 v16, 0, v40, v41 bitop3:0xf7
    v_bitop3_b32 v36, 0, v42, v43 bitop3:0xf7
    v_bitop3_b32 v16, v16, v44, v45 bitop3:0xf7
    v_bitop3_b32 v36, v36, v46, v47 bitop3:0xf7
    v_bitop3_b32 v16, v16, v48, v49 bitop3:0xf7
    v_bitop3_b32 v36, v36, v50, v51 bitop3:0xf7
    v_bitop3_b32 v16, v16, v52, v53 bitop3:0xf7
    v_bitop3_b32 v36, v36, v54, v55 bitop3:0xf7
.gj_136:
    v_or_b32 v16, v16, v36
    v_and_b32 v16, 1, v16
    v_cmp_ne_u32 vcc, 0, v16
    s_nop 0
    s_cbranch_vccz .okg_134
    s_mov_b64 exec, vcc
    buffer_load_dwordx4 v[40:43], v10, s[44:47], 0 offen offset:0 sc1
    buffer_load_dwordx4 v[44:47], v10, s[44:47], 0 offen offset:512 sc1
    buffer_load_dwordx4 v[48:51], v10, s[44:47], 0 offen offset:1024 sc1
    buffer_load_dwordx4 v[52:55], v10, s[44:47], 0 offen offset:1536 sc1
.gr_137:
    buffer_load_dwordx4 v[40:43], v10, s[44:47], 0 offen offset:0 sc1
    buffer_load_dwordx4 v[44:47], v10, s[44:47], 0 offen offset:512 sc1
    buffer_load_dwordx4 v[48:51], v10, s[44:47], 0 offen offset:1024 sc1
    buffer_load_dwordx4 v[52:55], v10, s[44:47], 0 offen offset:1536 sc1
    s_mov_b64 exec, -1
    s_cmp_eq_u32 s59, 1
    s_waitcnt vmcnt(4)
    s_cbranch_scc1 .go_138
    v_or3_b32 v16, v40, v41, v42
    v_or3_b32 v36, v43, v44, v45
    v_or3_b32 v16, v16, v46, v47
    v_or3_b32 v36, v36, v48, v49
    v_or3_b32 v16, v16, v50, v51
    v_or3_b32 v36, v36, v52, v53
    v_or3_b32 v16, v16, v54, v55
    s_branch .gj_139
.go_138:
    v_bitop3_b32 v16, 0, v40, v41 bitop3:0xf7
    v_bitop3_b32 v36, 0, v42, v43 bitop3:0xf7
    v_bitop3_b32 v16, v16, v44, v45 bitop3:0xf7
    v_bitop3_b32 v36, v36, v46, v47 bitop3:0xf7
    v_bitop3_b32 v16, v16, v48, v49 bitop3:0xf7
    v_bitop3_b32 v36, v36, v50, v51 bitop3:0xf7
    v_bitop3_b32 v16, v16, v52, v53 bitop3:0xf7
    v_bitop3_b32 v36, v36, v54, v55 bitop3:0xf7
.gj_139:
    v_or_b32 v16, v16, v36
    v_and_b32 v16, 1, v16
    v_cmp_ne_u32 vcc, 0, v16
    s_nop 0
    s_cbranch_vccz .okg_134
    s_mov_b64 exec, vcc
    s_add_u32 s57, s57, 1
    s_cmp_lt_u32 s57, 3000000
    s_cbranch_scc1 .gr_137
    s_branch .abort_1
.okg_134:
    v_mfma_f32_16x16x32_bf16 v[56:59], v[40:43], v[24:27], 0
    v_mfma_f32_16x16x32_bf16 v[56:59], v[44:47], v[24:27], v[56:59]
    v_mfma_f32_16x16x32_bf16 v[56:59], v[48:51], v[24:27], v[56:59]
    v_mfma_f32_16x16x32_bf16 v[56:59], v[52:55], v[24:27], v[56:59]
    s_add_u32 s56, s54, 3
    s_and_b32 s56, s56, 3
    s_mul_i32 s56, s56, 10240
    s_add_u32 s56, s56, 0x5a00000
    v_mov_b32 v16, -1
    s_nop 2
    v_permlane32_swap_b32 v56, v58
    v_permlane32_swap_b32 v57, v59
    v_pk_add_f32 v[56:57], v[56:57], v[58:59]
    v_cvt_pk_bf16_f32 v56, v56, v57
    v_min_u32 v28, 0xfffffffe, v56
    v_min_u32 v29, 0xfffffffe, v56
    s_add_u32 s70, s54, 1
    s_and_b32 s70, s70, 3
    s_lshl_b32 s70, s70, 15
    s_add_u32 s70, s70, 0x5aa0000
    v_permlane32_swap_b32 v28, v29
    v_mov_b32 v30, v28
    v_mov_b32 v31, v29
    s_nop 0
    v_permlane16_swap_b32 v28, v30
    v_permlane16_swap_b32 v29, v31
    s_mov_b64 exec, 0xff
    buffer_store_dwordx4 v[28:31], v12, s[44:47], s55 offen
    buffer_store_dwordx4 v[28:31], v18, s[44:47], s70 offen sc1
    v_mov_b32 v58, 15360
    v_mov_b32 v59, s54
    ds_write_b32 v58, v59
    s_mov_b64 exec, s[66:67]
    buffer_store_dword v16, v12, s[44:47], s56 offen
    s_mov_b64 exec, -1
    s_branch .send_132
.idle_133:
    v_mov_b32 v40, 15360
    s_mov_b32 s57, 0
.il_140:
    ds_read_b32 v41, v40
    s_waitcnt lgkmcnt(0)
    v_readfirstlane_b32 s55, v41
    s_nop 0
    s_cmp_eq_u32 s55, s54
    s_cbranch_scc1 .send_132
    s_sleep 1
    s_add_u32 s57, s57, 1
    s_cmp_lt_u32 s57, 24000000
    s_cbranch_scc1 .il_140
    s_branch .abort_1
.gw3_131:
    s_add_u32 s55, s54, 3
    s_min_u32 s55, s55, 63
    s_cmp_lt_i32 s99, s55
    s_cbranch_scc0 .kvok_141
    v_mbcnt_lo_u32_b32 v36, -1, 0
    v_min_u32 v36, 7, v36
    v_lshlrev_b32 v36, 2, v36
    s_mov_b32 s57, 0
.kvl_142:
    global_load_dword v37, v36, s[38:39] offset:32 sc1
    s_waitcnt vmcnt(0)
    v_cmp_eq_u32 vcc, 0, v36
    v_lshrrev_b32 v38, 1, v37
    s_nop 0
    v_cndmask_b32 v37, v37, v38, vcc
    v_cmp_le_u32 vcc, 32, v37
    s_nop 0
    s_and_b32 s56, vcc_lo, 0xff
    s_ff0_i32_b32 s56, s56
    s_lshl_b32 s99, s56, 3
    s_sub_u32 s99, s99, 1
    s_cmp_lt_i32 s99, s55
    s_cbranch_scc0 .kvok_141
    s_sleep 4
    s_add_u32 s57, s57, 1
    s_cmp_lt_u32 s57, 3000000
    s_cbranch_scc1 .kvl_142
    s_branch .abort_1
.kvok_141:
.send_132:
    s_add_u32 s54, s54, 1
    s_branch .hstep_119
.hslow_117:
.hstep_143:
    s_cmp_eq_u32 s54, 63
    s_cbranch_scc1 .hfin_118
    s_and_b32 s59, s54, 1
    s_lshl_b32 s55, s59, 13
    v_add_u32 v36, s55, v7
    v_xor_b32 v37, 0, v36
    ds_read_b128 v[80:83], v37
    ds_read_b128 v[96:99], v37 offset:4096
    v_xor_b32 v37, 64, v36
    ds_read_b128 v[84:87], v37
    ds_read_b128 v[100:103], v37 offset:4096
    v_xor_b32 v37, 128, v36
    ds_read_b128 v[88:91], v37
    ds_read_b128 v[104:107], v37 offset:4096
    v_xor_b32 v37, 192, v36
    ds_read_b128 v[92:95], v37
    ds_read_b128 v[108:111], v37 offset:4096
    v_add_u32 v36, s55, v8
    v_xor_b32 v37, 32, v36
    ds_read_b64_tr_b16 v[112:113], v36
    ds_read_b64_tr_b16 v[114:115], v36 offset:4096
    ds_read_b64_tr_b16 v[116:117], v37
    ds_read_b64_tr_b16 v[118:119], v37 offset:4096
    v_mov_b32 v64, 0
    v_mov_b32 v65, 0
    v_mov_b32 v66, 0
    v_mov_b32 v67, 0
    v_mov_b32 v68, 0
    v_mov_b32 v69, 0
    v_mov_b32 v70, 0
    v_mov_b32 v71, 0
    s_cmp_ge_u32 s53, 3
    s_cbranch_scc1 .nomp_144
    s_mul_i32 s56, s53, 7
    s_lshr_b32 s56, s56, 1
    s_lshl_b32 s56, s56, 10
    s_and_b32 s55, s54, 3
    s_mul_i32 s55, s55, 10240
    s_add_u32 s55, s55, s56
    s_add_u32 s55, s55, 0x5a00000
    s_mov_b32 s57, 0
    s_cmp_eq_u32 s53, 1
    s_cbranch_scc1 .m4_145
    buffer_load_dwordx4 v[72:75], v4, s[44:47], s55 offen offset:0 sc1
    buffer_load_dwordx4 v[76:79], v4, s[44:47], s55 offen offset:1024 sc1
    buffer_load_dwordx4 v[120:123], v4, s[44:47], s55 offen offset:2048 sc1
    s_waitcnt vmcnt(0)
    v_max3_u32 v36, v72, v73, v74
    v_max3_u32 v37, v75, v76, v77
    v_max3_u32 v36, v36, v78, v79
    v_max3_u32 v37, v37, v120, v121
    v_max3_u32 v36, v36, v122, v123
    v_max_u32 v36, v36, v37
    v_cmp_eq_u32 vcc, -1, v36
    s_nop 0
    s_cbranch_vccz .ok_147
    s_mov_b64 exec, vcc
    buffer_load_dwordx4 v[72:75], v4, s[44:47], s55 offen offset:0 sc1
    buffer_load_dwordx4 v[76:79], v4, s[44:47], s55 offen offset:1024 sc1
    buffer_load_dwordx4 v[120:123], v4, s[44:47], s55 offen offset:2048 sc1
.mp_148:
    buffer_load_dwordx4 v[72:75], v4, s[44:47], s55 offen offset:0 sc1
    buffer_load_dwordx4 v[76:79], v4, s[44:47], s55 offen offset:1024 sc1
    buffer_load_dwordx4 v[120:123], v4, s[44:47], s55 offen offset:2048 sc1
    s_mov_b64 exec, -1
    s_waitcnt vmcnt(3)
    v_max3_u32 v36, v72, v73, v74
    v_max3_u32 v37, v75, v76, v77
    v_max3_u32 v36, v36, v78, v79
    v_max3_u32 v37, v37, v120, v121
    v_max3_u32 v36, v36, v122, v123
    v_max_u32 v36, v36, v37
    v_cmp_eq_u32 vcc, -1, v36
    s_nop 0
    s_cbranch_vccz .ok_147
    s_mov_b64 exec, vcc
    s_add_u32 s57, s57, 1
    s_cmp_lt_u32 s57, 3000000
    s_cbranch_scc1 .mp_148
    s_branch .abort_1
.ok_147:
    v_add_u32 v37, s56, v4
    ds_write_b128 v37, v[72:75] offset:0
    ds_write_b128 v37, v[76:79] offset:1024
    ds_write_b128 v37, v[120:123] offset:2048
    s_branch .mj_146
.m4_145:
    buffer_load_dwordx4 v[72:75], v4, s[44:47], s55 offen offset:0 sc1
    buffer_load_dwordx4 v[76:79], v4, s[44:47], s55 offen offset:1024 sc1
    buffer_load_dwordx4 v[120:123], v4, s[44:47], s55 offen offset:2048 sc1
    buffer_load_dwordx4 v[124:127], v4, s[44:47], s55 offen offset:3072 sc1
    s_waitcnt vmcnt(0)
    v_max3_u32 v36, v72, v73, v74
    v_max3_u32 v37, v75, v76, v77
    v_max3_u32 v36, v36, v78, v79
    v_max3_u32 v37, v37, v120, v121
    v_max3_u32 v36, v36, v122, v123
    v_max3_u32 v37, v37, v124, v125
    v_max3_u32 v36, v36, v126, v127
    v_max_u32 v36, v36, v37
    v_cmp_eq_u32 vcc, -1, v36
    s_nop 0
    s_cbranch_vccz .ok_149
    s_mov_b64 exec, vcc
    buffer_load_dwordx4 v[72:75], v4, s[44:47], s55 offen offset:0 sc1
    buffer_load_dwordx4 v[76:79], v4, s[44:47], s55 offen offset:1024 sc1
    buffer_load_dwordx4 v[120:123], v4, s[44:47], s55 offen offset:2048 sc1
    buffer_load_dwordx4 v[124:127], v4, s[44:47], s55 offen offset:3072 sc1
.mp_150:
    buffer_load_dwordx4 v[72:75], v4, s[44:47], s55 offen offset:0 sc1
    buffer_load_dwordx4 v[76:79], v4, s[44:47], s55 offen offset:1024 sc1
    buffer_load_dwordx4 v[120:123], v4, s[44:47], s55 offen offset:2048 sc1
    buffer_load_dwordx4 v[124:127], v4, s[44:47], s55 offen offset:3072 sc1
    s_mov_b64 exec, -1
    s_waitcnt vmcnt(4)
    v_max3_u32 v36, v72, v73, v74
    v_max3_u32 v37, v75, v76, v77
    v_max3_u32 v36, v36, v78, v79
    v_max3_u32 v37, v37, v120, v121
    v_max3_u32 v36, v36, v122, v123
    v_max3_u32 v37, v37, v124, v125
    v_max3_u32 v36, v36, v126, v127
    v_max_u32 v36, v36, v37
    v_cmp_eq_u32 vcc, -1, v36
    s_nop 0
    s_cbranch_vccz .ok_149
    s_mov_b64 exec, vcc
    s_add_u32 s57, s57, 1
    s_cmp_lt_u32 s57, 3000000
    s_cbranch_scc1 .mp_150
    s_branch .abort_1
.ok_149:
    v_add_u32 v37, s56, v4
    ds_write_b128 v37, v[72:75] offset:0
    ds_write_b128 v37, v[76:79] offset:1024
    ds_write_b128 v37, v[120:123] offset:2048
    ds_write_b128 v37, v[124:127] offset:3072
.mj_146:
    s_waitcnt lgkmcnt(0)
.nomp_144:
    s_cmp_ge_u32 s87, 80
    s_cbranch_scc1 .lf_151
    s_cmp_eq_u32 s54, 0
    s_cbranch_scc1 .lf_151
    s_and_b32 s70, s54, 3
    s_mul_i32 s70, s70, 32768
    s_add_u32 s70, s70, 0x5aa0000
    s_add_u32 s71, s54, 2
    s_and_b32 s71, s71, 3
    s_mul_i32 s71, s71, 32768
    s_add_u32 s71, s71, 0x5aa0000
    v_mov_b32 v32, -1
    v_mov_b32 v33, -1
    v_mov_b32 v34, -1
    v_mov_b32 v35, -1
    s_mov_b64 exec, 0xff
    buffer_store_dwordx4 v[32:35], v18, s[44:47], s71 offen sc1
    s_mov_b64 exec, -1
.lf_151:
    s_waitcnt lgkmcnt(0)
    s_barrier
    ds_read_b128 v[40:43], v11 offset:0
    ds_read_b128 v[44:47], v11 offset:512
    ds_read_b128 v[48:51], v11 offset:1024
    ds_read_b128 v[52:55], v11 offset:1536
    s_add_u32 s55, s54, 2
    s_min_u32 s55, s55, 63
    s_lshl_b32 s70, s55, 18
    s_add_u32 s71, s70, 0x2000000
    s_add_u32 s70, s70, 0x1000000
    s_lshl_b32 s56, s59, 13
    s_add_u32 s56, s56, s98
    s_waitcnt lgkmcnt(3)
    v_smfmac_f32_16x16x64_bf16 v[68:71], v[40:43], a[0:7], v3
    ds_read_b128 v[40:43], v11 offset:2048
    s_waitcnt lgkmcnt(3)
    v_smfmac_f32_16x16x64_bf16 v[68:71], v[44:47], a[8:15], v3
    ds_read_b128 v[44:47], v11 offset:2560
    s_waitcnt lgkmcnt(3)
    v_smfmac_f32_16x16x64_bf16 v[68:71], v[48:51], a[16:23], v3
    ds_read_b128 v[48:51], v11 offset:3072
    s_waitcnt lgkmcnt(3)
    v_smfmac_f32_16x16x64_bf16 v[68:71], v[52:55], a[24:31], v3
    ds_read_b128 v[52:55], v11 offset:3584
    s_add_u32 m0, s56, 18432
    s_nop 0
    buffer_load_dwordx4 v14, s[44:47], s70 offen sc1 lds
    s_waitcnt lgkmcnt(3)
    v_smfmac_f32_16x16x64_bf16 v[68:71], v[40:43], a[32:39], v3
    ds_read_b128 v[40:43], v11 offset:4096
    s_waitcnt lgkmcnt(3)
    v_smfmac_f32_16x16x64_bf16 v[68:71], v[44:47], a[40:47], v3
    ds_read_b128 v[44:47], v11 offset:4608
    s_waitcnt lgkmcnt(3)
    v_smfmac_f32_16x16x64_bf16 v[68:71], v[48:51], a[48:55], v3
    ds_read_b128 v[48:51], v11 offset:5120
    s_waitcnt lgkmcnt(3)
    v_smfmac_f32_16x16x64_bf16 v[68:71], v[52:55], a[56:63], v3
    ds_read_b128 v[52:55], v11 offset:5632
    s_waitcnt lgkmcnt(3)
    v_smfmac_f32_16x16x64_bf16 v[68:71], v[40:43], a[64:71], v3
    ds_read_b128 v[40:43], v11 offset:6144
    s_add_u32 m0, s56, 19456
    s_nop 0
    buffer_load_dwordx4 v0, s[44:47], s70 offen sc1 lds
    s_waitcnt lgkmcnt(3)
    v_smfmac_f32_16x16x64_bf16 v[68:71], v[44:47], a[72:79], v3
    ds_read_b128 v[44:47], v11 offset:6656
    s_waitcnt lgkmcnt(3)
    v_smfmac_f32_16x16x64_bf16 v[68:71], v[48:51], a[80:87], v3
    ds_read_b128 v[48:51], v11 offset:7168
    s_waitcnt lgkmcnt(3)
    v_smfmac_f32_16x16x64_bf16 v[68:71], v[52:55], a[88:95], v3
    ds_read_b128 v[52:55], v11 offset:7680
    s_waitcnt lgkmcnt(3)
    v_smfmac_f32_16x16x64_bf16 v[68:71], v[40:43], a[96:103], v3
    ds_read_b128 v[40:43], v11 offset:8192
    s_waitcnt lgkmcnt(3)
    v_smfmac_f32_16x16x64_bf16 v[68:71], v[44:47], a[104:111], v3
    ds_read_b128 v[44:47], v11 offset:8704
    s_add_u32 m0, s56, 34816
    s_nop 0
    buffer_load_dwordx4 v15, s[44:47], s71 offen sc1 lds
    s_waitcnt lgkmcnt(3)
    v_smfmac_f32_16x16x64_bf16 v[68:71], v[48:51], a[112:119], v3
    ds_read_b128 v[48:51], v11 offset:9216
    s_waitcnt lgkmcnt(3)
    v_smfmac_f32_16x16x64_bf16 v[68:71], v[52:55], a[120:127], v3
    ds_read_b128 v[52:55], v11 offset:9728
    s_waitcnt lgkmcnt(3)
    v_smfmac_f32_16x16x64_bf16 v[68:71], v[40:43], a[128:135], v3
    ds_read_b128 v[40:43], v11 offset:0
    s_waitcnt lgkmcnt(3)
    v_smfmac_f32_16x16x64_bf16 v[68:71], v[44:47], a[136:143], v3
    ds_read_b128 v[44:47], v11 offset:512
    s_waitcnt lgkmcnt(3)
    v_smfmac_f32_16x16x64_bf16 v[68:71], v[48:51], a[144:151], v3
    ds_read_b128 v[48:51], v11 offset:1024
    s_add_u32 m0, s56, 35840
    s_nop 0
    buffer_load_dwordx4 v1, s[44:47], s71 offen sc1 lds
    s_waitcnt lgkmcnt(3)
    v_smfmac_f32_16x16x64_bf16 v[68:71], v[52:55], a[152:159], v3
    ds_read_b128 v[52:55], v11 offset:1536
    s_waitcnt lgkmcnt(3)
    v_smfmac_f32_16x16x64_bf16 v[64:67], v[40:43], a[160:167], v3
    ds_read_b128 v[40:43], v11 offset:2048
    s_waitcnt lgkmcnt(3)
    v_smfmac_f32_16x16x64_bf16 v[64:67], v[44:47], a[168:175], v3
    ds_read_b128 v[44:47], v11 offset:2560
    s_waitcnt lgkmcnt(3)
    v_smfmac_f32_16x16x64_bf16 v[64:67], v[48:51], a[176:183], v3
    ds_read_b128 v[48:51], v11 offset:3072
    v_cvt_pk_bf16_f32 v68, v68, v69
    v_cvt_pk_bf16_f32 v69, v70, v71
    ds_write_b64 v5, v[68:69]
    s_waitcnt lgkmcnt(4)
    v_smfmac_f32_16x16x64_bf16 v[64:67], v[52:55], a[184:191], v3
    ds_read_b128 v[52:55], v11 offset:3584
    s_waitcnt lgkmcnt(4)
    v_smfmac_f32_16x16x64_bf16 v[64:67], v[40:43], a[192:199], v3
    ds_read_b128 v[40:43], v11 offset:4096
    s_waitcnt lgkmcnt(4)
    v_smfmac_f32_16x16x64_bf16 v[64:67], v[44:47], a[200:207], v3
    ds_read_b128 v[44:47], v11 offset:4608
    s_waitcnt lgkmcnt(3)
    s_barrier
    s_waitcnt vmcnt(4)
    ds_read_b64_tr_b16 v[56:57], v6 offset:0
    ds_read_b64_tr_b16 v[58:59], v6 offset:64
    ds_read_b64_tr_b16 v[60:61], v6 offset:512
    ds_read_b64_tr_b16 v[62:63], v6 offset:576
    ds_read_b64_tr_b16 v[120:121], v6 offset:1024
    ds_read_b64_tr_b16 v[122:123], v6 offset:1088
    ds_read_b64_tr_b16 v[124:125], v6 offset:1536
    ds_read_b64_tr_b16 v[126:127], v6 offset:1600
    s_waitcnt lgkmcnt(12)
    v_smfmac_f32_16x16x64_bf16 v[64:67], v[48:51], a[208:215], v3
    ds_read_b128 v[48:51], v11 offset:5120
    s_waitcnt lgkmcnt(11)
    v_smfmac_f32_16x16x64_bf16 v[64:67], v[52:55], a[216:223], v3
    ds_read_b128 v[52:55], v11 offset:5632
    s_waitcnt lgkmcnt(11)
    v_smfmac_f32_16x16x64_bf16 v[64:67], v[40:43], a[224:231], v3
    ds_read_b128 v[40:43], v11 offset:6144
    s_waitcnt lgkmcnt(11)
    v_smfmac_f32_16x16x64_bf16 v[64:67], v[44:47], a[232:239], v3
    ds_read_b128 v[44:47], v11 offset:6656
    s_waitcnt lgkmcnt(10)
    v_mfma_f32_16x16x32_bf16 v[72:75], v[80:83], v[56:59], 0
    v_mfma_f32_16x16x32_bf16 v[76:79], v[96:99], v[56:59], 0
    s_waitcnt lgkmcnt(8)
    v_mfma_f32_16x16x32_bf16 v[72:75], v[84:87], v[60:63], v[72:75]
    v_mfma_f32_16x16x32_bf16 v[76:79], v[100:103], v[60:63], v[76:79]
    s_waitcnt lgkmcnt(6)
    v_mfma_f32_16x16x32_bf16 v[72:75], v[88:91], v[120:123], v[72:75]
    v_mfma_f32_16x16x32_bf16 v[76:79], v[104:107], v[120:123], v[76:79]
    s_waitcnt lgkmcnt(4)
    v_mfma_f32_16x16x32_bf16 v[72:75], v[92:95], v[124:127], v[72:75]
    v_mfma_f32_16x16x32_bf16 v[76:79], v[108:111], v[124:127], v[76:79]
    s_waitcnt lgkmcnt(3)
    v_smfmac_f32_16x16x64_bf16 v[64:67], v[48:51], a[240:247], v3
    ds_read_b128 v[48:51], v11 offset:7168
    s_waitcnt lgkmcnt(3)
    v_smfmac_f32_16x16x64_bf16 v[64:67], v[52:55], a[248:255], v3
    ds_read_b128 v[52:55], v11 offset:7680
    v_mov_b32 v80, 0
    v_mov_b32 v81, 0
    v_mov_b32 v82, 0
    v_mov_b32 v83, 0
    v_max3_f32 v36, v72, v73, v74
    v_max3_f32 v37, v75, v76, v77
    v_max3_f32 v36, v36, v78, v79
    v_max_f32 v36, v36, v37
    s_waitcnt lgkmcnt(3)
    v_smfmac_f32_16x16x64_bf16 v[64:67], v[40:43], v[192:199], v3
    ds_read_b128 v[40:43], v11 offset:8192
    v_mov_b32 v37, v36
    v_mov_b32 v84, 0
    v_mov_b32 v85, 0
    v_permlane32_swap_b32 v36, v37
    s_waitcnt lgkmcnt(3)
    v_smfmac_f32_16x16x64_bf16 v[64:67], v[44:47], v[200:207], v3
    ds_read_b128 v[44:47], v11 offset:8704
    v_max_f32 v36, v36, v37
    v_mov_b32 v37, v36
    v_mov_b32 v86, 0
    v_mov_b32 v87, 0
    s_waitcnt lgkmcnt(3)
    v_smfmac_f32_16x16x64_bf16 v[64:67], v[48:51], v[208:215], v3
    ds_read_b128 v[48:51], v11 offset:9216
    v_permlane16_swap_b32 v36, v37
    s_mov_b32 s55, 0x3e0293ee
    v_max_f32 v36, v36, v37
    v_mul_f32 v36, s55, v36
    s_waitcnt lgkmcnt(3)
    v_smfmac_f32_16x16x64_bf16 v[64:67], v[52:55], v[216:223], v3
    ds_read_b128 v[52:55], v11 offset:9728
    v_fma_f32 v72, v72, s55, -v36
    v_fma_f32 v73, v73, s55, -v36
    v_fma_f32 v74, v74, s55, -v36
    v_fma_f32 v75, v75, s55, -v36
    s_waitcnt lgkmcnt(3)
    v_smfmac_f32_16x16x64_bf16 v[64:67], v[40:43], v[224:231], v3
    v_fma_f32 v76, v76, s55, -v36
    v_fma_f32 v77, v77, s55, -v36
    v_fma_f32 v78, v78, s55, -v36
    v_fma_f32 v79, v79, s55, -v36
    s_waitcnt lgkmcnt(2)
    v_smfmac_f32_16x16x64_bf16 v[64:67], v[44:47], v[232:239], v3
    v_exp_f32 v72, v72
    v_exp_f32 v73, v73
    v_exp_f32 v74, v74
    v_exp_f32 v75, v75
    s_waitcnt lgkmcnt(1)
    v_smfmac_f32_16x16x64_bf16 v[64:67], v[48:51], v[240:247], v3
    v_exp_f32 v76, v76
    v_exp_f32 v77, v77
    v_exp_f32 v78, v78
    v_exp_f32 v79, v79
    s_waitcnt lgkmcnt(0)
    v_smfmac_f32_16x16x64_bf16 v[64:67], v[52:55], v[248:255], v3
    v_cvt_pk_bf16_f32 v28, v72, v73
    v_cvt_pk_bf16_f32 v29, v74, v75
    v_cvt_pk_bf16_f32 v30, v76, v77
    v_cvt_pk_bf16_f32 v31, v78, v79
    s_nop 1
    v_mfma_f32_16x16x32_bf16 v[104:107], v[112:115], v[28:31], 0
    v_mfma_f32_16x16x32_bf16 v[108:111], v[116:119], v[28:31], 0
    v_cvt_pk_bf16_f32 v64, v64, v65
    v_cvt_pk_bf16_f32 v65, v66, v67
    ds_write_b64 v5, v[64:65] offset:2048
    s_and_b32 s70, s54, 3
    s_lshl_b32 s70, s70, 17
    s_add_u32 s70, s70, 0x5a20000
    buffer_load_dwordx2 v[38:39], v9, s[44:47], s70 offen sc1
    v_add_f32 v72, v72, v73
    v_add_f32 v74, v74, v75
    v_add_f32 v76, v76, v77
    v_add_f32 v78, v78, v79
    s_waitcnt lgkmcnt(0)
    s_barrier
    ds_read_b64_tr_b16 v[40:41], v6 offset:2048
    ds_read_b64_tr_b16 v[42:43], v6 offset:2112
    ds_read_b64_tr_b16 v[44:45], v6 offset:2560
    ds_read_b64_tr_b16 v[46:47], v6 offset:2624
    ds_read_b64_tr_b16 v[48:49], v6 offset:3072
    ds_read_b64_tr_b16 v[50:51], v6 offset:3136
    ds_read_b64_tr_b16 v[52:53], v6 offset:3584
    ds_read_b64_tr_b16 v[54:55], v6 offset:3648
    v_add_f32 v72, v72, v74
    v_add_f32 v76, v76, v78
    v_add_f32 v13, v72, v76
    v_mov_b32 v88, 0
    v_mov_b32 v89, 0
    v_mov_b32 v90, 0
    v_mov_b32 v91, 0
    v_mov_b32 v92, 0
    v_mov_b32 v93, 0
    v_mov_b32 v94, 0
    v_mov_b32 v95, 0
    v_mov_b32 v96, 0
    v_mov_b32 v97, 0
    v_mov_b32 v98, 0
    v_mov_b32 v99, 0
    buffer_load_dwordx2 v[38:39], v9, s[44:47], s70 offen sc1
    s_waitcnt lgkmcnt(6)
    v_mfma_f32_16x16x32_bf16 v[64:67], v[40:43], v[56:59], 0
    s_waitcnt lgkmcnt(4)
    v_mfma_f32_16x16x32_bf16 v[64:67], v[44:47], v[60:63], v[64:67]
    s_waitcnt lgkmcnt(2)
    v_mfma_f32_16x16x32_bf16 v[64:67], v[48:51], v[120:123], v[64:67]
    s_waitcnt lgkmcnt(0)
    v_mfma_f32_16x16x32_bf16 v[64:67], v[52:55], v[124:127], v[64:67]
    ds_read_b128 v[40:43], v17 offset:0
    ds_read_b128 v[44:47], v17 offset:1024
    ds_read_b128 v[48:51], v17 offset:2048
    ds_read_b128 v[52:55], v17 offset:3072
    ds_read_b128 v[112:115], v17 offset:4096
    ds_read_b128 v[116:119], v17 offset:5120
    buffer_load_dwordx2 v[38:39], v9, s[44:47], s70 offen sc1
    v_mov_b32 v16, 0x42800000
    v_fma_f32 v64, v64, s55, -v36
    v_fma_f32 v65, v65, s55, -v36
    v_fma_f32 v66, v66, s55, -v36
    v_fma_f32 v67, v67, s55, -v36
    v_max3_f32 v37, v64, v65, v66
    v_max_f32 v37, v37, v67
    v_cmp_nle_f32 vcc, v37, v16
    s_nop 0
    s_cbranch_vccz .safe_152
    v_mov_b32 v16, v37
    s_nop 1
    v_permlane16_swap_b32 v37, v16
    v_max_f32 v37, v37, v16
    v_max_f32 v37, 0, v37
    v_sub_f32 v64, v64, v37
    v_sub_f32 v65, v65, v37
    v_sub_f32 v66, v66, v37
    v_sub_f32 v67, v67, v37
    v_sub_f32 v16, 0, v37
    v_exp_f32 v16, v16
    s_nop 0
    v_mul_f32 v104, v104, v16
    v_mul_f32 v105, v105, v16
    v_mul_f32 v106, v106, v16
    v_mul_f32 v107, v107, v16
    v_mul_f32 v108, v108, v16
    v_mul_f32 v109, v109, v16
    v_mul_f32 v110, v110, v16
    v_mul_f32 v111, v111, v16
    v_mul_f32 v13, v13, v16
.safe_152:
    v_exp_f32 v64, v64
    v_exp_f32 v65, v65
    v_exp_f32 v66, v66
    v_exp_f32 v67, v67
    buffer_load_dwordx2 v[38:39], v9, s[44:47], s70 offen sc1
    v_cvt_pk_bf16_f32 v37, v64, v65
    v_cvt_pk_bf16_f32 v16, v66, v67
    v_cndmask_b32 v32, 0, v37, s[62:63]
    v_cndmask_b32 v33, 0, v16, s[62:63]
    v_cndmask_b32 v34, v37, 0, s[62:63]
    v_cndmask_b32 v35, v16, 0, s[62:63]
    v_add_f32 v64, v64, v65
    v_add_f32 v66, v66, v67
    v_add_f32 v36, v64, v66
    v_cndmask_b32 v36, 0, v36, s[62:63]
    v_add_f32 v36, v36, v13
    v_mov_b32 v16, v36
    s_nop 1
    v_permlane32_swap_b32 v36, v16
    v_add_f32 v36, v36, v16
    v_mov_b32 v16, v36
    s_nop 1
    v_permlane16_swap_b32 v36, v16
    v_add_f32 v36, v36, v16
    v_rcp_f32 v16, v36
    s_mov_b32 s57, 0
.vp_153:
    s_waitcnt vmcnt(3)
    v_max_u32 v37, v38, v39
    v_cmp_eq_u32 vcc, -1, v37
    s_nop 0
    s_cbranch_vccz .okv_154
    buffer_load_dwordx2 v[38:39], v9, s[44:47], s70 offen sc1
    s_add_u32 s57, s57, 1
    s_cmp_lt_u32 s57, 3000000
    s_cbranch_scc1 .vp_153
    s_branch .abort_1
.okv_154:
    v_mfma_f32_16x16x16_bf16 v[104:107], v[38:39], v[32:33], v[104:107]
    v_mfma_f32_16x16x16_bf16 v[108:111], v[38:39], v[34:35], v[108:111]
    v_mov_b32 v37, s59
    s_nop 5
    v_mul_f32 v104, v104, v16
    v_mul_f32 v105, v105, v16
    v_mul_f32 v106, v106, v16
    v_mul_f32 v107, v107, v16
    v_mul_f32 v108, v108, v16
    v_mul_f32 v109, v109, v16
    v_mul_f32 v110, v110, v16
    v_mul_f32 v111, v111, v16
    v_cvt_pk_bf16_f32 v104, v104, v105
    v_cvt_pk_bf16_f32 v105, v106, v107
    v_cvt_pk_bf16_f32 v106, v108, v109
    v_cvt_pk_bf16_f32 v107, v110, v111
    s_mov_b64 exec, s[66:67]
    ds_write_b128 v2, v[104:107]
    s_mov_b64 exec, -1
    s_waitcnt lgkmcnt(0)
    s_barrier
    ds_read_b128 v[64:67], v11 offset:16384
    ds_read_b128 v[68:71], v11 offset:16896
    ds_read_b128 v[72:75], v11 offset:17408
    ds_read_b128 v[76:79], v11 offset:17920
    s_waitcnt lgkmcnt(3)
    v_smfmac_f32_16x16x64_bf16 v[80:83], v[64:67], v[128:135], v3
    v_smfmac_f32_16x16x64_bf16 v[84:87], v[64:67], v[160:167], v3
    s_waitcnt lgkmcnt(2)
    v_smfmac_f32_16x16x64_bf16 v[80:83], v[68:71], v[136:143], v3
    v_smfmac_f32_16x16x64_bf16 v[84:87], v[68:71], v[168:175], v3
    s_waitcnt lgkmcnt(1)
    v_smfmac_f32_16x16x64_bf16 v[80:83], v[72:75], v[144:151], v3
    v_smfmac_f32_16x16x64_bf16 v[84:87], v[72:75], v[176:183], v3
    s_waitcnt lgkmcnt(0)
    v_smfmac_f32_16x16x64_bf16 v[80:83], v[76:79], v[152:159], v3
    v_smfmac_f32_16x16x64_bf16 v[84:87], v[76:79], v[184:191], v3
    s_waitcnt lgkmcnt(9)
    v_smfmac_f32_16x16x64_bf16 v[88:91], v[64:67], v[40:47], v3
    ds_read_b128 v[40:43], v17 offset:6144
    ds_read_b128 v[44:47], v17 offset:7168
    s_waitcnt lgkmcnt(9)
    v_smfmac_f32_16x16x64_bf16 v[88:91], v[68:71], v[48:55], v3
    ds_read_b128 v[48:51], v17 offset:8192
    ds_read_b128 v[52:55], v17 offset:9216
    s_waitcnt lgkmcnt(9)
    v_smfmac_f32_16x16x64_bf16 v[88:91], v[72:75], v[112:119], v3
    ds_read_b128 v[112:115], v17 offset:10240
    ds_read_b128 v[116:119], v17 offset:11264
    s_waitcnt lgkmcnt(4)
    v_smfmac_f32_16x16x64_bf16 v[88:91], v[76:79], v[40:47], v3
    ds_read_b128 v[40:43], v17 offset:12288
    ds_read_b128 v[44:47], v17 offset:13312
    s_waitcnt lgkmcnt(4)
    v_smfmac_f32_16x16x64_bf16 v[92:95], v[64:67], v[48:55], v3
    ds_read_b128 v[48:51], v17 offset:14336
    ds_read_b128 v[52:55], v17 offset:15360
    v_cvt_pk_bf16_f32 v80, v80, v81
    v_cvt_pk_bf16_f32 v81, v82, v83
    v_bfi_b32 v80, 1, v37, v80
    s_waitcnt lgkmcnt(4)
    v_smfmac_f32_16x16x64_bf16 v[92:95], v[68:71], v[112:119], v3
    ds_read_b128 v[112:115], v17 offset:16384
    ds_read_b128 v[116:119], v17 offset:17408
    v_bfi_b32 v81, 1, v37, v81
    buffer_store_dwordx2 v[80:81], v19, s[44:47], 0 offen sc1
    v_cvt_pk_bf16_f32 v84, v84, v85
    s_waitcnt lgkmcnt(4)
    v_smfmac_f32_16x16x64_bf16 v[92:95], v[72:75], v[40:47], v3
    ds_read_b128 v[40:43], v17 offset:18432
    ds_read_b128 v[44:47], v17 offset:19456
    v_cvt_pk_bf16_f32 v85, v86, v87
    v_bfi_b32 v84, 1, v37, v84
    v_bfi_b32 v85, 1, v37, v85
    s_waitcnt lgkmcnt(4)
    v_smfmac_f32_16x16x64_bf16 v[92:95], v[76:79], v[48:55], v3
    ds_read_b128 v[48:51], v17 offset:20480
    ds_read_b128 v[52:55], v17 offset:21504
    buffer_store_dwordx2 v[84:85], v20, s[44:47], 0 offen sc1
    s_waitcnt lgkmcnt(4)
    v_smfmac_f32_16x16x64_bf16 v[96:99], v[64:67], v[112:119], v3
    ds_read_b128 v[112:115], v17 offset:22528
    ds_read_b128 v[116:119], v17 offset:23552
    s_waitcnt lgkmcnt(4)
    v_smfmac_f32_16x16x64_bf16 v[96:99], v[68:71], v[40:47], v3
    v_cvt_pk_bf16_f32 v88, v88, v89
    v_cvt_pk_bf16_f32 v89, v90, v91
    v_bfi_b32 v88, 1, v37, v88
    s_waitcnt lgkmcnt(2)
    v_smfmac_f32_16x16x64_bf16 v[96:99], v[72:75], v[48:55], v3
    v_bfi_b32 v89, 1, v37, v89
    buffer_store_dwordx2 v[88:89], v21, s[44:47], 0 offen sc1
    s_waitcnt lgkmcnt(0)
    v_smfmac_f32_16x16x64_bf16 v[96:99], v[76:79], v[112:119], v3
    v_cvt_pk_bf16_f32 v92, v92, v93
    v_cvt_pk_bf16_f32 v93, v94, v95
    v_bfi_b32 v92, 1, v37, v92
    v_bfi_b32 v93, 1, v37, v93
    buffer_store_dwordx2 v[92:93], v22, s[44:47], 0 offen sc1
    s_nop 2
    v_cvt_pk_bf16_f32 v96, v96, v97
    v_cvt_pk_bf16_f32 v97, v98, v99
    v_bfi_b32 v96, 1, v37, v96
    v_bfi_b32 v97, 1, v37, v97
    buffer_store_dwordx2 v[96:97], v23, s[44:47], 0 offen sc1
    s_cmp_eq_u32 s53, 3
    s_cbranch_scc1 .gw3_155
    s_cmp_ge_u32 s87, 80
    s_cbranch_scc1 .idle_157
    s_mov_b32 s57, 0
    s_add_u32 s55, s54, 1
    s_and_b32 s55, s55, 3
    s_mul_i32 s55, s55, 10240
    s_add_u32 s55, s55, 0x5a00000
    buffer_load_dwordx4 v[40:43], v10, s[44:47], 0 offen offset:0 sc1
    buffer_load_dwordx4 v[44:47], v10, s[44:47], 0 offen offset:512 sc1
    buffer_load_dwordx4 v[48:51], v10, s[44:47], 0 offen offset:1024 sc1
    buffer_load_dwordx4 v[52:55], v10, s[44:47], 0 offen offset:1536 sc1
    s_cmp_eq_u32 s59, 1
    s_waitcnt vmcnt(0)
    s_cbranch_scc1 .go_159
    v_or3_b32 v16, v40, v41, v42
    v_or3_b32 v36, v43, v44, v45
    v_or3_b32 v16, v16, v46, v47
    v_or3_b32 v36, v36, v48, v49
    v_or3_b32 v16, v16, v50, v51
    v_or3_b32 v36, v36, v52, v53
    v_or3_b32 v16, v16, v54, v55
    s_branch .gj_160
.go_159:
    v_bitop3_b32 v16, 0, v40, v41 bitop3:0xf7
    v_bitop3_b32 v36, 0, v42, v43 bitop3:0xf7
    v_bitop3_b32 v16, v16, v44, v45 bitop3:0xf7
    v_bitop3_b32 v36, v36, v46, v47 bitop3:0xf7
    v_bitop3_b32 v16, v16, v48, v49 bitop3:0xf7
    v_bitop3_b32 v36, v36, v50, v51 bitop3:0xf7
    v_bitop3_b32 v16, v16, v52, v53 bitop3:0xf7
    v_bitop3_b32 v36, v36, v54, v55 bitop3:0xf7
.gj_160:
    v_or_b32 v16, v16, v36
    v_and_b32 v16, 1, v16
    v_cmp_ne_u32 vcc, 0, v16
    s_nop 0
    s_cbranch_vccz .okg_158
    s_mov_b64 exec, vcc
    buffer_load_dwordx4 v[40:43], v10, s[44:47], 0 offen offset:0 sc1
    buffer_load_dwordx4 v[44:47], v10, s[44:47], 0 offen offset:512 sc1
    buffer_load_dwordx4 v[48:51], v10, s[44:47], 0 offen offset:1024 sc1
    buffer_load_dwordx4 v[52:55], v10, s[44:47], 0 offen offset:1536 sc1
.gr_161:
    buffer_load_dwordx4 v[40:43], v10, s[44:47], 0 offen offset:0 sc1
    buffer_load_dwordx4 v[44:47], v10, s[44:47], 0 offen offset:512 sc1
    buffer_load_dwordx4 v[48:51], v10, s[44:47], 0 offen offset:1024 sc1
    buffer_load_dwordx4 v[52:55], v10, s[44:47], 0 offen offset:1536 sc1
    s_mov_b64 exec, -1
    s_cmp_eq_u32 s59, 1
    s_waitcnt vmcnt(4)
    s_cbranch_scc1 .go_162
    v_or3_b32 v16, v40, v41, v42
    v_or3_b32 v36, v43, v44, v45
    v_or3_b32 v16, v16, v46, v47
    v_or3_b32 v36, v36, v48, v49
    v_or3_b32 v16, v16, v50, v51
    v_or3_b32 v36, v36, v52, v53
    v_or3_b32 v16, v16, v54, v55
    s_branch .gj_163
.go_162:
    v_bitop3_b32 v16, 0, v40, v41 bitop3:0xf7
    v_bitop3_b32 v36, 0, v42, v43 bitop3:0xf7
    v_bitop3_b32 v16, v16, v44, v45 bitop3:0xf7
    v_bitop3_b32 v36, v36, v46, v47 bitop3:0xf7
    v_bitop3_b32 v16, v16, v48, v49 bitop3:0xf7
    v_bitop3_b32 v36, v36, v50, v51 bitop3:0xf7
    v_bitop3_b32 v16, v16, v52, v53 bitop3:0xf7
    v_bitop3_b32 v36, v36, v54, v55 bitop3:0xf7
.gj_163:
    v_or_b32 v16, v16, v36
    v_and_b32 v16, 1, v16
    v_cmp_ne_u32 vcc, 0, v16
    s_nop 0
    s_cbranch_vccz .okg_158
    s_mov_b64 exec, vcc
    s_add_u32 s57, s57, 1
    s_cmp_lt_u32 s57, 3000000
    s_cbranch_scc1 .gr_161
    s_branch .abort_1
.okg_158:
    v_mfma_f32_16x16x32_bf16 v[56:59], v[40:43], v[24:27], 0
    v_mfma_f32_16x16x32_bf16 v[56:59], v[44:47], v[24:27], v[56:59]
    v_mfma_f32_16x16x32_bf16 v[56:59], v[48:51], v[24:27], v[56:59]
    v_mfma_f32_16x16x32_bf16 v[56:59], v[52:55], v[24:27], v[56:59]
    s_add_u32 s56, s54, 3
    s_and_b32 s56, s56, 3
    s_mul_i32 s56, s56, 10240
    s_add_u32 s56, s56, 0x5a00000
    v_mov_b32 v16, -1
    s_nop 2
    v_permlane32_swap_b32 v56, v58
    v_permlane32_swap_b32 v57, v59
    v_pk_add_f32 v[56:57], v[56:57], v[58:59]
    v_cvt_pk_bf16_f32 v56, v56, v57
    v_min_u32 v28, 0xfffffffe, v56
    v_min_u32 v29, 0xfffffffe, v56
    s_add_u32 s70, s54, 1
    s_and_b32 s70, s70, 3
    s_lshl_b32 s70, s70, 15
    s_add_u32 s70, s70, 0x5aa0000
    v_permlane32_swap_b32 v28, v29
    v_mov_b32 v30, v28
    v_mov_b32 v31, v29
    s_nop 0
    v_permlane16_swap_b32 v28, v30
    v_permlane16_swap_b32 v29, v31
    s_mov_b64 exec, 0xff
    buffer_store_dwordx4 v[28:31], v12, s[44:47], s55 offen sc1
    buffer_store_dwordx4 v[28:31], v18, s[44:47], s70 offen sc1
    v_mov_b32 v58, 15360
    v_mov_b32 v59, s54
    ds_write_b32 v58, v59
    s_mov_b64 exec, s[66:67]
    buffer_store_dword v16, v12, s[44:47], s56 offen sc1
    s_mov_b64 exec, -1
    s_branch .send_156
.idle_157:
    v_mov_b32 v40, 15360
    s_mov_b32 s57, 0
.il_164:
    ds_read_b32 v41, v40
    s_waitcnt lgkmcnt(0)
    v_readfirstlane_b32 s55, v41
    s_nop 0
    s_cmp_eq_u32 s55, s54
    s_cbranch_scc1 .send_156
    s_sleep 1
    s_add_u32 s57, s57, 1
    s_cmp_lt_u32 s57, 24000000
    s_cbranch_scc1 .il_164
    s_branch .abort_1
.gw3_155:
    s_add_u32 s55, s54, 3
    s_min_u32 s55, s55, 63
    s_cmp_lt_i32 s99, s55
    s_cbranch_scc0 .kvok_165
    v_mbcnt_lo_u32_b32 v36, -1, 0
    v_min_u32 v36, 7, v36
    v_lshlrev_b32 v36, 2, v36
    s_mov_b32 s57, 0
.kvl_166:
    global_load_dword v37, v36, s[38:39] offset:32 sc1
    s_waitcnt vmcnt(0)
    v_cmp_eq_u32 vcc, 0, v36
    v_lshrrev_b32 v38, 1, v37
    s_nop 0
    v_cndmask_b32 v37, v37, v38, vcc
    v_cmp_le_u32 vcc, 32, v37
    s_nop 0
    s_and_b32 s56, vcc_lo, 0xff
    s_ff0_i32_b32 s56, s56
    s_lshl_b32 s99, s56, 3
    s_sub_u32 s99, s99, 1
    s_cmp_lt_i32 s99, s55
    s_cbranch_scc0 .kvok_165
    s_sleep 4
    s_add_u32 s57, s57, 1
    s_cmp_lt_u32 s57, 3000000
    s_cbranch_scc1 .kvl_166
    s_branch .abort_1
.kvok_165:
.send_156:
    s_add_u32 s54, s54, 1
    s_branch .hstep_143
.hfin_118:
    s_branch .hdone_82
.hdone_82:
    s_branch .done_2
.vrole_5:
    v_and_b32 v1, 63, v0
    v_lshrrev_b32 v2, 6, v0
    s_nop 0
    v_readfirstlane_b32 s53, v2
    v_and_b32 v2, 8, v1
    v_cmp_ne_u32 s[60:61], 0, v2
    v_cmp_gt_u32 s[62:63], 32, v1
    v_cmp_gt_u32 s[64:65], 40, v1
    v_cmp_eq_u32 s[66:67], 0, v2
    s_cmp_eq_u32 s53, 1
    s_cselect_b64 s[88:89], -1, 0
    s_mov_b32 s44, s40
    s_and_b32 s45, s41, 0xffff
    s_mov_b32 s46, 0xfe00000
    s_mov_b32 s47, 0x00020000
    s_mov_b32 s72, s30
    s_and_b32 s73, s31, 0xffff
    s_mov_b32 s74, 0x500000
    s_mov_b32 s75, 0x00020000
    s_mov_b32 s76, s28
    s_and_b32 s77, s29, 0xffff
    s_mov_b32 s78, 0x500000
    s_mov_b32 s79, 0x00020000
    v_lshrrev_b32 v48, 4, v1
    s_lshl_b32 s55, s53, 4
    v_add_u32 v48, s55, v48
    v_and_b32 v50, 15, v1
    v_lshlrev_b32 v50, 4, v50
    v_mul_u32_u24 v49, 1280, v48
    v_add_u32 v49, v49, v50
    v_lshl_add_u32 v48, v48, 13, v50
    v_lshrrev_b32 v50, 5, v1
    v_lshlrev_b32 v50, 3, v50
    v_bfe_u32 v52, v1, 4, 1
    v_lshl_add_u32 v50, v52, 2, v50
    v_bfe_u32 v52, v1, 2, 1
    v_add_u32 v50, v52, v50
    v_lshlrev_b32 v50, 8, v50
    v_bfe_u32 v52, v1, 3, 1
    v_lshl_add_u32 v50, v52, 5, v50
    v_and_b32 v52, 3, v1
    v_lshl_add_u32 v50, v52, 3, v50
    s_lshl_b32 s55, s53, 6
    v_add_u32 v50, s55, v50
    v_lshrrev_b32 v51, 5, v1
    v_lshlrev_b32 v51, 2, v51
    v_bfe_u32 v52, v1, 4, 1
    v_lshl_add_u32 v51, v52, 4, v51
    v_bfe_u32 v52, v1, 2, 1
    v_add_u32 v51, v52, v51
    v_lshlrev_b32 v51, 8, v51
    v_bfe_u32 v52, v1, 3, 1
    v_lshl_add_u32 v51, v52, 5, v51
    v_and_b32 v52, 3, v1
    v_lshl_add_u32 v51, v52, 3, v51
    s_lshl_b32 s70, s52, 8
    s_mul_i32 s71, s52, 163840
    s_lshl_b32 s98, s53, 12
    s_add_u32 m0, s98, 0
    s_add_u32 s56, s70, 0
    buffer_load_dwordx4 v48, s[72:75], s56 offen lds
    s_add_u32 m0, s98, 1024
    s_add_u32 s56, s70, 32768
    buffer_load_dwordx4 v48, s[72:75], s56 offen lds
    s_add_u32 m0, s98, 2048
    s_add_u32 s56, s70, 65536
    buffer_load_dwordx4 v48, s[72:75], s56 offen lds
    s_add_u32 m0, s98, 3072
    s_add_u32 s56, s70, 98304
    buffer_load_dwordx4 v48, s[72:75], s56 offen lds
    s_add_u32 m0, s98, 16384
    s_add_u32 s56, s70, 524288
    buffer_load_dwordx4 v48, s[72:75], s56 offen lds
    s_add_u32 m0, s98, 17408
    s_add_u32 s56, s70, 557056
    buffer_load_dwordx4 v48, s[72:75], s56 offen lds
    s_add_u32 m0, s98, 18432
    s_add_u32 s56, s70, 589824
    buffer_load_dwordx4 v48, s[72:75], s56 offen lds
    s_add_u32 m0, s98, 19456
    s_add_u32 s56, s70, 622592
    buffer_load_dwordx4 v48, s[72:75], s56 offen lds
    s_add_u32 m0, s98, 32768
    s_add_u32 s56, s70, 1048576
    buffer_load_dwordx4 v48, s[72:75], s56 offen lds
    s_add_u32 m0, s98, 33792
    s_add_u32 s56, s70, 1081344
    buffer_load_dwordx4 v48, s[72:75], s56 offen lds
    s_add_u32 m0, s98, 34816
    s_add_u32 s56, s70, 1114112
    buffer_load_dwordx4 v48, s[72:75], s56 offen lds
    s_add_u32 m0, s98, 35840
    s_add_u32 s56, s70, 1146880
    buffer_load_dwordx4 v48, s[72:75], s56 offen lds
    s_add_u32 m0, s98, 49152
    s_add_u32 s56, s70, 1572864
    buffer_load_dwordx4 v48, s[72:75], s56 offen lds
    s_add_u32 m0, s98, 50176
    s_add_u32 s56, s70, 1605632
    buffer_load_dwordx4 v48, s[72:75], s56 offen lds
    s_add_u32 m0, s98, 51200
    s_add_u32 s56, s70, 1638400
    buffer_load_dwordx4 v48, s[72:75], s56 offen lds
    s_add_u32 m0, s98, 52224
    s_add_u32 s56, s70, 1671168
    buffer_load_dwordx4 v48, s[72:75], s56 offen lds
    s_add_u32 m0, s98, 65536
    s_add_u32 s56, s70, 2097152
    buffer_load_dwordx4 v48, s[72:75], s56 offen lds
    s_add_u32 m0, s98, 66560
    s_add_u32 s56, s70, 2129920
    buffer_load_dwordx4 v48, s[72:75], s56 offen lds
    s_add_u32 m0, s98, 67584
    s_add_u32 s56, s70, 2162688
    buffer_load_dwordx4 v48, s[72:75], s56 offen lds
    s_add_u32 m0, s98, 68608
    s_add_u32 s56, s70, 2195456
    buffer_load_dwordx4 v48, s[72:75], s56 offen lds
    s_add_u32 m0, s98, 81920
    s_add_u32 s56, s70, 2621440
    buffer_load_dwordx4 v48, s[72:75], s56 offen lds
    s_add_u32 m0, s98, 82944
    s_add_u32 s56, s70, 2654208
    buffer_load_dwordx4 v48, s[72:75], s56 offen lds
    s_add_u32 m0, s98, 83968
    s_add_u32 s56, s70, 2686976
    buffer_load_dwordx4 v48, s[72:75], s56 offen lds
    s_add_u32 m0, s98, 84992
    s_add_u32 s56, s70, 2719744
    buffer_load_dwordx4 v48, s[72:75], s56 offen lds
    s_add_u32 m0, s98, 98304
    s_add_u32 s56, s70, 3145728
    buffer_load_dwordx4 v48, s[72:75], s56 offen lds
    s_add_u32 m0, s98, 99328
    s_add_u32 s56, s70, 3178496
    buffer_load_dwordx4 v48, s[72:75], s56 offen lds
    s_add_u32 m0, s98, 100352
    s_add_u32 s56, s70, 3211264
    buffer_load_dwordx4 v48, s[72:75], s56 offen lds
    s_add_u32 m0, s98, 101376
    s_add_u32 s56, s70, 3244032
    buffer_load_dwordx4 v48, s[72:75], s56 offen lds
    s_add_u32 m0, s98, 114688
    s_add_u32 s56, s70, 3670016
    buffer_load_dwordx4 v48, s[72:75], s56 offen lds
    s_add_u32 m0, s98, 115712
    s_add_u32 s56, s70, 3702784
    buffer_load_dwordx4 v48, s[72:75], s56 offen lds
    s_add_u32 m0, s98, 116736
    s_add_u32 s56, s70, 3735552
    buffer_load_dwordx4 v48, s[72:75], s56 offen lds
    s_add_u32 m0, s98, 117760
    s_add_u32 s56, s70, 3768320
    buffer_load_dwordx4 v48, s[72:75], s56 offen lds
    s_add_u32 m0, s98, 131072
    s_add_u32 s56, s70, 4194304
    buffer_load_dwordx4 v48, s[72:75], s56 offen lds
    s_add_u32 m0, s98, 132096
    s_add_u32 s56, s70, 4227072
    buffer_load_dwordx4 v48, s[72:75], s56 offen lds
    s_add_u32 m0, s98, 133120
    s_add_u32 s56, s70, 4259840
    buffer_load_dwordx4 v48, s[72:75], s56 offen lds
    s_add_u32 m0, s98, 134144
    s_add_u32 s56, s70, 4292608
    buffer_load_dwordx4 v48, s[72:75], s56 offen lds
    s_waitcnt vmcnt(32) lgkmcnt(0)
    s_barrier
    v_add_u32 v52, 0, v50
    ds_read_b64_tr_b16 a[0:1], v52 offset:0
    ds_read_b64_tr_b16 a[2:3], v52 offset:512
    ds_read_b64_tr_b16 a[4:5], v52 offset:4096
    ds_read_b64_tr_b16 a[6:7], v52 offset:4608
    ds_read_b64_tr_b16 a[8:9], v52 offset:8192
    ds_read_b64_tr_b16 a[10:11], v52 offset:8704
    ds_read_b64_tr_b16 a[12:13], v52 offset:12288
    ds_read_b64_tr_b16 a[14:15], v52 offset:12800
    s_waitcnt vmcnt(28) lgkmcnt(0)
    s_barrier
    s_add_u32 m0, s98, 0
    s_add_u32 s56, s70, 4718592
    buffer_load_dwordx4 v48, s[72:75], s56 offen lds
    s_add_u32 m0, s98, 1024
    s_add_u32 s56, s70, 4751360
    buffer_load_dwordx4 v48, s[72:75], s56 offen lds
    s_add_u32 m0, s98, 2048
    s_add_u32 s56, s70, 4784128
    buffer_load_dwordx4 v48, s[72:75], s56 offen lds
    s_add_u32 m0, s98, 3072
    s_add_u32 s56, s70, 4816896
    buffer_load_dwordx4 v48, s[72:75], s56 offen lds
    v_add_u32 v52, 16384, v50
    ds_read_b64_tr_b16 a[16:17], v52 offset:0
    ds_read_b64_tr_b16 a[18:19], v52 offset:512
    ds_read_b64_tr_b16 a[20:21], v52 offset:4096
    ds_read_b64_tr_b16 a[22:23], v52 offset:4608
    ds_read_b64_tr_b16 a[24:25], v52 offset:8192
    ds_read_b64_tr_b16 a[26:27], v52 offset:8704
    ds_read_b64_tr_b16 a[28:29], v52 offset:12288
    ds_read_b64_tr_b16 a[30:31], v52 offset:12800
    s_waitcnt vmcnt(28) lgkmcnt(0)
    s_barrier
    s_add_u32 m0, s98, 16384
    s_add_u32 s56, s70, 0
    buffer_load_dwordx4 v48, s[76:79], s56 offen lds
    s_add_u32 m0, s98, 17408
    s_add_u32 s56, s70, 32768
    buffer_load_dwordx4 v48, s[76:79], s56 offen lds
    s_add_u32 m0, s98, 18432
    s_add_u32 s56, s70, 65536
    buffer_load_dwordx4 v48, s[76:79], s56 offen lds
    s_add_u32 m0, s98, 19456
    s_add_u32 s56, s70, 98304
    buffer_load_dwordx4 v48, s[76:79], s56 offen lds
    v_add_u32 v52, 32768, v50
    ds_read_b64_tr_b16 a[32:33], v52 offset:0
    ds_read_b64_tr_b16 a[34:35], v52 offset:512
    ds_read_b64_tr_b16 a[36:37], v52 offset:4096
    ds_read_b64_tr_b16 a[38:39], v52 offset:4608
    ds_read_b64_tr_b16 a[40:41], v52 offset:8192
    ds_read_b64_tr_b16 a[42:43], v52 offset:8704
    ds_read_b64_tr_b16 a[44:45], v52 offset:12288
    ds_read_b64_tr_b16 a[46:47], v52 offset:12800
    s_waitcnt vmcnt(28) lgkmcnt(0)
    s_barrier
    s_add_u32 m0, s98, 32768
    s_add_u32 s56, s70, 524288
    buffer_load_dwordx4 v48, s[76:79], s56 offen lds
    s_add_u32 m0, s98, 33792
    s_add_u32 s56, s70, 557056
    buffer_load_dwordx4 v48, s[76:79], s56 offen lds
    s_add_u32 m0, s98, 34816
    s_add_u32 s56, s70, 589824
    buffer_load_dwordx4 v48, s[76:79], s56 offen lds
    s_add_u32 m0, s98, 35840
    s_add_u32 s56, s70, 622592
    buffer_load_dwordx4 v48, s[76:79], s56 offen lds
    v_add_u32 v52, 49152, v50
    ds_read_b64_tr_b16 a[48:49], v52 offset:0
    ds_read_b64_tr_b16 a[50:51], v52 offset:512
    ds_read_b64_tr_b16 a[52:53], v52 offset:4096
    ds_read_b64_tr_b16 a[54:55], v52 offset:4608
    ds_read_b64_tr_b16 a[56:57], v52 offset:8192
    ds_read_b64_tr_b16 a[58:59], v52 offset:8704
    ds_read_b64_tr_b16 a[60:61], v52 offset:12288
    ds_read_b64_tr_b16 a[62:63], v52 offset:12800
    s_waitcnt vmcnt(28) lgkmcnt(0)
    s_barrier
    s_add_u32 m0, s98, 49152
    s_add_u32 s56, s70, 1048576
    buffer_load_dwordx4 v48, s[76:79], s56 offen lds
    s_add_u32 m0, s98, 50176
    s_add_u32 s56, s70, 1081344
    buffer_load_dwordx4 v48, s[76:79], s56 offen lds
    s_add_u32 m0, s98, 51200
    s_add_u32 s56, s70, 1114112
    buffer_load_dwordx4 v48, s[76:79], s56 offen lds
    s_add_u32 m0, s98, 52224
    s_add_u32 s56, s70, 1146880
    buffer_load_dwordx4 v48, s[76:79], s56 offen lds
    v_add_u32 v52, 65536, v50
    ds_read_b64_tr_b16 a[64:65], v52 offset:0
    ds_read_b64_tr_b16 a[66:67], v52 offset:512
    ds_read_b64_tr_b16 a[68:69], v52 offset:4096
    ds_read_b64_tr_b16 a[70:71], v52 offset:4608
    ds_read_b64_tr_b16 a[72:73], v52 offset:8192
    ds_read_b64_tr_b16 a[74:75], v52 offset:8704
    ds_read_b64_tr_b16 a[76:77], v52 offset:12288
    ds_read_b64_tr_b16 a[78:79], v52 offset:12800
    s_waitcnt vmcnt(28) lgkmcnt(0)
    s_barrier
    s_add_u32 m0, s98, 65536
    s_add_u32 s56, s70, 1572864
    buffer_load_dwordx4 v48, s[76:79], s56 offen lds
    s_add_u32 m0, s98, 66560
    s_add_u32 s56, s70, 1605632
    buffer_load_dwordx4 v48, s[76:79], s56 offen lds
    s_add_u32 m0, s98, 67584
    s_add_u32 s56, s70, 1638400
    buffer_load_dwordx4 v48, s[76:79], s56 offen lds
    s_add_u32 m0, s98, 68608
    s_add_u32 s56, s70, 1671168
    buffer_load_dwordx4 v48, s[76:79], s56 offen lds
    v_add_u32 v52, 81920, v50
    ds_read_b64_tr_b16 a[80:81], v52 offset:0
    ds_read_b64_tr_b16 a[82:83], v52 offset:512
    ds_read_b64_tr_b16 a[84:85], v52 offset:4096
    ds_read_b64_tr_b16 a[86:87], v52 offset:4608
    ds_read_b64_tr_b16 a[88:89], v52 offset:8192
    ds_read_b64_tr_b16 a[90:91], v52 offset:8704
    ds_read_b64_tr_b16 a[92:93], v52 offset:12288
    ds_read_b64_tr_b16 a[94:95], v52 offset:12800
    s_waitcnt vmcnt(28) lgkmcnt(0)
    s_barrier
    s_add_u32 m0, s98, 81920
    s_add_u32 s56, s70, 2097152
    buffer_load_dwordx4 v48, s[76:79], s56 offen lds
    s_add_u32 m0, s98, 82944
    s_add_u32 s56, s70, 2129920
    buffer_load_dwordx4 v48, s[76:79], s56 offen lds
    s_add_u32 m0, s98, 83968
    s_add_u32 s56, s70, 2162688
    buffer_load_dwordx4 v48, s[76:79], s56 offen lds
    s_add_u32 m0, s98, 84992
    s_add_u32 s56, s70, 2195456
    buffer_load_dwordx4 v48, s[76:79], s56 offen lds
    v_add_u32 v52, 98304, v50
    ds_read_b64_tr_b16 a[96:97], v52 offset:0
    ds_read_b64_tr_b16 a[98:99], v52 offset:512
    ds_read_b64_tr_b16 a[100:101], v52 offset:4096
    ds_read_b64_tr_b16 a[102:103], v52 offset:4608
    ds_read_b64_tr_b16 a[104:105], v52 offset:8192
    ds_read_b64_tr_b16 a[106:107], v52 offset:8704
    ds_read_b64_tr_b16 a[108:109], v52 offset:12288
    ds_read_b64_tr_b16 a[110:111], v52 offset:12800
    s_waitcnt vmcnt(28) lgkmcnt(0)
    s_barrier
    s_add_u32 m0, s98, 98304
    s_add_u32 s56, s70, 2621440
    buffer_load_dwordx4 v48, s[76:79], s56 offen lds
    s_add_u32 m0, s98, 99328
    s_add_u32 s56, s70, 2654208
    buffer_load_dwordx4 v48, s[76:79], s56 offen lds
    s_add_u32 m0, s98, 100352
    s_add_u32 s56, s70, 2686976
    buffer_load_dwordx4 v48, s[76:79], s56 offen lds
    s_add_u32 m0, s98, 101376
    s_add_u32 s56, s70, 2719744
    buffer_load_dwordx4 v48, s[76:79], s56 offen lds
    v_add_u32 v52, 114688, v50
    ds_read_b64_tr_b16 a[112:113], v52 offset:0
    ds_read_b64_tr_b16 a[114:115], v52 offset:512
    ds_read_b64_tr_b16 a[116:117], v52 offset:4096
    ds_read_b64_tr_b16 a[118:119], v52 offset:4608
    ds_read_b64_tr_b16 a[120:121], v52 offset:8192
    ds_read_b64_tr_b16 a[122:123], v52 offset:8704
    ds_read_b64_tr_b16 a[124:125], v52 offset:12288
    ds_read_b64_tr_b16 a[126:127], v52 offset:12800
    s_waitcnt vmcnt(28) lgkmcnt(0)
    s_barrier
    s_add_u32 m0, s98, 114688
    s_add_u32 s56, s70, 3145728
    buffer_load_dwordx4 v48, s[76:79], s56 offen lds
    s_add_u32 m0, s98, 115712
    s_add_u32 s56, s70, 3178496
    buffer_load_dwordx4 v48, s[76:79], s56 offen lds
    s_add_u32 m0, s98, 116736
    s_add_u32 s56, s70, 3211264
    buffer_load_dwordx4 v48, s[76:79], s56 offen lds
    s_add_u32 m0, s98, 117760
    s_add_u32 s56, s70, 3244032
    buffer_load_dwordx4 v48, s[76:79], s56 offen lds
    v_add_u32 v52, 131072, v50
    ds_read_b64_tr_b16 a[128:129], v52 offset:0
    ds_read_b64_tr_b16 a[130:131], v52 offset:512
    ds_read_b64_tr_b16 a[132:133], v52 offset:4096
    ds_read_b64_tr_b16 a[134:135], v52 offset:4608
    ds_read_b64_tr_b16 a[136:137], v52 offset:8192
    ds_read_b64_tr_b16 a[138:139], v52 offset:8704
    ds_read_b64_tr_b16 a[140:141], v52 offset:12288
    ds_read_b64_tr_b16 a[142:143], v52 offset:12800
    s_waitcnt vmcnt(28) lgkmcnt(0)
    s_barrier
    s_add_u32 m0, s98, 131072
    s_add_u32 s56, s70, 3670016
    buffer_load_dwordx4 v48, s[76:79], s56 offen lds
    s_add_u32 m0, s98, 132096
    s_add_u32 s56, s70, 3702784
    buffer_load_dwordx4 v48, s[76:79], s56 offen lds
    s_add_u32 m0, s98, 133120
    s_add_u32 s56, s70, 3735552
    buffer_load_dwordx4 v48, s[76:79], s56 offen lds
    s_add_u32 m0, s98, 134144
    s_add_u32 s56, s70, 3768320
    buffer_load_dwordx4 v48, s[76:79], s56 offen lds
    v_add_u32 v52, 0, v50
    ds_read_b64_tr_b16 a[144:145], v52 offset:0
    ds_read_b64_tr_b16 a[146:147], v52 offset:512
    ds_read_b64_tr_b16 a[148:149], v52 offset:4096
    ds_read_b64_tr_b16 a[150:151], v52 offset:4608
    ds_read_b64_tr_b16 a[152:153], v52 offset:8192
    ds_read_b64_tr_b16 a[154:155], v52 offset:8704
    ds_read_b64_tr_b16 a[156:157], v52 offset:12288
    ds_read_b64_tr_b16 a[158:159], v52 offset:12800
    s_waitcnt vmcnt(28) lgkmcnt(0)
    s_barrier
    s_add_u32 m0, s98, 0
    s_add_u32 s56, s70, 4194304
    buffer_load_dwordx4 v48, s[76:79], s56 offen lds
    s_add_u32 m0, s98, 1024
    s_add_u32 s56, s70, 4227072
    buffer_load_dwordx4 v48, s[76:79], s56 offen lds
    s_add_u32 m0, s98, 2048
    s_add_u32 s56, s70, 4259840
    buffer_load_dwordx4 v48, s[76:79], s56 offen lds
    s_add_u32 m0, s98, 3072
    s_add_u32 s56, s70, 4292608
    buffer_load_dwordx4 v48, s[76:79], s56 offen lds
    v_add_u32 v52, 16384, v50
    ds_read_b64_tr_b16 a[160:161], v52 offset:0
    ds_read_b64_tr_b16 a[162:163], v52 offset:512
    ds_read_b64_tr_b16 a[164:165], v52 offset:4096
    ds_read_b64_tr_b16 a[166:167], v52 offset:4608
    ds_read_b64_tr_b16 a[168:169], v52 offset:8192
    ds_read_b64_tr_b16 a[170:171], v52 offset:8704
    ds_read_b64_tr_b16 a[172:173], v52 offset:12288
    ds_read_b64_tr_b16 a[174:175], v52 offset:12800
    s_waitcnt vmcnt(28) lgkmcnt(0)
    s_barrier
    s_add_u32 m0, s98, 16384
    s_add_u32 s56, s70, 4718592
    buffer_load_dwordx4 v48, s[76:79], s56 offen lds
    s_add_u32 m0, s98, 17408
    s_add_u32 s56, s70, 4751360
    buffer_load_dwordx4 v48, s[76:79], s56 offen lds
    s_add_u32 m0, s98, 18432
    s_add_u32 s56, s70, 4784128
    buffer_load_dwordx4 v48, s[76:79], s56 offen lds
    s_add_u32 m0, s98, 19456
    s_add_u32 s56, s70, 4816896
    buffer_load_dwordx4 v48, s[76:79], s56 offen lds
    v_add_u32 v52, 32768, v50
    ds_read_b64_tr_b16 a[176:177], v52 offset:0
    ds_read_b64_tr_b16 a[178:179], v52 offset:512
    ds_read_b64_tr_b16 a[180:181], v52 offset:4096
    ds_read_b64_tr_b16 a[182:183], v52 offset:4608
    ds_read_b64_tr_b16 a[184:185], v52 offset:8192
    ds_read_b64_tr_b16 a[186:187], v52 offset:8704
    ds_read_b64_tr_b16 a[188:189], v52 offset:12288
    ds_read_b64_tr_b16 a[190:191], v52 offset:12800
    s_waitcnt vmcnt(28) lgkmcnt(0)
    s_barrier
    v_add_u32 v52, 49152, v50
    ds_read_b64_tr_b16 a[192:193], v52 offset:0
    ds_read_b64_tr_b16 a[194:195], v52 offset:512
    ds_read_b64_tr_b16 a[196:197], v52 offset:4096
    ds_read_b64_tr_b16 a[198:199], v52 offset:4608
    ds_read_b64_tr_b16 a[200:201], v52 offset:8192
    ds_read_b64_tr_b16 a[202:203], v52 offset:8704
    ds_read_b64_tr_b16 a[204:205], v52 offset:12288
    ds_read_b64_tr_b16 a[206:207], v52 offset:12800
    s_waitcnt vmcnt(24) lgkmcnt(0)
    s_barrier
    v_add_u32 v52, 65536, v50
    ds_read_b64_tr_b16 a[208:209], v52 offset:0
    ds_read_b64_tr_b16 a[210:211], v52 offset:512
    ds_read_b64_tr_b16 a[212:213], v52 offset:4096
    ds_read_b64_tr_b16 a[214:215], v52 offset:4608
    ds_read_b64_tr_b16 a[216:217], v52 offset:8192
    ds_read_b64_tr_b16 a[218:219], v52 offset:8704
    ds_read_b64_tr_b16 a[220:221], v52 offset:12288
    ds_read_b64_tr_b16 a[222:223], v52 offset:12800
    s_waitcnt vmcnt(20) lgkmcnt(0)
    s_barrier
    v_add_u32 v52, 81920, v50
    ds_read_b64_tr_b16 a[224:225], v52 offset:0
    ds_read_b64_tr_b16 a[226:227], v52 offset:512
    ds_read_b64_tr_b16 a[228:229], v52 offset:4096
    ds_read_b64_tr_b16 a[230:231], v52 offset:4608
    ds_read_b64_tr_b16 a[232:233], v52 offset:8192
    ds_read_b64_tr_b16 a[234:235], v52 offset:8704
    ds_read_b64_tr_b16 a[236:237], v52 offset:12288
    ds_read_b64_tr_b16 a[238:239], v52 offset:12800
    s_waitcnt vmcnt(16) lgkmcnt(0)
    s_barrier
    v_add_u32 v52, 98304, v50
    ds_read_b64_tr_b16 a[240:241], v52 offset:0
    ds_read_b64_tr_b16 a[242:243], v52 offset:512
    ds_read_b64_tr_b16 a[244:245], v52 offset:4096
    ds_read_b64_tr_b16 a[246:247], v52 offset:4608
    ds_read_b64_tr_b16 a[248:249], v52 offset:8192
    ds_read_b64_tr_b16 a[250:251], v52 offset:8704
    ds_read_b64_tr_b16 a[252:253], v52 offset:12288
    ds_read_b64_tr_b16 a[254:255], v52 offset:12800
    s_waitcnt vmcnt(12) lgkmcnt(0)
    s_barrier
    v_add_u32 v52, 114688, v50
    ds_read_b64_tr_b16 v[192:193], v52 offset:0
    ds_read_b64_tr_b16 v[194:195], v52 offset:512
    ds_read_b64_tr_b16 v[196:197], v52 offset:4096
    ds_read_b64_tr_b16 v[198:199], v52 offset:4608
    ds_read_b64_tr_b16 v[200:201], v52 offset:8192
    ds_read_b64_tr_b16 v[202:203], v52 offset:8704
    ds_read_b64_tr_b16 v[204:205], v52 offset:12288
    ds_read_b64_tr_b16 v[206:207], v52 offset:12800
    s_waitcnt vmcnt(8) lgkmcnt(0)
    s_barrier
    v_add_u32 v52, 131072, v50
    ds_read_b64_tr_b16 v[208:209], v52 offset:0
    ds_read_b64_tr_b16 v[210:211], v52 offset:512
    ds_read_b64_tr_b16 v[212:213], v52 offset:4096
    ds_read_b64_tr_b16 v[214:215], v52 offset:4608
    ds_read_b64_tr_b16 v[216:217], v52 offset:8192
    ds_read_b64_tr_b16 v[218:219], v52 offset:8704
    ds_read_b64_tr_b16 v[220:221], v52 offset:12288
    ds_read_b64_tr_b16 v[222:223], v52 offset:12800
    s_waitcnt vmcnt(4) lgkmcnt(0)
    s_barrier
    v_add_u32 v52, 0, v50
    ds_read_b64_tr_b16 v[224:225], v52 offset:0
    ds_read_b64_tr_b16 v[226:227], v52 offset:512
    ds_read_b64_tr_b16 v[228:229], v52 offset:4096
    ds_read_b64_tr_b16 v[230:231], v52 offset:4608
    ds_read_b64_tr_b16 v[232:233], v52 offset:8192
    ds_read_b64_tr_b16 v[234:235], v52 offset:8704
    ds_read_b64_tr_b16 v[236:237], v52 offset:12288
    ds_read_b64_tr_b16 v[238:239], v52 offset:12800
    s_waitcnt vmcnt(0) lgkmcnt(0)
    s_barrier
    v_add_u32 v52, 16384, v50
    ds_read_b64_tr_b16 v[240:241], v52 offset:0
    ds_read_b64_tr_b16 v[242:243], v52 offset:512
    ds_read_b64_tr_b16 v[244:245], v52 offset:4096
    ds_read_b64_tr_b16 v[246:247], v52 offset:4608
    ds_read_b64_tr_b16 v[248:249], v52 offset:8192
    ds_read_b64_tr_b16 v[250:251], v52 offset:8704
    ds_read_b64_tr_b16 v[252:253], v52 offset:12288
    ds_read_b64_tr_b16 v[254:255], v52 offset:12800
    s_waitcnt lgkmcnt(0)
    s_barrier
    s_cmp_lg_u32 s52, 0
    s_cbranch_scc1 .nm_169
    s_cmp_lg_u32 s53, 0
    s_cbranch_scc1 .nm_169
    v_mov_b32 v2, 16
    global_load_dword v3, v2, s[38:39] sc1
    s_waitcnt vmcnt(0)
    v_readfirstlane_b32 s55, v3
    s_nop 0
    s_cmp_lg_u32 s55, 0
    s_cbranch_scc1 .nm_169
    s_mov_b64 exec, 1
    v_mov_b32 v3, 0
    s_mov_b32 s70, -1
    s_mov_b32 s71, -1
    v_mov_b32 v2, 0x5aa1f80
    s_memtime s[4:5]
    s_waitcnt lgkmcnt(0)
    global_atomic_add v4, v2, v3, s[40:41] sc0
    s_waitcnt vmcnt(0)
    s_memtime s[6:7]
    s_waitcnt lgkmcnt(0)
    s_sub_u32 s6, s6, s4
    s_min_u32 s70, s70, s6
    v_mov_b32 v2, 0x5aa3f80
    s_memtime s[4:5]
    s_waitcnt lgkmcnt(0)
    global_atomic_add v4, v2, v3, s[40:41] sc0
    s_waitcnt vmcnt(0)
    s_memtime s[6:7]
    s_waitcnt lgkmcnt(0)
    s_sub_u32 s6, s6, s4
    s_min_u32 s71, s71, s6
    v_mov_b32 v2, 0x5aa1b80
    s_memtime s[4:5]
    s_waitcnt lgkmcnt(0)
    global_atomic_add v4, v2, v3, s[40:41] sc0
    s_waitcnt vmcnt(0)
    s_memtime s[6:7]
    s_waitcnt lgkmcnt(0)
    s_sub_u32 s6, s6, s4
    s_min_u32 s70, s70, s6
    v_mov_b32 v2, 0x5aa3b80
    s_memtime s[4:5]
    s_waitcnt lgkmcnt(0)
    global_atomic_add v4, v2, v3, s[40:41] sc0
    s_waitcnt vmcnt(0)
    s_memtime s[6:7]
    s_waitcnt lgkmcnt(0)
    s_sub_u32 s6, s6, s4
    s_min_u32 s71, s71, s6
    v_mov_b32 v2, 0x5aa1780
    s_memtime s[4:5]
    s_waitcnt lgkmcnt(0)
    global_atomic_add v4, v2, v3, s[40:41] sc0
    s_waitcnt vmcnt(0)
    s_memtime s[6:7]
    s_waitcnt lgkmcnt(0)
    s_sub_u32 s6, s6, s4
    s_min_u32 s70, s70, s6
    v_mov_b32 v2, 0x5aa3780
    s_memtime s[4:5]
    s_waitcnt lgkmcnt(0)
    global_atomic_add v4, v2, v3, s[40:41] sc0
    s_waitcnt vmcnt(0)
    s_memtime s[6:7]
    s_waitcnt lgkmcnt(0)
    s_sub_u32 s6, s6, s4
    s_min_u32 s71, s71, s6
    v_mov_b32 v2, 0x5aa1380
    s_memtime s[4:5]
    s_waitcnt lgkmcnt(0)
    global_atomic_add v4, v2, v3, s[40:41] sc0
    s_waitcnt vmcnt(0)
    s_memtime s[6:7]
    s_waitcnt lgkmcnt(0)
    s_sub_u32 s6, s6, s4
    s_min_u32 s70, s70, s6
    v_mov_b32 v2, 0x5aa3380
    s_memtime s[4:5]
    s_waitcnt lgkmcnt(0)
    global_atomic_add v4, v2, v3, s[40:41] sc0
    s_waitcnt vmcnt(0)
    s_memtime s[6:7]
    s_waitcnt lgkmcnt(0)
    s_sub_u32 s6, s6, s4
    s_min_u32 s71, s71, s6
    v_mov_b32 v2, 0x5aa1f80
    s_memtime s[4:5]
    s_waitcnt lgkmcnt(0)
    global_atomic_add v4, v2, v3, s[40:41] sc0
    s_waitcnt vmcnt(0)
    s_memtime s[6:7]
    s_waitcnt lgkmcnt(0)
    s_sub_u32 s6, s6, s4
    s_min_u32 s70, s70, s6
    v_mov_b32 v2, 0x5aa3f80
    s_memtime s[4:5]
    s_waitcnt lgkmcnt(0)
    global_atomic_add v4, v2, v3, s[40:41] sc0
    s_waitcnt vmcnt(0)
    s_memtime s[6:7]
    s_waitcnt lgkmcnt(0)
    s_sub_u32 s6, s6, s4
    s_min_u32 s71, s71, s6
    v_mov_b32 v2, 0x5aa1b80
    s_memtime s[4:5]
    s_waitcnt lgkmcnt(0)
    global_atomic_add v4, v2, v3, s[40:41] sc0
    s_waitcnt vmcnt(0)
    s_memtime s[6:7]
    s_waitcnt lgkmcnt(0)
    s_sub_u32 s6, s6, s4
    s_min_u32 s70, s70, s6
    v_mov_b32 v2, 0x5aa3b80
    s_memtime s[4:5]
    s_waitcnt lgkmcnt(0)
    global_atomic_add v4, v2, v3, s[40:41] sc0
    s_waitcnt vmcnt(0)
    s_memtime s[6:7]
    s_waitcnt lgkmcnt(0)
    s_sub_u32 s6, s6, s4
    s_min_u32 s71, s71, s6
    v_mov_b32 v2, 0x5aa1780
    s_memtime s[4:5]
    s_waitcnt lgkmcnt(0)
    global_atomic_add v4, v2, v3, s[40:41] sc0
    s_waitcnt vmcnt(0)
    s_memtime s[6:7]
    s_waitcnt lgkmcnt(0)
    s_sub_u32 s6, s6, s4
    s_min_u32 s70, s70, s6
    v_mov_b32 v2, 0x5aa3780
    s_memtime s[4:5]
    s_waitcnt lgkmcnt(0)
    global_atomic_add v4, v2, v3, s[40:41] sc0
    s_waitcnt vmcnt(0)
    s_memtime s[6:7]
    s_waitcnt lgkmcnt(0)
    s_sub_u32 s6, s6, s4
    s_min_u32 s71, s71, s6
    v_mov_b32 v2, 0x5aa1380
    s_memtime s[4:5]
    s_waitcnt lgkmcnt(0)
    global_atomic_add v4, v2, v3, s[40:41] sc0
    s_waitcnt vmcnt(0)
    s_memtime s[6:7]
    s_waitcnt lgkmcnt(0)
    s_sub_u32 s6, s6, s4
    s_min_u32 s70, s70, s6
    v_mov_b32 v2, 0x5aa3380
    s_memtime s[4:5]
    s_waitcnt lgkmcnt(0)
    global_atomic_add v4, v2, v3, s[40:41] sc0
    s_waitcnt vmcnt(0)
    s_memtime s[6:7]
    s_waitcnt lgkmcnt(0)
    s_sub_u32 s6, s6, s4
    s_min_u32 s71, s71, s6
    v_mov_b32 v2, 0x5aa1f80
    s_memtime s[4:5]
    s_waitcnt lgkmcnt(0)
    global_atomic_add v4, v2, v3, s[40:41] sc0
    s_waitcnt vmcnt(0)
    s_memtime s[6:7]
    s_waitcnt lgkmcnt(0)
    s_sub_u32 s6, s6, s4
    s_min_u32 s70, s70, s6
    v_mov_b32 v2, 0x5aa3f80
    s_memtime s[4:5]
    s_waitcnt lgkmcnt(0)
    global_atomic_add v4, v2, v3, s[40:41] sc0
    s_waitcnt vmcnt(0)
    s_memtime s[6:7]
    s_waitcnt lgkmcnt(0)
    s_sub_u32 s6, s6, s4
    s_min_u32 s71, s71, s6
    v_mov_b32 v2, 0x5aa1b80
    s_memtime s[4:5]
    s_waitcnt lgkmcnt(0)
    global_atomic_add v4, v2, v3, s[40:41] sc0
    s_waitcnt vmcnt(0)
    s_memtime s[6:7]
    s_waitcnt lgkmcnt(0)
    s_sub_u32 s6, s6, s4
    s_min_u32 s70, s70, s6
    v_mov_b32 v2, 0x5aa3b80
    s_memtime s[4:5]
    s_waitcnt lgkmcnt(0)
    global_atomic_add v4, v2, v3, s[40:41] sc0
    s_waitcnt vmcnt(0)
    s_memtime s[6:7]
    s_waitcnt lgkmcnt(0)
    s_sub_u32 s6, s6, s4
    s_min_u32 s71, s71, s6
    s_cmp_lt_u32 s71, s70
    s_cselect_b32 s55, 2, 1
    v_mov_b32 v2, 16
    v_mov_b32 v4, s55
    v_mov_b32 v5, 0
    global_atomic_cmpswap v2, v[4:5], s[38:39]
    s_mov_b64 exec, -1
.nm_169:
    v_mbcnt_lo_u32_b32 v2, -1, 0
    v_min_u32 v2, 31, v2
    v_lshlrev_b32 v2, 2, v2
    s_mov_b32 s57, 0
.sw_167:
    global_load_dword v3, v2, s[38:39] sc1
    s_waitcnt vmcnt(0)
    v_readlane_b32 s55, v3, 29
    v_readlane_b32 s56, v3, 0
    v_readlane_b32 s70, v3, 8
    v_readlane_b32 s71, v3, 2
    s_cmp_ge_u32 s55, 34
    s_cselect_b32 s55, 1, 0
    v_readlane_b32 s85, v3, 4
    s_nop 0
    s_cmp_lg_u32 s85, 0
    s_cselect_b32 s55, s55, 0
    s_cmp_eq_u32 s55, 1
    s_cbranch_scc1 .swo_168
    s_sleep 4
    s_add_u32 s57, s57, 1
    s_cmp_lt_u32 s57, 3000000
    s_cbranch_scc1 .sw_167
    s_branch .abort_1
.swo_168:
    s_and_b32 s85, s85, 3
    s_sub_u32 s85, s85, 1
    s_lshl_b32 s85, s85, 13
    v_mov_b32 v3, 0x4444
    v_mov_b32 v2, 0xeeee
    v_cndmask_b32 v3, v3, v2, s[60:61]
    v_lshlrev_b32 v4, 4, v1
    v_and_b32 v2, 7, v1
    v_lshlrev_b32 v2, 4, v2
    v_lshrrev_b32 v24, 4, v1
    v_lshl_add_u32 v13, v24, 7, v2
    v_lshrrev_b32 v2, 5, v1
    v_lshlrev_b32 v2, 4, v2
    v_and_b32 v24, 15, v1
    v_add_u32 v2, v2, v24
    s_lshl_b32 s55, s53, 5
    v_add_u32 v2, s55, v2
    v_lshlrev_b32 v2, 4, v2
    v_bfe_u32 v24, v1, 4, 1
    v_lshl_add_u32 v2, v24, 3, v2
    v_add_u32 v7, 12288, v2
    v_lshrrev_b32 v2, 4, v1
    v_lshlrev_b32 v2, 3, v2
    v_bfe_u32 v24, v1, 2, 2
    v_add_u32 v2, v2, v24
    v_lshlrev_b32 v2, 4, v2
    v_and_b32 v24, 1, v1
    v_lshl_add_u32 v2, v24, 3, v2
    s_lshl_b32 s55, s53, 9
    s_add_u32 s55, s55, 12288
    v_add_u32 v8, s55, v2
    v_and_b32 v2, 15, v1
    v_lshlrev_b32 v2, 8, v2
    v_lshrrev_b32 v24, 4, v1
    v_lshl_add_u32 v2, v24, 4, v2
    s_lshl_b32 s55, s52, 11
    s_lshl_b32 s56, s53, 6
    s_add_u32 s55, s55, s56
    s_add_u32 s55, s55, 0x4000000
    v_add_u32 v9, s55, v2
    s_lshl_b32 s55, s52, 11
    s_lshl_b32 s56, s53, 9
    s_add_u32 s55, s55, s56
    v_lshlrev_b32 v2, 3, v1
    v_add_u32 v6, s55, v2
    v_lshrrev_b32 v2, 5, v1
    v_lshlrev_b32 v2, 4, v2
    v_and_b32 v24, 15, v1
    v_add_u32 v2, v2, v24
    v_lshlrev_b32 v2, 4, v2
    s_lshr_b32 s55, s52, 2
    s_lshl_b32 s55, s55, 14
    s_and_b32 s56, s52, 3
    s_lshl_b32 s56, s56, 11
    s_add_u32 s55, s55, s56
    s_add_u32 s55, s55, s85
    s_lshl_b32 s56, s53, 9
    s_add_u32 s55, s55, s56
    v_add_u32 v14, s55, v2
    v_lshlrev_b32 v2, 3, v1
    v_add_u32 v15, s55, v2
    v_and_b32 v24, 16, v1
    v_cmp_eq_u32 s[72:73], 0, v24
    v_mov_b32 v20, -1
    v_mov_b32 v21, -1
    s_mov_b32 s54, 0
    s_barrier
.vstep_170:
    v_mov_b32 v112, 0
    v_mov_b32 v113, 0
    v_mov_b32 v114, 0
    v_mov_b32 v115, 0
    v_mov_b32 v116, 0
    v_mov_b32 v117, 0
    v_mov_b32 v118, 0
    v_mov_b32 v119, 0
    v_mov_b32 v120, 0
    v_mov_b32 v121, 0
    v_mov_b32 v122, 0
    v_mov_b32 v123, 0
    v_mov_b32 v124, 0
    v_mov_b32 v125, 0
    v_mov_b32 v126, 0
    v_mov_b32 v127, 0
    s_cmp_ge_u32 s53, 3
    s_cbranch_scc1 .nomp_171
    s_mul_i32 s56, s53, 7
    s_lshr_b32 s56, s56, 1
    s_lshl_b32 s56, s56, 10
    s_and_b32 s55, s54, 3
    s_mul_i32 s55, s55, 10240
    s_add_u32 s55, s55, s56
    s_add_u32 s55, s55, 0x5a10000
    s_and_b32 s55, s54, 3
    s_lshl_b32 s55, s55, 15
    s_add_u32 s55, s55, s85
    s_add_u32 s55, s55, 0x5aa0000
    s_add_u32 s74, s56, 0
    s_and_b32 s78, s74, 8192
    s_add_u32 s74, s74, s78
    s_add_u32 s74, s74, s55
    s_add_u32 s75, s56, 1024
    s_and_b32 s78, s75, 8192
    s_add_u32 s75, s75, s78
    s_add_u32 s75, s75, s55
    s_add_u32 s76, s56, 2048
    s_and_b32 s78, s76, 8192
    s_add_u32 s76, s76, s78
    s_add_u32 s76, s76, s55
    s_add_u32 s77, s56, 3072
    s_and_b32 s78, s77, 8192
    s_add_u32 s77, s77, s78
    s_add_u32 s77, s77, s55
    s_mov_b32 s57, 0
    s_cmp_eq_u32 s53, 1
    s_cbranch_scc1 .m4_172
    buffer_load_dwordx4 v[128:131], v4, s[44:47], s74 offen sc1
    buffer_load_dwordx4 v[132:135], v4, s[44:47], s75 offen sc1
    buffer_load_dwordx4 v[136:139], v4, s[44:47], s76 offen sc1
    s_waitcnt vmcnt(0)
    v_max3_u32 v24, v128, v129, v130
    v_max3_u32 v25, v131, v132, v133
    v_max3_u32 v24, v24, v134, v135
    v_max3_u32 v25, v25, v136, v137
    v_max3_u32 v24, v24, v138, v139
    v_max_u32 v24, v24, v25
    v_cmp_eq_u32 vcc, -1, v24
    s_nop 0
    s_cbranch_vccz .ok_174
    s_mov_b64 exec, vcc
    buffer_load_dwordx4 v[128:131], v4, s[44:47], s74 offen sc1
    buffer_load_dwordx4 v[132:135], v4, s[44:47], s75 offen sc1
    buffer_load_dwordx4 v[136:139], v4, s[44:47], s76 offen sc1
.mp_175:
    buffer_load_dwordx4 v[128:131], v4, s[44:47], s74 offen sc1
    buffer_load_dwordx4 v[132:135], v4, s[44:47], s75 offen sc1
    buffer_load_dwordx4 v[136:139], v4, s[44:47], s76 offen sc1
    s_mov_b64 exec, -1
    s_waitcnt vmcnt(3)
    v_max3_u32 v24, v128, v129, v130
    v_max3_u32 v25, v131, v132, v133
    v_max3_u32 v24, v24, v134, v135
    v_max3_u32 v25, v25, v136, v137
    v_max3_u32 v24, v24, v138, v139
    v_max_u32 v24, v24, v25
    v_cmp_eq_u32 vcc, -1, v24
    s_nop 0
    s_cbranch_vccz .ok_174
    s_mov_b64 exec, vcc
    s_add_u32 s57, s57, 1
    s_cmp_lt_u32 s57, 3000000
    s_cbranch_scc1 .mp_175
    s_branch .abort_1
.ok_174:
    v_add_u32 v25, s56, v4
    ds_write_b128 v25, v[128:131] offset:0
    ds_write_b128 v25, v[132:135] offset:1024
    ds_write_b128 v25, v[136:139] offset:2048
    s_branch .mj_173
.m4_172:
    buffer_load_dwordx4 v[128:131], v4, s[44:47], s74 offen sc1
    buffer_load_dwordx4 v[132:135], v4, s[44:47], s75 offen sc1
    buffer_load_dwordx4 v[136:139], v4, s[44:47], s76 offen sc1
    buffer_load_dwordx4 v[140:143], v4, s[44:47], s77 offen sc1
    s_waitcnt vmcnt(0)
    v_max3_u32 v24, v128, v129, v130
    v_max3_u32 v25, v131, v132, v133
    v_max3_u32 v24, v24, v134, v135
    v_max3_u32 v25, v25, v136, v137
    v_max3_u32 v24, v24, v138, v139
    v_max3_u32 v25, v25, v140, v141
    v_max3_u32 v24, v24, v142, v143
    v_max_u32 v24, v24, v25
    v_cmp_eq_u32 vcc, -1, v24
    s_nop 0
    s_cbranch_vccz .ok_176
    s_mov_b64 exec, vcc
    buffer_load_dwordx4 v[128:131], v4, s[44:47], s74 offen sc1
    buffer_load_dwordx4 v[132:135], v4, s[44:47], s75 offen sc1
    buffer_load_dwordx4 v[136:139], v4, s[44:47], s76 offen sc1
    buffer_load_dwordx4 v[140:143], v4, s[44:47], s77 offen sc1
.mp_177:
    buffer_load_dwordx4 v[128:131], v4, s[44:47], s74 offen sc1
    buffer_load_dwordx4 v[132:135], v4, s[44:47], s75 offen sc1
    buffer_load_dwordx4 v[136:139], v4, s[44:47], s76 offen sc1
    buffer_load_dwordx4 v[140:143], v4, s[44:47], s77 offen sc1
    s_mov_b64 exec, -1
    s_waitcnt vmcnt(4)
    v_max3_u32 v24, v128, v129, v130
    v_max3_u32 v25, v131, v132, v133
    v_max3_u32 v24, v24, v134, v135
    v_max3_u32 v25, v25, v136, v137
    v_max3_u32 v24, v24, v138, v139
    v_max3_u32 v25, v25, v140, v141
    v_max3_u32 v24, v24, v142, v143
    v_max_u32 v24, v24, v25
    v_cmp_eq_u32 vcc, -1, v24
    s_nop 0
    s_cbranch_vccz .ok_176
    s_mov_b64 exec, vcc
    s_add_u32 s57, s57, 1
    s_cmp_lt_u32 s57, 3000000
    s_cbranch_scc1 .mp_177
    s_branch .abort_1
.ok_176:
    v_add_u32 v25, s56, v4
    ds_write_b128 v25, v[128:131] offset:0
    ds_write_b128 v25, v[132:135] offset:1024
    ds_write_b128 v25, v[136:139] offset:2048
    ds_write_b128 v25, v[140:143] offset:3072
.mj_173:
    s_waitcnt lgkmcnt(0)
.nomp_171:
    s_barrier
    ds_read_b128 v[32:35], v13 offset:0
    ds_read_b128 v[36:39], v13 offset:512
    ds_read_b128 v[40:43], v13 offset:1024
    ds_read_b128 v[44:47], v13 offset:1536
    ds_read_b128 v[48:51], v13 offset:2048
    ds_read_b128 v[52:55], v13 offset:2560
    ds_read_b128 v[56:59], v13 offset:3072
    ds_read_b128 v[60:63], v13 offset:3584
    ds_read_b128 v[64:67], v13 offset:4096
    ds_read_b128 v[68:71], v13 offset:4608
    ds_read_b128 v[72:75], v13 offset:5120
    ds_read_b128 v[76:79], v13 offset:5632
    s_and_b32 s55, s54, 3
    s_lshl_b32 s55, s55, 17
    s_add_u32 s55, s55, 0x5a20000
    s_waitcnt lgkmcnt(11)
    v_smfmac_f32_16x16x64_bf16 v[112:115], v[32:35], a[0:7], v3
    ds_read_b128 v[80:83], v13 offset:6144
    s_waitcnt lgkmcnt(11)
    v_smfmac_f32_16x16x64_bf16 v[116:119], v[36:39], a[8:15], v3
    ds_read_b128 v[84:87], v13 offset:6656
    s_waitcnt lgkmcnt(11)
    v_smfmac_f32_16x16x64_bf16 v[112:115], v[40:43], a[16:23], v3
    ds_read_b128 v[88:91], v13 offset:7168
    s_waitcnt lgkmcnt(11)
    v_smfmac_f32_16x16x64_bf16 v[116:119], v[44:47], a[24:31], v3
    ds_read_b128 v[92:95], v13 offset:7680
    s_waitcnt lgkmcnt(11)
    v_smfmac_f32_16x16x64_bf16 v[112:115], v[48:51], a[32:39], v3
    ds_read_b128 v[96:99], v13 offset:8192
    s_waitcnt lgkmcnt(11)
    v_smfmac_f32_16x16x64_bf16 v[116:119], v[52:55], a[40:47], v3
    ds_read_b128 v[100:103], v13 offset:8704
    s_waitcnt lgkmcnt(11)
    v_smfmac_f32_16x16x64_bf16 v[112:115], v[56:59], a[48:55], v3
    ds_read_b128 v[104:107], v13 offset:9216
    s_waitcnt lgkmcnt(11)
    v_smfmac_f32_16x16x64_bf16 v[116:119], v[60:63], a[56:63], v3
    ds_read_b128 v[108:111], v13 offset:9728
    s_waitcnt lgkmcnt(11)
    v_smfmac_f32_16x16x64_bf16 v[112:115], v[64:67], a[64:71], v3
    s_waitcnt lgkmcnt(10)
    v_smfmac_f32_16x16x64_bf16 v[116:119], v[68:71], a[72:79], v3
    s_waitcnt lgkmcnt(9)
    v_smfmac_f32_16x16x64_bf16 v[112:115], v[72:75], a[80:87], v3
    s_waitcnt lgkmcnt(8)
    v_smfmac_f32_16x16x64_bf16 v[116:119], v[76:79], a[88:95], v3
    s_waitcnt lgkmcnt(7)
    v_smfmac_f32_16x16x64_bf16 v[112:115], v[80:83], a[96:103], v3
    s_waitcnt lgkmcnt(6)
    v_smfmac_f32_16x16x64_bf16 v[116:119], v[84:87], a[104:111], v3
    s_waitcnt lgkmcnt(5)
    v_smfmac_f32_16x16x64_bf16 v[112:115], v[88:91], a[112:119], v3
    s_waitcnt lgkmcnt(4)
    v_smfmac_f32_16x16x64_bf16 v[116:119], v[92:95], a[120:127], v3
    s_waitcnt lgkmcnt(3)
    v_smfmac_f32_16x16x64_bf16 v[112:115], v[96:99], a[128:135], v3
    s_waitcnt lgkmcnt(2)
    v_smfmac_f32_16x16x64_bf16 v[116:119], v[100:103], a[136:143], v3
    s_waitcnt lgkmcnt(1)
    v_smfmac_f32_16x16x64_bf16 v[112:115], v[104:107], a[144:151], v3
    s_waitcnt lgkmcnt(0)
    v_smfmac_f32_16x16x64_bf16 v[116:119], v[108:111], a[152:159], v3
    s_nop 7
    v_add_f32 v112, v112, v116
    v_add_f32 v113, v113, v117
    v_add_f32 v114, v114, v118
    v_add_f32 v115, v115, v119
    v_cvt_pk_bf16_f32 v112, v112, v113
    v_cvt_pk_bf16_f32 v113, v114, v115
    v_min_u32 v112, 0xfffffffe, v112
    v_min_u32 v113, 0xfffffffe, v113
    v_mov_b32 v116, v112
    v_mov_b32 v117, v113
    v_mov_b32 v118, v112
    v_mov_b32 v119, v113
    s_nop 0
    v_permlane16_swap_b32 v116, v118
    v_permlane16_swap_b32 v117, v119
    s_mov_b64 exec, s[72:73]
    buffer_store_dwordx4 v[116:119], v14, s[44:47], s55 offen sc1
    s_mov_b64 exec, -1
    s_lshl_b32 s55, s54, 16
    s_add_u32 s55, s55, 0x4400000
    buffer_store_dwordx2 v[112:113], v6, s[44:47], s55 offen sc1
    s_add_u32 s55, s54, 2
    s_and_b32 s55, s55, 3
    s_lshl_b32 s55, s55, 17
    s_add_u32 s55, s55, 0x5a20000
    buffer_store_dwordx2 v[20:21], v15, s[44:47], s55 offen sc1
    v_smfmac_f32_16x16x64_bf16 v[120:123], v[32:35], a[160:167], v3
    v_smfmac_f32_16x16x64_bf16 v[120:123], v[36:39], a[168:175], v3
    v_smfmac_f32_16x16x64_bf16 v[120:123], v[40:43], a[176:183], v3
    v_smfmac_f32_16x16x64_bf16 v[120:123], v[44:47], a[184:191], v3
    v_smfmac_f32_16x16x64_bf16 v[120:123], v[48:51], a[192:199], v3
    v_smfmac_f32_16x16x64_bf16 v[120:123], v[52:55], a[200:207], v3
    v_smfmac_f32_16x16x64_bf16 v[120:123], v[56:59], a[208:215], v3
    v_smfmac_f32_16x16x64_bf16 v[120:123], v[60:63], a[216:223], v3
    v_smfmac_f32_16x16x64_bf16 v[120:123], v[64:67], a[224:231], v3
    v_smfmac_f32_16x16x64_bf16 v[120:123], v[68:71], a[232:239], v3
    v_smfmac_f32_16x16x64_bf16 v[120:123], v[72:75], a[240:247], v3
    v_smfmac_f32_16x16x64_bf16 v[120:123], v[76:79], a[248:255], v3
    v_smfmac_f32_16x16x64_bf16 v[120:123], v[80:83], v[192:199], v3
    v_smfmac_f32_16x16x64_bf16 v[120:123], v[84:87], v[200:207], v3
    v_smfmac_f32_16x16x64_bf16 v[120:123], v[88:91], v[208:215], v3
    v_smfmac_f32_16x16x64_bf16 v[120:123], v[92:95], v[216:223], v3
    v_smfmac_f32_16x16x64_bf16 v[120:123], v[96:99], v[224:231], v3
    v_smfmac_f32_16x16x64_bf16 v[120:123], v[100:103], v[232:239], v3
    v_smfmac_f32_16x16x64_bf16 v[120:123], v[104:107], v[240:247], v3
    v_smfmac_f32_16x16x64_bf16 v[120:123], v[108:111], v[248:255], v3
    s_nop 7
    v_cvt_pk_bf16_f32 v120, v120, v121
    v_cvt_pk_bf16_f32 v121, v122, v123
    ds_write_b64 v7, v[120:121]
    s_waitcnt lgkmcnt(0)
    ds_read_b64_tr_b16 v[124:125], v8
    ds_read_b64_tr_b16 v[126:127], v8 offset:64
    s_lshl_b32 s55, s54, 16
    s_waitcnt lgkmcnt(0)
    s_mov_b64 exec, s[66:67]
    buffer_store_dwordx4 v[124:127], v9, s[44:47], s55 offen sc1
    s_mov_b64 exec, -1
    s_waitcnt vmcnt(0)
    s_barrier
    s_cmp_lg_u32 s53, 3
    s_cbranch_scc1 .pa_178
    s_mov_b64 exec, 1
    s_lshl_b32 s55, s54, 2
    s_add_u32 s55, s55, 0x5a0c100
    v_mov_b32 v22, s55
    v_mov_b32 v23, 1
    global_atomic_add v22, v23, s[40:41]
    s_mov_b64 exec, -1
.pa_178:
    s_add_u32 s54, s54, 1
    s_cmp_lt_u32 s54, 64
    s_cbranch_scc1 .vstep_170
    s_branch .done_2
.abort_1:
    s_mov_b64 exec, -1
    v_mov_b32 v1, 252
    v_mov_b32 v2, 1
    global_atomic_add v1, v2, s[38:39]
.done_2:
    s_endpgm
.section .rodata,"a"
.p2align 6
.amdhsa_kernel main_kernel
  .amdhsa_next_free_vgpr 512
  .amdhsa_next_free_sgpr 102
  .amdhsa_accum_offset 256
  .amdhsa_group_segment_fixed_size 0
  .amdhsa_kernarg_size 104
  .amdhsa_user_sgpr_count 2
  .amdhsa_user_sgpr_kernarg_segment_ptr 1
  .amdhsa_system_sgpr_workgroup_id_x 1
  .amdhsa_float_denorm_mode_32 3
.end_amdhsa_kernel
```
